```python
import torch

def _softmax(x, axis=-1):
    return torch.softmax(x, dim=axis)
def _gelu(x):
    return torch.nn.functional.gelu(x, approximate="tanh")
def _silu(x):
    return torch.nn.functional.silu(x)
def _sigmoid(x):
    return torch.sigmoid(x)
def _layernorm(x, axis=-1, eps=1e-5):
    m = x.mean(dim=axis, keepdim=True)
    v = x.var(dim=axis, keepdim=True, unbiased=False)
    return (x - m) / torch.sqrt(v + eps)
def _scatter_add(tgt, idx, src, axis=0):
    return tgt.clone().index_add_(axis, idx, src)
def _segment_sum(src, seg, n):
    out = torch.zeros((n,) + src.shape[1:], dtype=src.dtype)
    return out.index_add_(0, seg, src)
def _pad(x, pw):
    flat = tuple(v for pair in reversed(pw) for v in pair)
    return torch.nn.functional.pad(x, flat)

kernel_name = 'parallel_sum__mha_block__glu_gated_glu__prompt'

def setup_inputs():

    _w = (lambda a: (lambda t: t.to(torch.bfloat16) if t.is_floating_point() else t)(torch.as_tensor(a)))
    def _A_setup():
        B, S, D, H = 1, 2048, 1024, 32
        return {
            "x": _w((lambda *s: torch.randn(*s, dtype=torch.bfloat16) * 0.05)(B, S, D)),
            "wqkv": _w((lambda *s: torch.randn(*s, dtype=torch.bfloat16) * 0.05)(D, 3 * D)),
            "wo": _w((lambda *s: torch.randn(*s, dtype=torch.bfloat16) * 0.05)(D, D)),
        }
    _A_in = _A_setup()

    def _B_setup():
        B, S, D, F = 1, 2048, 1024, 3584
        return {
            "x": _w((lambda *s: torch.randn(*s, dtype=torch.bfloat16) * 0.05)(B, S, D)),
            "w_gate": _w((lambda *s: torch.randn(*s, dtype=torch.bfloat16) * 0.05)(D, F)),
            "w_up": _w((lambda *s: torch.randn(*s, dtype=torch.bfloat16) * 0.05)(D, F)),
            "w_down": _w((lambda *s: torch.randn(*s, dtype=torch.bfloat16) * 0.05)(F, D)),
        }
    _B_in = _B_setup()

    return {
        "A_x": _A_in["x"],
        "A_wqkv": _A_in["wqkv"],
        "A_wo": _A_in["wo"],
        "B_x": _B_in["x"],
        "B_w_gate": _B_in["w_gate"],
        "B_w_up": _B_in["w_up"],
        "B_w_down": _B_in["w_down"],
    }

def reference(A_x, A_wqkv, A_wo, B_x, B_w_gate, B_w_up, B_w_down):
    def _A_ref(x, wqkv, wo):
        B, S, D = x.shape
        H = 32
        Dh = D // H
        qkv = (lambda x, *d: x.permute(*d))((x @ wqkv).reshape(B, S, 3, H, Dh), 2, 0, 3, 1, 4)
        q, k, v = qkv[0], qkv[1], qkv[2]
        scores = torch.einsum("bhqd,bhkd->bhqk", q, k) * (Dh ** -0.5)
        p = _softmax(scores, axis=-1)
        o = torch.einsum("bhqk,bhkd->bhqd", p, v)
        return (lambda x, *d: x.permute(*d))(o, 0, 2, 1, 3).reshape(B, S, D) @ wo

    def _B_ref(x, w_gate, w_up, w_down):
        g = torch.einsum("bsd,df->bsf", x, w_gate)
        u = torch.einsum("bsd,df->bsf", x, w_up)
        h = _sigmoid(g) * u
        return torch.einsum("bsf,fd->bsd", h, w_down)

    x = A_x
    xn = _layernorm(x, axis=-1)
    return x + _A_ref(xn, A_wqkv, A_wo) + _B_ref(xn, B_w_gate, B_w_up, B_w_down)
```

```asm
; @launch kernel=mega_kernel grid=(256,1,1) block=(256,1,1) lds=163840
.amdgcn_target "amdgcn-amd-amdhsa--gfx950"
.text
.globl mega_kernel
.p2align 8
.type mega_kernel,@function
mega_kernel:
    s_cmp_ge_u32 s2, 256
    s_cbranch_scc0 L_mega_go
    s_endpgm
L_mega_go:
    s_load_dwordx2 s[4:5], s[0:1], 8
    s_load_dwordx2 s[6:7], s[0:1], 32
    s_load_dwordx2 s[8:9], s[0:1], 40
    s_load_dwordx2 s[10:11], s[0:1], 72
    s_load_dwordx2 s[68:69], s[0:1], 0
    s_load_dwordx2 s[70:71], s[0:1], 64
    v_lshrrev_b32 v1, 6, v0
    s_lshl_b32 s3, s2, 3
    v_readfirstlane_b32 s14, v1
    s_lshr_b32 s17, s2, 3
    s_and_b32 s12, s17, 3
    s_lshr_b32 s13, s17, 2
    s_lshr_b32 s15, s14, 1
    s_and_b32 s16, s14, 1
    v_and_b32 v6, 63, v0
    v_lshlrev_b32 v6, 4, v6
    s_getpc_b64 s[24:25]
L_pc_start:
    s_add_u32 s24, s24, L_code_0 - L_pc_start
    s_addc_u32 s25, s25, 0
    s_mov_b32 s26, L_at_begin - L_code_0
    s_mov_b32 s27, 0x00020000
    s_lshr_b32 s19, s2, 3
    s_lshl_b32 s19, s19, 2
    s_add_u32 s19, s19, s14
    s_lshl_b32 s19, s19, 10
    buffer_load_dwordx4 a[232:235], v6, s[24:27], s19 offen
L_code_0:
    s_waitcnt lgkmcnt(0)
    s_mov_b32 s64, s68
    s_mov_b32 s65, s69
    s_mov_b32 s66, 0x400000
    s_mov_b32 s67, 0x00020000
    v_and_b32 v33, 63, v0
    v_lshrrev_b32 v34, 6, v0
    v_and_b32 v35, 7, v33
    v_lshrrev_b32 v36, 3, v33
    v_lshl_add_u32 v37, v34, 4, v36
    v_add_u32 v38, s3, v35
    v_lshlrev_b32 v39, 11, v38
    v_lshrrev_b32 v40, 1, v37
    v_and_b32 v41, 1, v37
    v_lshl_add_u32 v39, v40, 6, v39
    v_lshl_add_u32 v39, v41, 4, v39
    buffer_load_dwordx4 v[48:51], v39, s[64:67], 0 offen
    buffer_load_dwordx4 v[52:55], v39, s[64:67], 0 offen offset:32
    buffer_load_dwordx4 v[56:59], v39, s[64:67], 0 offen offset:256
    buffer_load_dwordx4 v[60:63], v39, s[64:67], 0 offen offset:288
    v_lshrrev_b32 v40, 5, v38
    v_lshlrev_b32 v40, 6, v40
    v_add_u32 v40, v40, v37
    v_lshlrev_b32 v40, 10, v40
    v_and_b32 v41, 31, v38
    v_lshl_add_u32 v41, v41, 4, v40
    v_lshlrev_b32 v43, 4, v35
    v_lshl_add_u32 v44, v34, 2, v43
    v_and_b32 v0, 63, v0
    s_and_b32 s3, s2, 7
    s_lshl_b32 s17, s12, 1
    s_add_u32 s17, s17, s16
    s_lshr_b32 s18, s17, 2
    s_and_b32 s19, s17, 3
    s_cmp_eq_u32 s19, 3
    s_cbranch_scc1 L_g1_isv2
    s_sub_u32 s17, s17, s18
    s_mul_i32 s19, s3, 6
    s_add_u32 s19, s19, s17
    s_lshl_b32 s62, s19, 6
    s_lshl_b32 s19, s3, 2
    s_lshl_b32 s18, s17, 5
    s_add_u32 s18, s18, 3
    s_add_u32 s63, s17, 62
    s_cmp_lt_u32 s17, 2
    s_cselect_b32 s63, s18, s63
    s_add_u32 s63, s63, s19
    s_mov_b32 s77, 1
    s_branch L_g1_vd
L_g1_isv2:
    s_lshl_b32 s19, s3, 1
    s_add_u32 s19, s19, s18
    s_lshl_b32 s62, s19, 5
    s_add_u32 s62, s62, 3072
    s_lshl_b32 s63, s18, 5
    s_lshl_b32 s19, s3, 2
    s_add_u32 s63, s63, s19
    s_mov_b32 s77, 2
L_g1_vd:
    s_mov_b32 s20, s10
    s_mov_b32 s21, s11
    s_mov_b32 s22, 0x400000
    s_mov_b32 s23, 0x00020000
    s_add_u32 s64, s10, 0x3200000
    s_addc_u32 s65, s11, 0
    s_mov_b32 s66, 0x8000
    s_mov_b32 s67, 0x00020000
    s_getreg_b32 s17, hwreg(HW_REG_XCC_ID, 0, 4)
    s_add_u32 s17, s17, 1
    v_mov_b32 v8, s17
    s_lshl_b32 s17, s3, 5
    s_lshr_b32 s18, s2, 3
    s_add_u32 s17, s17, s18
    s_lshl_b32 s17, s17, 4
    s_add_u32 s17, s17, 28672
    s_lshl_b32 s74, s14, 20
    s_add_u32 s17, s17, s74
    s_mov_b64 exec, 1
    buffer_store_dword v8, off, s[64:67], s17 sc1
    v_mov_b32 v8, 0
    s_lshl_b32 s28, s3, 9
    s_lshr_b32 s17, s2, 3
    s_lshl_b32 s17, s17, 2
    s_add_u32 s17, s17, s14
    s_lshl_b32 s17, s17, 2
    s_add_u32 s29, s28, s17
    s_lshl_b32 s30, s13, 1
    s_add_u32 s30, s30, s15
    s_lshl_b32 s30, s30, 6
    s_lshl_b32 s17, s3, 3
    s_lshl_b32 s19, s12, 1
    s_add_u32 s17, s17, s19
    s_add_u32 s17, s17, s16
    s_add_u32 s30, s30, s17
    s_lshl_b32 s30, s30, 2
    s_add_u32 s31, s30, 8192
    s_add_u32 s30, s30, 4096
    s_lshr_b32 s17, s2, 4
    s_lshl_b32 s17, s17, 3
    s_add_u32 s17, s17, s3
    s_lshl_b32 s28, s17, 7
    s_add_u32 s28, s28, 12288
    s_bfe_u32 s17, s2, 0x10003
    s_lshl_b32 s17, s17, 2
    s_add_u32 s17, s17, s14
    s_lshl_b32 s17, s17, 2
    s_add_u32 s28, s28, s17
    buffer_store_dword v8, off, s[64:67], s29 sc1
    buffer_store_dword v8, off, s[64:67], s30 sc1
    buffer_store_dword v8, off, s[64:67], s31 sc1
    buffer_store_dword v8, off, s[64:67], s28 sc1
    s_mov_b64 exec, -1
    s_lshl_b32 s17, s13, 3
    s_lshl_b32 s18, s14, 1
    s_add_u32 s17, s17, s18
    s_lshl_b32 s17, s17, 16
    v_lshlrev_b32 v23, 4, v0
    v_add_u32 v1, s17, v23
    v_add_u32 v2, 0x10000, v1
    s_mov_b32 s59, 0
    s_lshl_b32 s60, s14, 12
    s_mul_i32 s18, s16, 10240
    s_add_u32 s18, s18, 16384
    s_lshl_b32 s72, s62, 1
    s_lshl_b32 s73, s63, 6
    v_lshrrev_b32 v9, 2, v0
    s_lshl_b32 s17, s15, 4
    v_add_u32 v9, s17, v9
    v_and_b32 v10, 3, v0
    v_bfe_u32 v11, v0, 4, 1
    v_lshlrev_b32 v11, 1, v11
    v_xor_b32 v10, v10, v11
    v_lshlrev_b32 v10, 4, v10
    v_mul_u32_u24 v8, 7168, v9
    v_mul_u32_u24 v9, 6144, v9
    v_add3_u32 v8, v8, v10, s72
    v_add3_u32 v9, v9, v10, s73
    s_lshl_b32 s17, s15, 10
    s_add_u32 s17, s17, s18
    s_cmp_eq_u32 s77, 2
    s_cbranch_scc1 L_g1_set2
    s_mov_b32 s24, s6
    s_mov_b32 s25, s7
    s_mov_b32 s26, 0x700000
    s_mov_b32 s49, 229376
    s_add_u32 s54, s17, 0
    v_add_u32 v3, 0, v8
    s_mov_b32 s28, s6
    s_mov_b32 s29, s7
    s_mov_b32 s30, 0x700000
    s_mov_b32 s50, 229376
    s_add_u32 s55, s17, 4096
    v_add_u32 v4, 64, v8
    s_mov_b32 s32, s8
    s_mov_b32 s33, s9
    s_mov_b32 s34, 0x700000
    s_mov_b32 s51, 229376
    s_add_u32 s56, s17, 2048
    v_add_u32 v5, 0, v8
    s_mov_b32 s36, s8
    s_mov_b32 s37, s9
    s_mov_b32 s38, 0x700000
    s_mov_b32 s52, 229376
    s_add_u32 s57, s17, 6144
    v_add_u32 v6, 64, v8
    s_mov_b32 s40, s4
    s_mov_b32 s41, s5
    s_mov_b32 s42, 0x600000
    s_mov_b32 s53, 196608
    s_add_u32 s58, s17, 8192
    v_add_u32 v7, 0, v9
    s_branch L_g1_setd
L_g1_set2:
    s_mov_b32 s24, s6
    s_mov_b32 s25, s7
    s_mov_b32 s26, 0x700000
    s_mov_b32 s49, 229376
    s_add_u32 s54, s17, 0
    v_add_u32 v3, 0, v8
    s_mov_b32 s28, s8
    s_mov_b32 s29, s9
    s_mov_b32 s30, 0x700000
    s_mov_b32 s50, 229376
    s_add_u32 s55, s17, 2048
    v_add_u32 v4, 0, v8
    s_mov_b32 s32, s4
    s_mov_b32 s33, s5
    s_mov_b32 s34, 0x600000
    s_mov_b32 s51, 196608
    s_add_u32 s56, s17, 4096
    v_add_u32 v5, 0, v9
    s_mov_b32 s36, s4
    s_mov_b32 s37, s5
    s_mov_b32 s38, 0x600000
    s_mov_b32 s52, 196608
    s_add_u32 s57, s17, 6144
    v_add_u32 v6, 64, v9
    s_mov_b32 s40, s4
    s_mov_b32 s41, s5
    s_mov_b32 s42, 0x600000
    s_mov_b32 s53, 196608
    s_add_u32 s58, s17, 8192
    v_add_u32 v7, 128, v9
L_g1_setd:
    s_mov_b32 s27, 0x00020000
    s_mov_b32 s44, 0
    s_mov_b32 s31, 0x00020000
    s_mov_b32 s45, 0
    s_mov_b32 s35, 0x00020000
    s_mov_b32 s46, 0
    s_mov_b32 s39, 0x00020000
    s_mov_b32 s47, 0
    s_mov_b32 s43, 0x00020000
    s_mov_b32 s48, 0
    s_mov_b32 s80, s6
    s_mov_b32 s81, s7
    s_mov_b32 s82, 0x0
    s_mov_b32 s83, 0x00020000
    s_mov_b32 s84, s8
    s_mov_b32 s85, s9
    s_mov_b32 s86, 0x0
    s_mov_b32 s87, 0x00020000
    s_mov_b32 s88, s4
    s_mov_b32 s89, s5
    s_mov_b32 s90, 0x0
    s_mov_b32 s91, 0x00020000
    s_mov_b32 s92, 0
    s_mov_b32 s93, 0
    s_mov_b32 s94, 0
    s_lshl_b32 s17, s2, 2
    s_add_u32 s17, s17, s14
    s_lshl_b32 s17, s17, 10
    v_add_u32 v23, s17, v23
    v_accvgpr_write_b32 a0, 0
    v_accvgpr_write_b32 a1, 0
    v_accvgpr_write_b32 a2, 0
    v_accvgpr_write_b32 a3, 0
    v_accvgpr_write_b32 a4, 0
    v_accvgpr_write_b32 a5, 0
    v_accvgpr_write_b32 a6, 0
    v_accvgpr_write_b32 a7, 0
    v_accvgpr_write_b32 a8, 0
    v_accvgpr_write_b32 a9, 0
    v_accvgpr_write_b32 a10, 0
    v_accvgpr_write_b32 a11, 0
    v_accvgpr_write_b32 a12, 0
    v_accvgpr_write_b32 a13, 0
    v_accvgpr_write_b32 a14, 0
    v_accvgpr_write_b32 a15, 0
    v_accvgpr_write_b32 a16, 0
    v_accvgpr_write_b32 a17, 0
    v_accvgpr_write_b32 a18, 0
    v_accvgpr_write_b32 a19, 0
    v_accvgpr_write_b32 a20, 0
    v_accvgpr_write_b32 a21, 0
    v_accvgpr_write_b32 a22, 0
    v_accvgpr_write_b32 a23, 0
    v_accvgpr_write_b32 a24, 0
    v_accvgpr_write_b32 a25, 0
    v_accvgpr_write_b32 a26, 0
    v_accvgpr_write_b32 a27, 0
    v_accvgpr_write_b32 a28, 0
    v_accvgpr_write_b32 a29, 0
    v_accvgpr_write_b32 a30, 0
    v_accvgpr_write_b32 a31, 0
    v_accvgpr_write_b32 a32, 0
    v_accvgpr_write_b32 a33, 0
    v_accvgpr_write_b32 a34, 0
    v_accvgpr_write_b32 a35, 0
    v_accvgpr_write_b32 a36, 0
    v_accvgpr_write_b32 a37, 0
    v_accvgpr_write_b32 a38, 0
    v_accvgpr_write_b32 a39, 0
    v_accvgpr_write_b32 a40, 0
    v_accvgpr_write_b32 a41, 0
    v_accvgpr_write_b32 a42, 0
    v_accvgpr_write_b32 a43, 0
    v_accvgpr_write_b32 a44, 0
    v_accvgpr_write_b32 a45, 0
    v_accvgpr_write_b32 a46, 0
    v_accvgpr_write_b32 a47, 0
    v_accvgpr_write_b32 a48, 0
    v_accvgpr_write_b32 a49, 0
    v_accvgpr_write_b32 a50, 0
    v_accvgpr_write_b32 a51, 0
    v_accvgpr_write_b32 a52, 0
    v_accvgpr_write_b32 a53, 0
    v_accvgpr_write_b32 a54, 0
    v_accvgpr_write_b32 a55, 0
    v_accvgpr_write_b32 a56, 0
    v_accvgpr_write_b32 a57, 0
    v_accvgpr_write_b32 a58, 0
    v_accvgpr_write_b32 a59, 0
    v_accvgpr_write_b32 a60, 0
    v_accvgpr_write_b32 a61, 0
    v_accvgpr_write_b32 a62, 0
    v_accvgpr_write_b32 a63, 0
    v_accvgpr_write_b32 a64, 0
    v_accvgpr_write_b32 a65, 0
    v_accvgpr_write_b32 a66, 0
    v_accvgpr_write_b32 a67, 0
    v_accvgpr_write_b32 a68, 0
    v_accvgpr_write_b32 a69, 0
    v_accvgpr_write_b32 a70, 0
    v_accvgpr_write_b32 a71, 0
    v_accvgpr_write_b32 a72, 0
    v_accvgpr_write_b32 a73, 0
    v_accvgpr_write_b32 a74, 0
    v_accvgpr_write_b32 a75, 0
    v_accvgpr_write_b32 a76, 0
    v_accvgpr_write_b32 a77, 0
    v_accvgpr_write_b32 a78, 0
    v_accvgpr_write_b32 a79, 0
    v_accvgpr_write_b32 a80, 0
    v_accvgpr_write_b32 a81, 0
    v_accvgpr_write_b32 a82, 0
    v_accvgpr_write_b32 a83, 0
    v_accvgpr_write_b32 a84, 0
    v_accvgpr_write_b32 a85, 0
    v_accvgpr_write_b32 a86, 0
    v_accvgpr_write_b32 a87, 0
    v_mov_b32 v108, 0
    v_mov_b32 v109, 0
    v_mov_b32 v110, 0
    v_mov_b32 v111, 0
    v_mov_b32 v112, 0
    v_mov_b32 v113, 0
    v_mov_b32 v114, 0
    v_mov_b32 v115, 0
    v_mov_b32 v116, 0
    v_mov_b32 v117, 0
    v_mov_b32 v118, 0
    v_mov_b32 v119, 0
    v_mov_b32 v120, 0
    v_mov_b32 v121, 0
    v_mov_b32 v122, 0
    v_mov_b32 v123, 0
    v_mov_b32 v124, 0
    v_mov_b32 v125, 0
    v_mov_b32 v126, 0
    v_mov_b32 v127, 0
    v_mov_b32 v128, 0
    v_mov_b32 v129, 0
    v_mov_b32 v130, 0
    v_mov_b32 v131, 0
    v_mov_b32 v132, 0
    v_mov_b32 v133, 0
    v_mov_b32 v134, 0
    v_mov_b32 v135, 0
    v_mov_b32 v136, 0
    v_mov_b32 v137, 0
    v_mov_b32 v138, 0
    v_mov_b32 v139, 0
    v_mov_b32 v140, 0
    v_mov_b32 v141, 0
    v_mov_b32 v142, 0
    v_mov_b32 v143, 0
    v_mov_b32 v144, 0
    v_mov_b32 v145, 0
    v_mov_b32 v146, 0
    v_mov_b32 v147, 0
    v_mov_b32 v148, 0
    v_mov_b32 v149, 0
    v_mov_b32 v150, 0
    v_mov_b32 v151, 0
    v_mov_b32 v152, 0
    v_mov_b32 v153, 0
    v_mov_b32 v154, 0
    v_mov_b32 v155, 0
    v_mov_b32 v156, 0
    v_mov_b32 v157, 0
    v_mov_b32 v158, 0
    v_mov_b32 v159, 0
    v_mov_b32 v160, 0
    v_mov_b32 v161, 0
    v_mov_b32 v162, 0
    v_mov_b32 v163, 0
    v_mov_b32 v164, 0
    v_mov_b32 v165, 0
    v_mov_b32 v166, 0
    v_mov_b32 v167, 0
    v_mov_b32 v168, 0
    v_mov_b32 v169, 0
    v_mov_b32 v170, 0
    v_mov_b32 v171, 0
    v_mov_b32 v172, 0
    v_mov_b32 v173, 0
    v_mov_b32 v174, 0
    v_mov_b32 v175, 0
    v_mov_b32 v176, 0
    v_mov_b32 v177, 0
    v_mov_b32 v178, 0
    v_mov_b32 v179, 0
    v_mov_b32 v180, 0
    v_mov_b32 v181, 0
    v_mov_b32 v182, 0
    v_mov_b32 v183, 0
    v_mov_b32 v184, 0
    v_mov_b32 v185, 0
    v_mov_b32 v186, 0
    v_mov_b32 v187, 0
    v_mov_b32 v188, 0
    v_mov_b32 v189, 0
    v_mov_b32 v190, 0
    v_mov_b32 v191, 0
    v_mov_b32 v192, 0
    v_mov_b32 v193, 0
    v_mov_b32 v194, 0
    v_mov_b32 v195, 0
    v_mov_b32 v196, 0
    v_mov_b32 v197, 0
    v_mov_b32 v198, 0
    v_mov_b32 v199, 0
    v_mov_b32 v200, 0
    v_mov_b32 v201, 0
    v_mov_b32 v202, 0
    v_mov_b32 v203, 0
    v_mov_b32 v204, 0
    v_mov_b32 v205, 0
    v_mov_b32 v206, 0
    v_mov_b32 v207, 0
    v_mov_b32 v208, 0
    v_mov_b32 v209, 0
    v_mov_b32 v210, 0
    v_mov_b32 v211, 0
    v_mov_b32 v212, 0
    v_mov_b32 v213, 0
    v_mov_b32 v214, 0
    v_mov_b32 v215, 0
    v_mov_b32 v216, 0
    v_mov_b32 v217, 0
    v_mov_b32 v218, 0
    v_mov_b32 v219, 0
    v_mov_b32 v220, 0
    v_mov_b32 v221, 0
    v_mov_b32 v222, 0
    v_mov_b32 v223, 0
    v_mov_b32 v224, 0
    v_mov_b32 v225, 0
    v_mov_b32 v226, 0
    v_mov_b32 v227, 0
    v_mov_b32 v228, 0
    v_mov_b32 v229, 0
    v_mov_b32 v230, 0
    v_mov_b32 v231, 0
    v_mov_b32 v232, 0
    v_mov_b32 v233, 0
    v_mov_b32 v234, 0
    v_mov_b32 v235, 0
    v_mov_b32 v236, 0
    v_mov_b32 v237, 0
    v_mov_b32 v238, 0
    v_mov_b32 v239, 0
    v_mov_b32 v240, 0
    v_mov_b32 v241, 0
    v_mov_b32 v242, 0
    v_mov_b32 v243, 0
    v_mov_b32 v244, 0
    v_mov_b32 v245, 0
    v_mov_b32 v246, 0
    v_mov_b32 v247, 0
    v_mov_b32 v248, 0
    v_mov_b32 v249, 0
    v_mov_b32 v250, 0
    v_mov_b32 v251, 0
    v_mov_b32 v252, 0
    v_mov_b32 v253, 0
    v_mov_b32 v254, 0
    v_mov_b32 v255, 0
    s_waitcnt vmcnt(5)
    s_mov_b32 s80, s70
    s_mov_b32 s81, s71
    s_mov_b32 s82, 0x100
    s_mov_b32 s83, 0x00020000
    s_cmp_lg_u32 s14, 0
    s_cbranch_scc1 L_ln_b
    v_lshlrev_b32 v64, 16, v48
    v_and_b32 v65, 0xffff0000, v48
    v_lshlrev_b32 v66, 16, v49
    s_add_u32 m0, s54, 0
    v_and_b32 v67, 0xffff0000, v49
    v_lshlrev_b32 v68, 16, v50
    v_and_b32 v69, 0xffff0000, v50
    buffer_load_dwordx4 v3, s[24:27], s44 offen lds
    s_add_u32 s44, s44, s49
    v_lshlrev_b32 v70, 16, v51
    v_and_b32 v71, 0xffff0000, v51
    v_lshlrev_b32 v72, 16, v52
    s_add_u32 m0, s55, 0
    v_and_b32 v73, 0xffff0000, v52
    v_lshlrev_b32 v74, 16, v53
    v_and_b32 v75, 0xffff0000, v53
    buffer_load_dwordx4 v4, s[28:31], s45 offen lds
    s_add_u32 s45, s45, s50
    v_lshlrev_b32 v76, 16, v54
    v_and_b32 v77, 0xffff0000, v54
    v_lshlrev_b32 v78, 16, v55
    s_add_u32 m0, s56, 0
    v_and_b32 v79, 0xffff0000, v55
    v_lshlrev_b32 v80, 16, v56
    v_and_b32 v81, 0xffff0000, v56
    buffer_load_dwordx4 v5, s[32:35], s46 offen lds
    s_add_u32 s46, s46, s51
    v_lshlrev_b32 v82, 16, v57
    v_and_b32 v83, 0xffff0000, v57
    v_lshlrev_b32 v84, 16, v58
    s_add_u32 m0, s57, 0
    v_and_b32 v85, 0xffff0000, v58
    v_lshlrev_b32 v86, 16, v59
    v_and_b32 v87, 0xffff0000, v59
    buffer_load_dwordx4 v6, s[36:39], s47 offen lds
    s_add_u32 s47, s47, s52
    v_lshlrev_b32 v88, 16, v60
    v_and_b32 v89, 0xffff0000, v60
    v_lshlrev_b32 v90, 16, v61
    s_add_u32 m0, s58, 0
    v_and_b32 v91, 0xffff0000, v61
    v_lshlrev_b32 v92, 16, v62
    v_and_b32 v93, 0xffff0000, v62
    buffer_load_dwordx4 v7, s[40:43], s48 offen lds
    s_add_u32 s48, s48, s53
    v_lshlrev_b32 v94, 16, v63
    v_and_b32 v95, 0xffff0000, v63
    v_pk_add_f32 v[100:101], v[64:65], v[66:67]
    s_add_u32 m0, s54, 36864
    v_pk_add_f32 v[96:97], v[68:69], v[70:71]
    v_pk_add_f32 v[100:101], v[100:101], v[72:73]
    v_pk_add_f32 v[96:97], v[96:97], v[74:75]
    buffer_load_dwordx4 v3, s[24:27], s44 offen lds
    s_add_u32 s44, s44, s49
    v_pk_add_f32 v[100:101], v[100:101], v[76:77]
    v_pk_add_f32 v[96:97], v[96:97], v[78:79]
    v_pk_add_f32 v[100:101], v[100:101], v[80:81]
    s_add_u32 m0, s55, 36864
    v_pk_add_f32 v[96:97], v[96:97], v[82:83]
    v_pk_add_f32 v[100:101], v[100:101], v[84:85]
    v_pk_add_f32 v[96:97], v[96:97], v[86:87]
    buffer_load_dwordx4 v4, s[28:31], s45 offen lds
    s_add_u32 s45, s45, s50
    v_pk_add_f32 v[100:101], v[100:101], v[88:89]
    v_pk_add_f32 v[96:97], v[96:97], v[90:91]
    v_pk_add_f32 v[100:101], v[100:101], v[92:93]
    s_add_u32 m0, s56, 36864
    v_pk_add_f32 v[96:97], v[96:97], v[94:95]
    v_pk_add_f32 v[100:101], v[100:101], v[96:97]
    v_add_f32 v45, v100, v101
    buffer_load_dwordx4 v5, s[32:35], s46 offen lds
    s_add_u32 s46, s46, s51
    s_nop 1
    v_add_f32_dpp v45, v45, v45 row_ror:8 row_mask:0xf bank_mask:0xf
    v_mov_b32 v46, v45
    s_add_u32 m0, s57, 36864
    s_nop 1
    v_permlane16_swap_b32 v45, v46
    s_nop 1
    buffer_load_dwordx4 v6, s[36:39], s47 offen lds
    s_add_u32 s47, s47, s52
    v_add_f32 v45, v45, v46
    v_mov_b32 v46, v45
    s_nop 1
    s_add_u32 m0, s58, 36864
    v_permlane32_swap_b32 v45, v46
    s_nop 1
    v_add_f32 v45, v45, v46
    buffer_load_dwordx4 v7, s[40:43], s48 offen lds
    s_add_u32 s48, s48, s53
    ds_write_b32 v44, v45 offset:0
    s_waitcnt lgkmcnt(0)
    s_barrier
    s_add_u32 m0, s54, 73728
    ds_read_b128 v[96:99], v43 offset:0
    s_waitcnt lgkmcnt(0)
    v_add_f32 v96, v96, v97
    buffer_load_dwordx4 v3, s[24:27], s44 offen lds
    s_add_u32 s44, s44, s49
    v_add_f32 v98, v98, v99
    v_add_f32 v45, v96, v98
    v_mul_f32 v102, 0x3a800000, v45
    s_add_u32 m0, s55, 73728
    v_pk_add_f32 v[96:97], v[64:65], v[102:103] op_sel_hi:[1,0] neg_lo:[0,1] neg_hi:[0,1]
    v_pk_mul_f32 v[100:101], v[96:97], v[96:97]
    v_pk_add_f32 v[98:99], v[66:67], v[102:103] op_sel_hi:[1,0] neg_lo:[0,1] neg_hi:[0,1]
    buffer_load_dwordx4 v4, s[28:31], s45 offen lds
    s_add_u32 s45, s45, s50
    v_pk_fma_f32 v[100:101], v[98:99], v[98:99], v[100:101]
    v_pk_add_f32 v[96:97], v[68:69], v[102:103] op_sel_hi:[1,0] neg_lo:[0,1] neg_hi:[0,1]
    v_pk_fma_f32 v[100:101], v[96:97], v[96:97], v[100:101]
    s_add_u32 m0, s56, 73728
    v_pk_add_f32 v[98:99], v[70:71], v[102:103] op_sel_hi:[1,0] neg_lo:[0,1] neg_hi:[0,1]
    v_pk_fma_f32 v[100:101], v[98:99], v[98:99], v[100:101]
    v_pk_add_f32 v[96:97], v[72:73], v[102:103] op_sel_hi:[1,0] neg_lo:[0,1] neg_hi:[0,1]
    buffer_load_dwordx4 v5, s[32:35], s46 offen lds
    s_add_u32 s46, s46, s51
    v_pk_fma_f32 v[100:101], v[96:97], v[96:97], v[100:101]
    v_pk_add_f32 v[98:99], v[74:75], v[102:103] op_sel_hi:[1,0] neg_lo:[0,1] neg_hi:[0,1]
    v_pk_fma_f32 v[100:101], v[98:99], v[98:99], v[100:101]
    s_add_u32 m0, s57, 73728
    v_pk_add_f32 v[96:97], v[76:77], v[102:103] op_sel_hi:[1,0] neg_lo:[0,1] neg_hi:[0,1]
    v_pk_fma_f32 v[100:101], v[96:97], v[96:97], v[100:101]
    v_pk_add_f32 v[98:99], v[78:79], v[102:103] op_sel_hi:[1,0] neg_lo:[0,1] neg_hi:[0,1]
    buffer_load_dwordx4 v6, s[36:39], s47 offen lds
    s_add_u32 s47, s47, s52
    v_pk_fma_f32 v[100:101], v[98:99], v[98:99], v[100:101]
    v_pk_add_f32 v[96:97], v[80:81], v[102:103] op_sel_hi:[1,0] neg_lo:[0,1] neg_hi:[0,1]
    v_pk_fma_f32 v[100:101], v[96:97], v[96:97], v[100:101]
    s_add_u32 m0, s58, 73728
    v_pk_add_f32 v[98:99], v[82:83], v[102:103] op_sel_hi:[1,0] neg_lo:[0,1] neg_hi:[0,1]
    v_pk_fma_f32 v[100:101], v[98:99], v[98:99], v[100:101]
    v_pk_add_f32 v[96:97], v[84:85], v[102:103] op_sel_hi:[1,0] neg_lo:[0,1] neg_hi:[0,1]
    buffer_load_dwordx4 v7, s[40:43], s48 offen lds
    s_add_u32 s48, s48, s53
    v_pk_fma_f32 v[100:101], v[96:97], v[96:97], v[100:101]
    v_pk_add_f32 v[98:99], v[86:87], v[102:103] op_sel_hi:[1,0] neg_lo:[0,1] neg_hi:[0,1]
    v_pk_fma_f32 v[100:101], v[98:99], v[98:99], v[100:101]
    s_add_u32 m0, s54, 110592
    v_pk_add_f32 v[96:97], v[88:89], v[102:103] op_sel_hi:[1,0] neg_lo:[0,1] neg_hi:[0,1]
    v_pk_fma_f32 v[100:101], v[96:97], v[96:97], v[100:101]
    v_pk_add_f32 v[98:99], v[90:91], v[102:103] op_sel_hi:[1,0] neg_lo:[0,1] neg_hi:[0,1]
    buffer_load_dwordx4 v3, s[24:27], s44 offen lds
    s_add_u32 s44, s44, s49
    v_pk_fma_f32 v[100:101], v[98:99], v[98:99], v[100:101]
    v_pk_add_f32 v[96:97], v[92:93], v[102:103] op_sel_hi:[1,0] neg_lo:[0,1] neg_hi:[0,1]
    v_pk_fma_f32 v[100:101], v[96:97], v[96:97], v[100:101]
    s_add_u32 m0, s55, 110592
    v_pk_add_f32 v[98:99], v[94:95], v[102:103] op_sel_hi:[1,0] neg_lo:[0,1] neg_hi:[0,1]
    v_pk_fma_f32 v[100:101], v[98:99], v[98:99], v[100:101]
    v_add_f32 v47, v100, v101
    buffer_load_dwordx4 v4, s[28:31], s45 offen lds
    s_add_u32 s45, s45, s50
    s_nop 1
    v_add_f32_dpp v47, v47, v47 row_ror:8 row_mask:0xf bank_mask:0xf
    v_mov_b32 v46, v47
    s_add_u32 m0, s56, 110592
    s_nop 1
    v_permlane16_swap_b32 v47, v46
    s_nop 1
    buffer_load_dwordx4 v5, s[32:35], s46 offen lds
    s_add_u32 s46, s46, s51
    v_add_f32 v47, v47, v46
    v_mov_b32 v46, v47
    s_nop 1
    s_add_u32 m0, s57, 110592
    v_permlane32_swap_b32 v47, v46
    s_nop 1
    v_add_f32 v47, v47, v46
    buffer_load_dwordx4 v6, s[36:39], s47 offen lds
    s_add_u32 s47, s47, s52
    ds_write_b32 v44, v47 offset:128
    s_waitcnt lgkmcnt(0)
    s_barrier
    s_add_u32 m0, s58, 110592
    ds_read_b128 v[96:99], v43 offset:128
    s_waitcnt lgkmcnt(0)
    v_add_f32 v96, v96, v97
    buffer_load_dwordx4 v7, s[40:43], s48 offen lds
    s_add_u32 s48, s48, s53
    v_add_f32 v98, v98, v99
    v_add_f32 v47, v96, v98
    v_mul_f32 v47, 0x3a800000, v47
    v_cvt_pk_bf16_f32 v102, v102, v47
    v_and_b32 v47, 0xffff0000, v102
    v_lshlrev_b32 v102, 16, v102
    v_add_f32 v47, 0x3727c5ac, v47
    v_cvt_pk_bf16_f32 v47, v47, v47
    v_and_b32 v47, 0xffff0000, v47
    v_sqrt_f32 v47, v47
    s_nop 0
    v_cvt_pk_bf16_f32 v47, v47, v47
    v_and_b32 v105, 0xffff0000, v47
    v_rcp_f32 v104, v105
    s_nop 0
    v_fma_f32 v96, -v105, v104, 1.0
    v_fma_f32 v104, v104, v96, v104
    v_pk_add_f32 v[64:65], v[64:65], v[102:103] op_sel_hi:[1,0] neg_lo:[0,1] neg_hi:[0,1]
    v_cvt_pk_bf16_f32 v96, v64, v65
    v_lshlrev_b32 v64, 16, v96
    v_and_b32 v65, 0xffff0000, v96
    v_pk_mul_f32 v[98:99], v[64:65], v[104:105] op_sel_hi:[1,0]
    v_pk_fma_f32 v[100:101], v[98:99], v[104:105], v[64:65] op_sel:[0,1,0] op_sel_hi:[1,1,1] neg_lo:[1,0,0] neg_hi:[1,0,0]
    v_pk_fma_f32 v[64:65], v[100:101], v[104:105], v[98:99] op_sel_hi:[1,0,1]
    v_cvt_pk_bf16_f32 v48, v64, v65
    v_pk_add_f32 v[66:67], v[66:67], v[102:103] op_sel_hi:[1,0] neg_lo:[0,1] neg_hi:[0,1]
    v_cvt_pk_bf16_f32 v96, v66, v67
    v_lshlrev_b32 v66, 16, v96
    v_and_b32 v67, 0xffff0000, v96
    v_pk_mul_f32 v[98:99], v[66:67], v[104:105] op_sel_hi:[1,0]
    v_pk_fma_f32 v[100:101], v[98:99], v[104:105], v[66:67] op_sel:[0,1,0] op_sel_hi:[1,1,1] neg_lo:[1,0,0] neg_hi:[1,0,0]
    v_pk_fma_f32 v[66:67], v[100:101], v[104:105], v[98:99] op_sel_hi:[1,0,1]
    v_cvt_pk_bf16_f32 v49, v66, v67
    v_pk_add_f32 v[68:69], v[68:69], v[102:103] op_sel_hi:[1,0] neg_lo:[0,1] neg_hi:[0,1]
    v_cvt_pk_bf16_f32 v96, v68, v69
    v_lshlrev_b32 v68, 16, v96
    v_and_b32 v69, 0xffff0000, v96
    v_pk_mul_f32 v[98:99], v[68:69], v[104:105] op_sel_hi:[1,0]
    v_pk_fma_f32 v[100:101], v[98:99], v[104:105], v[68:69] op_sel:[0,1,0] op_sel_hi:[1,1,1] neg_lo:[1,0,0] neg_hi:[1,0,0]
    v_pk_fma_f32 v[68:69], v[100:101], v[104:105], v[98:99] op_sel_hi:[1,0,1]
    v_cvt_pk_bf16_f32 v52, v68, v69
    v_pk_add_f32 v[70:71], v[70:71], v[102:103] op_sel_hi:[1,0] neg_lo:[0,1] neg_hi:[0,1]
    v_cvt_pk_bf16_f32 v96, v70, v71
    v_lshlrev_b32 v70, 16, v96
    v_and_b32 v71, 0xffff0000, v96
    v_pk_mul_f32 v[98:99], v[70:71], v[104:105] op_sel_hi:[1,0]
    v_pk_fma_f32 v[100:101], v[98:99], v[104:105], v[70:71] op_sel:[0,1,0] op_sel_hi:[1,1,1] neg_lo:[1,0,0] neg_hi:[1,0,0]
    v_pk_fma_f32 v[70:71], v[100:101], v[104:105], v[98:99] op_sel_hi:[1,0,1]
    v_cvt_pk_bf16_f32 v53, v70, v71
    v_pk_add_f32 v[72:73], v[72:73], v[102:103] op_sel_hi:[1,0] neg_lo:[0,1] neg_hi:[0,1]
    v_cvt_pk_bf16_f32 v96, v72, v73
    v_lshlrev_b32 v72, 16, v96
    v_and_b32 v73, 0xffff0000, v96
    v_pk_mul_f32 v[98:99], v[72:73], v[104:105] op_sel_hi:[1,0]
    v_pk_fma_f32 v[100:101], v[98:99], v[104:105], v[72:73] op_sel:[0,1,0] op_sel_hi:[1,1,1] neg_lo:[1,0,0] neg_hi:[1,0,0]
    v_pk_fma_f32 v[72:73], v[100:101], v[104:105], v[98:99] op_sel_hi:[1,0,1]
    v_cvt_pk_bf16_f32 v50, v72, v73
    v_pk_add_f32 v[74:75], v[74:75], v[102:103] op_sel_hi:[1,0] neg_lo:[0,1] neg_hi:[0,1]
    v_cvt_pk_bf16_f32 v96, v74, v75
    v_lshlrev_b32 v74, 16, v96
    v_and_b32 v75, 0xffff0000, v96
    v_pk_mul_f32 v[98:99], v[74:75], v[104:105] op_sel_hi:[1,0]
    v_pk_fma_f32 v[100:101], v[98:99], v[104:105], v[74:75] op_sel:[0,1,0] op_sel_hi:[1,1,1] neg_lo:[1,0,0] neg_hi:[1,0,0]
    v_pk_fma_f32 v[74:75], v[100:101], v[104:105], v[98:99] op_sel_hi:[1,0,1]
    v_cvt_pk_bf16_f32 v51, v74, v75
    v_pk_add_f32 v[76:77], v[76:77], v[102:103] op_sel_hi:[1,0] neg_lo:[0,1] neg_hi:[0,1]
    v_cvt_pk_bf16_f32 v96, v76, v77
    v_lshlrev_b32 v76, 16, v96
    v_and_b32 v77, 0xffff0000, v96
    v_pk_mul_f32 v[98:99], v[76:77], v[104:105] op_sel_hi:[1,0]
    v_pk_fma_f32 v[100:101], v[98:99], v[104:105], v[76:77] op_sel:[0,1,0] op_sel_hi:[1,1,1] neg_lo:[1,0,0] neg_hi:[1,0,0]
    v_pk_fma_f32 v[76:77], v[100:101], v[104:105], v[98:99] op_sel_hi:[1,0,1]
    v_cvt_pk_bf16_f32 v54, v76, v77
    v_pk_add_f32 v[78:79], v[78:79], v[102:103] op_sel_hi:[1,0] neg_lo:[0,1] neg_hi:[0,1]
    v_cvt_pk_bf16_f32 v96, v78, v79
    v_lshlrev_b32 v78, 16, v96
    v_and_b32 v79, 0xffff0000, v96
    v_pk_mul_f32 v[98:99], v[78:79], v[104:105] op_sel_hi:[1,0]
    v_pk_fma_f32 v[100:101], v[98:99], v[104:105], v[78:79] op_sel:[0,1,0] op_sel_hi:[1,1,1] neg_lo:[1,0,0] neg_hi:[1,0,0]
    v_pk_fma_f32 v[78:79], v[100:101], v[104:105], v[98:99] op_sel_hi:[1,0,1]
    v_cvt_pk_bf16_f32 v55, v78, v79
    v_pk_add_f32 v[80:81], v[80:81], v[102:103] op_sel_hi:[1,0] neg_lo:[0,1] neg_hi:[0,1]
    v_cvt_pk_bf16_f32 v96, v80, v81
    v_lshlrev_b32 v80, 16, v96
    v_and_b32 v81, 0xffff0000, v96
    v_pk_mul_f32 v[98:99], v[80:81], v[104:105] op_sel_hi:[1,0]
    v_pk_fma_f32 v[100:101], v[98:99], v[104:105], v[80:81] op_sel:[0,1,0] op_sel_hi:[1,1,1] neg_lo:[1,0,0] neg_hi:[1,0,0]
    v_pk_fma_f32 v[80:81], v[100:101], v[104:105], v[98:99] op_sel_hi:[1,0,1]
    v_cvt_pk_bf16_f32 v56, v80, v81
    v_pk_add_f32 v[82:83], v[82:83], v[102:103] op_sel_hi:[1,0] neg_lo:[0,1] neg_hi:[0,1]
    v_cvt_pk_bf16_f32 v96, v82, v83
    v_lshlrev_b32 v82, 16, v96
    v_and_b32 v83, 0xffff0000, v96
    v_pk_mul_f32 v[98:99], v[82:83], v[104:105] op_sel_hi:[1,0]
    v_pk_fma_f32 v[100:101], v[98:99], v[104:105], v[82:83] op_sel:[0,1,0] op_sel_hi:[1,1,1] neg_lo:[1,0,0] neg_hi:[1,0,0]
    v_pk_fma_f32 v[82:83], v[100:101], v[104:105], v[98:99] op_sel_hi:[1,0,1]
    v_cvt_pk_bf16_f32 v57, v82, v83
    v_pk_add_f32 v[84:85], v[84:85], v[102:103] op_sel_hi:[1,0] neg_lo:[0,1] neg_hi:[0,1]
    v_cvt_pk_bf16_f32 v96, v84, v85
    v_lshlrev_b32 v84, 16, v96
    v_and_b32 v85, 0xffff0000, v96
    v_pk_mul_f32 v[98:99], v[84:85], v[104:105] op_sel_hi:[1,0]
    v_pk_fma_f32 v[100:101], v[98:99], v[104:105], v[84:85] op_sel:[0,1,0] op_sel_hi:[1,1,1] neg_lo:[1,0,0] neg_hi:[1,0,0]
    v_pk_fma_f32 v[84:85], v[100:101], v[104:105], v[98:99] op_sel_hi:[1,0,1]
    v_cvt_pk_bf16_f32 v60, v84, v85
    v_pk_add_f32 v[86:87], v[86:87], v[102:103] op_sel_hi:[1,0] neg_lo:[0,1] neg_hi:[0,1]
    v_cvt_pk_bf16_f32 v96, v86, v87
    v_lshlrev_b32 v86, 16, v96
    v_and_b32 v87, 0xffff0000, v96
    v_pk_mul_f32 v[98:99], v[86:87], v[104:105] op_sel_hi:[1,0]
    v_pk_fma_f32 v[100:101], v[98:99], v[104:105], v[86:87] op_sel:[0,1,0] op_sel_hi:[1,1,1] neg_lo:[1,0,0] neg_hi:[1,0,0]
    v_pk_fma_f32 v[86:87], v[100:101], v[104:105], v[98:99] op_sel_hi:[1,0,1]
    v_cvt_pk_bf16_f32 v61, v86, v87
    v_pk_add_f32 v[88:89], v[88:89], v[102:103] op_sel_hi:[1,0] neg_lo:[0,1] neg_hi:[0,1]
    v_cvt_pk_bf16_f32 v96, v88, v89
    v_lshlrev_b32 v88, 16, v96
    v_and_b32 v89, 0xffff0000, v96
    v_pk_mul_f32 v[98:99], v[88:89], v[104:105] op_sel_hi:[1,0]
    v_pk_fma_f32 v[100:101], v[98:99], v[104:105], v[88:89] op_sel:[0,1,0] op_sel_hi:[1,1,1] neg_lo:[1,0,0] neg_hi:[1,0,0]
    v_pk_fma_f32 v[88:89], v[100:101], v[104:105], v[98:99] op_sel_hi:[1,0,1]
    v_cvt_pk_bf16_f32 v58, v88, v89
    v_pk_add_f32 v[90:91], v[90:91], v[102:103] op_sel_hi:[1,0] neg_lo:[0,1] neg_hi:[0,1]
    v_cvt_pk_bf16_f32 v96, v90, v91
    v_lshlrev_b32 v90, 16, v96
    v_and_b32 v91, 0xffff0000, v96
    v_pk_mul_f32 v[98:99], v[90:91], v[104:105] op_sel_hi:[1,0]
    v_pk_fma_f32 v[100:101], v[98:99], v[104:105], v[90:91] op_sel:[0,1,0] op_sel_hi:[1,1,1] neg_lo:[1,0,0] neg_hi:[1,0,0]
    v_pk_fma_f32 v[90:91], v[100:101], v[104:105], v[98:99] op_sel_hi:[1,0,1]
    v_cvt_pk_bf16_f32 v59, v90, v91
    v_pk_add_f32 v[92:93], v[92:93], v[102:103] op_sel_hi:[1,0] neg_lo:[0,1] neg_hi:[0,1]
    v_cvt_pk_bf16_f32 v96, v92, v93
    v_lshlrev_b32 v92, 16, v96
    v_and_b32 v93, 0xffff0000, v96
    v_pk_mul_f32 v[98:99], v[92:93], v[104:105] op_sel_hi:[1,0]
    v_pk_fma_f32 v[100:101], v[98:99], v[104:105], v[92:93] op_sel:[0,1,0] op_sel_hi:[1,1,1] neg_lo:[1,0,0] neg_hi:[1,0,0]
    v_pk_fma_f32 v[92:93], v[100:101], v[104:105], v[98:99] op_sel_hi:[1,0,1]
    v_cvt_pk_bf16_f32 v62, v92, v93
    v_pk_add_f32 v[94:95], v[94:95], v[102:103] op_sel_hi:[1,0] neg_lo:[0,1] neg_hi:[0,1]
    v_cvt_pk_bf16_f32 v96, v94, v95
    v_lshlrev_b32 v94, 16, v96
    v_and_b32 v95, 0xffff0000, v96
    v_pk_mul_f32 v[98:99], v[94:95], v[104:105] op_sel_hi:[1,0]
    v_pk_fma_f32 v[100:101], v[98:99], v[104:105], v[94:95] op_sel:[0,1,0] op_sel_hi:[1,1,1] neg_lo:[1,0,0] neg_hi:[1,0,0]
    v_pk_fma_f32 v[94:95], v[100:101], v[104:105], v[98:99] op_sel_hi:[1,0,1]
    v_cvt_pk_bf16_f32 v63, v94, v95
    v_add_u32 v42, 0x2000, v41
    buffer_store_dwordx4 v[48:51], v41, s[20:23], 0 offen offset:0 sc1
    buffer_store_dwordx4 v[52:55], v41, s[20:23], 0 offen offset:512 sc1
    buffer_store_dwordx4 v[56:59], v42, s[20:23], 0 offen offset:0 sc1
    buffer_store_dwordx4 v[60:63], v42, s[20:23], 0 offen offset:512 sc1
    s_waitcnt vmcnt(0)
    s_branch L_ln_d
L_ln_b:
    v_lshlrev_b32 v64, 16, v48
    v_and_b32 v65, 0xffff0000, v48
    v_lshlrev_b32 v66, 16, v49
    v_and_b32 v67, 0xffff0000, v49
    v_lshlrev_b32 v68, 16, v50
    v_and_b32 v69, 0xffff0000, v50
    v_lshlrev_b32 v70, 16, v51
    v_and_b32 v71, 0xffff0000, v51
    v_lshlrev_b32 v72, 16, v52
    v_and_b32 v73, 0xffff0000, v52
    v_lshlrev_b32 v74, 16, v53
    v_and_b32 v75, 0xffff0000, v53
    v_lshlrev_b32 v76, 16, v54
    v_and_b32 v77, 0xffff0000, v54
    v_lshlrev_b32 v78, 16, v55
    v_and_b32 v79, 0xffff0000, v55
    v_lshlrev_b32 v80, 16, v56
    v_and_b32 v81, 0xffff0000, v56
    v_lshlrev_b32 v82, 16, v57
    v_and_b32 v83, 0xffff0000, v57
    v_lshlrev_b32 v84, 16, v58
    v_and_b32 v85, 0xffff0000, v58
    v_lshlrev_b32 v86, 16, v59
    v_and_b32 v87, 0xffff0000, v59
    v_lshlrev_b32 v88, 16, v60
    v_and_b32 v89, 0xffff0000, v60
    v_lshlrev_b32 v90, 16, v61
    v_and_b32 v91, 0xffff0000, v61
    v_lshlrev_b32 v92, 16, v62
    v_and_b32 v93, 0xffff0000, v62
    v_lshlrev_b32 v94, 16, v63
    v_and_b32 v95, 0xffff0000, v63
    v_pk_add_f32 v[100:101], v[64:65], v[66:67]
    v_pk_add_f32 v[96:97], v[68:69], v[70:71]
    v_pk_add_f32 v[100:101], v[100:101], v[72:73]
    v_pk_add_f32 v[96:97], v[96:97], v[74:75]
    v_pk_add_f32 v[100:101], v[100:101], v[76:77]
    v_pk_add_f32 v[96:97], v[96:97], v[78:79]
    v_pk_add_f32 v[100:101], v[100:101], v[80:81]
    v_pk_add_f32 v[96:97], v[96:97], v[82:83]
    v_pk_add_f32 v[100:101], v[100:101], v[84:85]
    v_pk_add_f32 v[96:97], v[96:97], v[86:87]
    v_pk_add_f32 v[100:101], v[100:101], v[88:89]
    v_pk_add_f32 v[96:97], v[96:97], v[90:91]
    v_pk_add_f32 v[100:101], v[100:101], v[92:93]
    v_pk_add_f32 v[96:97], v[96:97], v[94:95]
    v_pk_add_f32 v[100:101], v[100:101], v[96:97]
    v_add_f32 v45, v100, v101
    s_nop 1
    v_add_f32_dpp v45, v45, v45 row_ror:8 row_mask:0xf bank_mask:0xf
    v_mov_b32 v46, v45
    s_nop 1
    v_permlane16_swap_b32 v45, v46
    s_nop 1
    v_add_f32 v45, v45, v46
    v_mov_b32 v46, v45
    s_nop 1
    v_permlane32_swap_b32 v45, v46
    s_nop 1
    v_add_f32 v45, v45, v46
    ds_write_b32 v44, v45 offset:0
    s_waitcnt lgkmcnt(0)
    s_barrier
    ds_read_b128 v[96:99], v43 offset:0
    s_waitcnt lgkmcnt(0)
    v_add_f32 v96, v96, v97
    v_add_f32 v98, v98, v99
    v_add_f32 v45, v96, v98
    v_mul_f32 v102, 0x3a800000, v45
    v_pk_add_f32 v[96:97], v[64:65], v[102:103] op_sel_hi:[1,0] neg_lo:[0,1] neg_hi:[0,1]
    v_pk_mul_f32 v[100:101], v[96:97], v[96:97]
    v_pk_add_f32 v[98:99], v[66:67], v[102:103] op_sel_hi:[1,0] neg_lo:[0,1] neg_hi:[0,1]
    v_pk_fma_f32 v[100:101], v[98:99], v[98:99], v[100:101]
    v_pk_add_f32 v[96:97], v[68:69], v[102:103] op_sel_hi:[1,0] neg_lo:[0,1] neg_hi:[0,1]
    v_pk_fma_f32 v[100:101], v[96:97], v[96:97], v[100:101]
    v_pk_add_f32 v[98:99], v[70:71], v[102:103] op_sel_hi:[1,0] neg_lo:[0,1] neg_hi:[0,1]
    v_pk_fma_f32 v[100:101], v[98:99], v[98:99], v[100:101]
    v_pk_add_f32 v[96:97], v[72:73], v[102:103] op_sel_hi:[1,0] neg_lo:[0,1] neg_hi:[0,1]
    v_pk_fma_f32 v[100:101], v[96:97], v[96:97], v[100:101]
    v_pk_add_f32 v[98:99], v[74:75], v[102:103] op_sel_hi:[1,0] neg_lo:[0,1] neg_hi:[0,1]
    v_pk_fma_f32 v[100:101], v[98:99], v[98:99], v[100:101]
    v_pk_add_f32 v[96:97], v[76:77], v[102:103] op_sel_hi:[1,0] neg_lo:[0,1] neg_hi:[0,1]
    v_pk_fma_f32 v[100:101], v[96:97], v[96:97], v[100:101]
    v_pk_add_f32 v[98:99], v[78:79], v[102:103] op_sel_hi:[1,0] neg_lo:[0,1] neg_hi:[0,1]
    v_pk_fma_f32 v[100:101], v[98:99], v[98:99], v[100:101]
    v_pk_add_f32 v[96:97], v[80:81], v[102:103] op_sel_hi:[1,0] neg_lo:[0,1] neg_hi:[0,1]
    v_pk_fma_f32 v[100:101], v[96:97], v[96:97], v[100:101]
    v_pk_add_f32 v[98:99], v[82:83], v[102:103] op_sel_hi:[1,0] neg_lo:[0,1] neg_hi:[0,1]
    v_pk_fma_f32 v[100:101], v[98:99], v[98:99], v[100:101]
    v_pk_add_f32 v[96:97], v[84:85], v[102:103] op_sel_hi:[1,0] neg_lo:[0,1] neg_hi:[0,1]
    v_pk_fma_f32 v[100:101], v[96:97], v[96:97], v[100:101]
    v_pk_add_f32 v[98:99], v[86:87], v[102:103] op_sel_hi:[1,0] neg_lo:[0,1] neg_hi:[0,1]
    v_pk_fma_f32 v[100:101], v[98:99], v[98:99], v[100:101]
    v_pk_add_f32 v[96:97], v[88:89], v[102:103] op_sel_hi:[1,0] neg_lo:[0,1] neg_hi:[0,1]
    v_pk_fma_f32 v[100:101], v[96:97], v[96:97], v[100:101]
    v_pk_add_f32 v[98:99], v[90:91], v[102:103] op_sel_hi:[1,0] neg_lo:[0,1] neg_hi:[0,1]
    v_pk_fma_f32 v[100:101], v[98:99], v[98:99], v[100:101]
    v_pk_add_f32 v[96:97], v[92:93], v[102:103] op_sel_hi:[1,0] neg_lo:[0,1] neg_hi:[0,1]
    v_pk_fma_f32 v[100:101], v[96:97], v[96:97], v[100:101]
    v_pk_add_f32 v[98:99], v[94:95], v[102:103] op_sel_hi:[1,0] neg_lo:[0,1] neg_hi:[0,1]
    v_pk_fma_f32 v[100:101], v[98:99], v[98:99], v[100:101]
    v_add_f32 v47, v100, v101
    s_nop 1
    v_add_f32_dpp v47, v47, v47 row_ror:8 row_mask:0xf bank_mask:0xf
    v_mov_b32 v46, v47
    s_nop 1
    v_permlane16_swap_b32 v47, v46
    s_nop 1
    v_add_f32 v47, v47, v46
    v_mov_b32 v46, v47
    s_nop 1
    v_permlane32_swap_b32 v47, v46
    s_nop 1
    v_add_f32 v47, v47, v46
    ds_write_b32 v44, v47 offset:128
    s_waitcnt lgkmcnt(0)
    s_barrier
    ds_read_b128 v[96:99], v43 offset:128
    s_waitcnt lgkmcnt(0)
    v_add_f32 v96, v96, v97
    v_add_f32 v98, v98, v99
    v_add_f32 v47, v96, v98
    v_mul_f32 v47, 0x3a800000, v47
    v_cvt_pk_bf16_f32 v102, v102, v47
    v_and_b32 v47, 0xffff0000, v102
    v_lshlrev_b32 v102, 16, v102
    v_add_f32 v47, 0x3727c5ac, v47
    v_cvt_pk_bf16_f32 v47, v47, v47
    v_and_b32 v47, 0xffff0000, v47
    v_sqrt_f32 v47, v47
    s_nop 0
    v_cvt_pk_bf16_f32 v47, v47, v47
    v_and_b32 v105, 0xffff0000, v47
    v_rcp_f32 v104, v105
    s_nop 0
    v_fma_f32 v96, -v105, v104, 1.0
    v_fma_f32 v104, v104, v96, v104
    v_pk_add_f32 v[64:65], v[64:65], v[102:103] op_sel_hi:[1,0] neg_lo:[0,1] neg_hi:[0,1]
    v_cvt_pk_bf16_f32 v96, v64, v65
    v_lshlrev_b32 v64, 16, v96
    v_and_b32 v65, 0xffff0000, v96
    v_pk_mul_f32 v[98:99], v[64:65], v[104:105] op_sel_hi:[1,0]
    v_pk_fma_f32 v[100:101], v[98:99], v[104:105], v[64:65] op_sel:[0,1,0] op_sel_hi:[1,1,1] neg_lo:[1,0,0] neg_hi:[1,0,0]
    v_pk_fma_f32 v[64:65], v[100:101], v[104:105], v[98:99] op_sel_hi:[1,0,1]
    v_cvt_pk_bf16_f32 v48, v64, v65
    v_pk_add_f32 v[66:67], v[66:67], v[102:103] op_sel_hi:[1,0] neg_lo:[0,1] neg_hi:[0,1]
    v_cvt_pk_bf16_f32 v96, v66, v67
    v_lshlrev_b32 v66, 16, v96
    v_and_b32 v67, 0xffff0000, v96
    v_pk_mul_f32 v[98:99], v[66:67], v[104:105] op_sel_hi:[1,0]
    v_pk_fma_f32 v[100:101], v[98:99], v[104:105], v[66:67] op_sel:[0,1,0] op_sel_hi:[1,1,1] neg_lo:[1,0,0] neg_hi:[1,0,0]
    v_pk_fma_f32 v[66:67], v[100:101], v[104:105], v[98:99] op_sel_hi:[1,0,1]
    v_cvt_pk_bf16_f32 v49, v66, v67
    v_pk_add_f32 v[68:69], v[68:69], v[102:103] op_sel_hi:[1,0] neg_lo:[0,1] neg_hi:[0,1]
    v_cvt_pk_bf16_f32 v96, v68, v69
    v_lshlrev_b32 v68, 16, v96
    v_and_b32 v69, 0xffff0000, v96
    v_pk_mul_f32 v[98:99], v[68:69], v[104:105] op_sel_hi:[1,0]
    v_pk_fma_f32 v[100:101], v[98:99], v[104:105], v[68:69] op_sel:[0,1,0] op_sel_hi:[1,1,1] neg_lo:[1,0,0] neg_hi:[1,0,0]
    v_pk_fma_f32 v[68:69], v[100:101], v[104:105], v[98:99] op_sel_hi:[1,0,1]
    v_cvt_pk_bf16_f32 v52, v68, v69
    v_pk_add_f32 v[70:71], v[70:71], v[102:103] op_sel_hi:[1,0] neg_lo:[0,1] neg_hi:[0,1]
    v_cvt_pk_bf16_f32 v96, v70, v71
    v_lshlrev_b32 v70, 16, v96
    v_and_b32 v71, 0xffff0000, v96
    v_pk_mul_f32 v[98:99], v[70:71], v[104:105] op_sel_hi:[1,0]
    v_pk_fma_f32 v[100:101], v[98:99], v[104:105], v[70:71] op_sel:[0,1,0] op_sel_hi:[1,1,1] neg_lo:[1,0,0] neg_hi:[1,0,0]
    v_pk_fma_f32 v[70:71], v[100:101], v[104:105], v[98:99] op_sel_hi:[1,0,1]
    v_cvt_pk_bf16_f32 v53, v70, v71
    v_pk_add_f32 v[72:73], v[72:73], v[102:103] op_sel_hi:[1,0] neg_lo:[0,1] neg_hi:[0,1]
    v_cvt_pk_bf16_f32 v96, v72, v73
    v_lshlrev_b32 v72, 16, v96
    v_and_b32 v73, 0xffff0000, v96
    v_pk_mul_f32 v[98:99], v[72:73], v[104:105] op_sel_hi:[1,0]
    v_pk_fma_f32 v[100:101], v[98:99], v[104:105], v[72:73] op_sel:[0,1,0] op_sel_hi:[1,1,1] neg_lo:[1,0,0] neg_hi:[1,0,0]
    v_pk_fma_f32 v[72:73], v[100:101], v[104:105], v[98:99] op_sel_hi:[1,0,1]
    v_cvt_pk_bf16_f32 v50, v72, v73
    v_pk_add_f32 v[74:75], v[74:75], v[102:103] op_sel_hi:[1,0] neg_lo:[0,1] neg_hi:[0,1]
    v_cvt_pk_bf16_f32 v96, v74, v75
    v_lshlrev_b32 v74, 16, v96
    v_and_b32 v75, 0xffff0000, v96
    v_pk_mul_f32 v[98:99], v[74:75], v[104:105] op_sel_hi:[1,0]
    v_pk_fma_f32 v[100:101], v[98:99], v[104:105], v[74:75] op_sel:[0,1,0] op_sel_hi:[1,1,1] neg_lo:[1,0,0] neg_hi:[1,0,0]
    v_pk_fma_f32 v[74:75], v[100:101], v[104:105], v[98:99] op_sel_hi:[1,0,1]
    v_cvt_pk_bf16_f32 v51, v74, v75
    v_pk_add_f32 v[76:77], v[76:77], v[102:103] op_sel_hi:[1,0] neg_lo:[0,1] neg_hi:[0,1]
    v_cvt_pk_bf16_f32 v96, v76, v77
    v_lshlrev_b32 v76, 16, v96
    v_and_b32 v77, 0xffff0000, v96
    v_pk_mul_f32 v[98:99], v[76:77], v[104:105] op_sel_hi:[1,0]
    v_pk_fma_f32 v[100:101], v[98:99], v[104:105], v[76:77] op_sel:[0,1,0] op_sel_hi:[1,1,1] neg_lo:[1,0,0] neg_hi:[1,0,0]
    v_pk_fma_f32 v[76:77], v[100:101], v[104:105], v[98:99] op_sel_hi:[1,0,1]
    v_cvt_pk_bf16_f32 v54, v76, v77
    v_pk_add_f32 v[78:79], v[78:79], v[102:103] op_sel_hi:[1,0] neg_lo:[0,1] neg_hi:[0,1]
    v_cvt_pk_bf16_f32 v96, v78, v79
    v_lshlrev_b32 v78, 16, v96
    v_and_b32 v79, 0xffff0000, v96
    v_pk_mul_f32 v[98:99], v[78:79], v[104:105] op_sel_hi:[1,0]
    v_pk_fma_f32 v[100:101], v[98:99], v[104:105], v[78:79] op_sel:[0,1,0] op_sel_hi:[1,1,1] neg_lo:[1,0,0] neg_hi:[1,0,0]
    v_pk_fma_f32 v[78:79], v[100:101], v[104:105], v[98:99] op_sel_hi:[1,0,1]
    v_cvt_pk_bf16_f32 v55, v78, v79
    v_pk_add_f32 v[80:81], v[80:81], v[102:103] op_sel_hi:[1,0] neg_lo:[0,1] neg_hi:[0,1]
    v_cvt_pk_bf16_f32 v96, v80, v81
    v_lshlrev_b32 v80, 16, v96
    v_and_b32 v81, 0xffff0000, v96
    v_pk_mul_f32 v[98:99], v[80:81], v[104:105] op_sel_hi:[1,0]
    v_pk_fma_f32 v[100:101], v[98:99], v[104:105], v[80:81] op_sel:[0,1,0] op_sel_hi:[1,1,1] neg_lo:[1,0,0] neg_hi:[1,0,0]
    v_pk_fma_f32 v[80:81], v[100:101], v[104:105], v[98:99] op_sel_hi:[1,0,1]
    v_cvt_pk_bf16_f32 v56, v80, v81
    v_pk_add_f32 v[82:83], v[82:83], v[102:103] op_sel_hi:[1,0] neg_lo:[0,1] neg_hi:[0,1]
    v_cvt_pk_bf16_f32 v96, v82, v83
    v_lshlrev_b32 v82, 16, v96
    v_and_b32 v83, 0xffff0000, v96
    v_pk_mul_f32 v[98:99], v[82:83], v[104:105] op_sel_hi:[1,0]
    v_pk_fma_f32 v[100:101], v[98:99], v[104:105], v[82:83] op_sel:[0,1,0] op_sel_hi:[1,1,1] neg_lo:[1,0,0] neg_hi:[1,0,0]
    v_pk_fma_f32 v[82:83], v[100:101], v[104:105], v[98:99] op_sel_hi:[1,0,1]
    v_cvt_pk_bf16_f32 v57, v82, v83
    v_pk_add_f32 v[84:85], v[84:85], v[102:103] op_sel_hi:[1,0] neg_lo:[0,1] neg_hi:[0,1]
    v_cvt_pk_bf16_f32 v96, v84, v85
    v_lshlrev_b32 v84, 16, v96
    v_and_b32 v85, 0xffff0000, v96
    v_pk_mul_f32 v[98:99], v[84:85], v[104:105] op_sel_hi:[1,0]
    v_pk_fma_f32 v[100:101], v[98:99], v[104:105], v[84:85] op_sel:[0,1,0] op_sel_hi:[1,1,1] neg_lo:[1,0,0] neg_hi:[1,0,0]
    v_pk_fma_f32 v[84:85], v[100:101], v[104:105], v[98:99] op_sel_hi:[1,0,1]
    v_cvt_pk_bf16_f32 v60, v84, v85
    v_pk_add_f32 v[86:87], v[86:87], v[102:103] op_sel_hi:[1,0] neg_lo:[0,1] neg_hi:[0,1]
    v_cvt_pk_bf16_f32 v96, v86, v87
    v_lshlrev_b32 v86, 16, v96
    v_and_b32 v87, 0xffff0000, v96
    v_pk_mul_f32 v[98:99], v[86:87], v[104:105] op_sel_hi:[1,0]
    v_pk_fma_f32 v[100:101], v[98:99], v[104:105], v[86:87] op_sel:[0,1,0] op_sel_hi:[1,1,1] neg_lo:[1,0,0] neg_hi:[1,0,0]
    v_pk_fma_f32 v[86:87], v[100:101], v[104:105], v[98:99] op_sel_hi:[1,0,1]
    v_cvt_pk_bf16_f32 v61, v86, v87
    v_pk_add_f32 v[88:89], v[88:89], v[102:103] op_sel_hi:[1,0] neg_lo:[0,1] neg_hi:[0,1]
    v_cvt_pk_bf16_f32 v96, v88, v89
    v_lshlrev_b32 v88, 16, v96
    v_and_b32 v89, 0xffff0000, v96
    v_pk_mul_f32 v[98:99], v[88:89], v[104:105] op_sel_hi:[1,0]
    v_pk_fma_f32 v[100:101], v[98:99], v[104:105], v[88:89] op_sel:[0,1,0] op_sel_hi:[1,1,1] neg_lo:[1,0,0] neg_hi:[1,0,0]
    v_pk_fma_f32 v[88:89], v[100:101], v[104:105], v[98:99] op_sel_hi:[1,0,1]
    v_cvt_pk_bf16_f32 v58, v88, v89
    v_pk_add_f32 v[90:91], v[90:91], v[102:103] op_sel_hi:[1,0] neg_lo:[0,1] neg_hi:[0,1]
    v_cvt_pk_bf16_f32 v96, v90, v91
    v_lshlrev_b32 v90, 16, v96
    v_and_b32 v91, 0xffff0000, v96
    v_pk_mul_f32 v[98:99], v[90:91], v[104:105] op_sel_hi:[1,0]
    v_pk_fma_f32 v[100:101], v[98:99], v[104:105], v[90:91] op_sel:[0,1,0] op_sel_hi:[1,1,1] neg_lo:[1,0,0] neg_hi:[1,0,0]
    v_pk_fma_f32 v[90:91], v[100:101], v[104:105], v[98:99] op_sel_hi:[1,0,1]
    v_cvt_pk_bf16_f32 v59, v90, v91
    v_pk_add_f32 v[92:93], v[92:93], v[102:103] op_sel_hi:[1,0] neg_lo:[0,1] neg_hi:[0,1]
    v_cvt_pk_bf16_f32 v96, v92, v93
    v_lshlrev_b32 v92, 16, v96
    v_and_b32 v93, 0xffff0000, v96
    v_pk_mul_f32 v[98:99], v[92:93], v[104:105] op_sel_hi:[1,0]
    v_pk_fma_f32 v[100:101], v[98:99], v[104:105], v[92:93] op_sel:[0,1,0] op_sel_hi:[1,1,1] neg_lo:[1,0,0] neg_hi:[1,0,0]
    v_pk_fma_f32 v[92:93], v[100:101], v[104:105], v[98:99] op_sel_hi:[1,0,1]
    v_cvt_pk_bf16_f32 v62, v92, v93
    v_pk_add_f32 v[94:95], v[94:95], v[102:103] op_sel_hi:[1,0] neg_lo:[0,1] neg_hi:[0,1]
    v_cvt_pk_bf16_f32 v96, v94, v95
    v_lshlrev_b32 v94, 16, v96
    v_and_b32 v95, 0xffff0000, v96
    v_pk_mul_f32 v[98:99], v[94:95], v[104:105] op_sel_hi:[1,0]
    v_pk_fma_f32 v[100:101], v[98:99], v[104:105], v[94:95] op_sel:[0,1,0] op_sel_hi:[1,1,1] neg_lo:[1,0,0] neg_hi:[1,0,0]
    v_pk_fma_f32 v[94:95], v[100:101], v[104:105], v[98:99] op_sel_hi:[1,0,1]
    v_cvt_pk_bf16_f32 v63, v94, v95
    v_add_u32 v42, 0x2000, v41
    buffer_store_dwordx4 v[48:51], v41, s[20:23], 0 offen offset:0 sc1
    buffer_store_dwordx4 v[52:55], v41, s[20:23], 0 offen offset:512 sc1
    buffer_store_dwordx4 v[56:59], v42, s[20:23], 0 offen offset:0 sc1
    buffer_store_dwordx4 v[60:63], v42, s[20:23], 0 offen offset:512 sc1
    s_add_u32 m0, s54, 0
    s_nop 0
    buffer_load_dwordx4 v3, s[24:27], s44 offen lds
    s_add_u32 s44, s44, s49
    s_add_u32 m0, s55, 0
    s_nop 0
    buffer_load_dwordx4 v4, s[28:31], s45 offen lds
    s_add_u32 s45, s45, s50
    s_add_u32 m0, s56, 0
    s_nop 0
    buffer_load_dwordx4 v5, s[32:35], s46 offen lds
    s_add_u32 s46, s46, s51
    s_add_u32 m0, s57, 0
    s_nop 0
    buffer_load_dwordx4 v6, s[36:39], s47 offen lds
    s_add_u32 s47, s47, s52
    s_add_u32 m0, s58, 0
    s_nop 0
    buffer_load_dwordx4 v7, s[40:43], s48 offen lds
    s_add_u32 s48, s48, s53
    s_waitcnt vmcnt(5)
L_ln_d:
    s_barrier
    s_cmp_lg_u32 s14, 0
    s_cbranch_scc1 L_x_others
    v_mov_b32 v8, 1
    s_lshl_b32 s17, s13, 5
    s_mov_b64 exec, 1
    buffer_atomic_add v8, off, s[80:83], s17 sc0 sc1
    s_mov_b64 exec, -1
    v_mov_b32 v9, 0
    s_waitcnt vmcnt(0)
    v_readfirstlane_b32 s74, v8
    s_cmp_eq_u32 s74, 31
    s_cbranch_scc1 L_x_last
    v_mov_b32 v31, 0
    v_mov_b32 v32, 0
    v_mov_b32 v33, 0
    v_mov_b32 v34, 0
    v_mov_b32 v35, 0
    v_mov_b32 v36, 0
    v_mov_b32 v37, 0
    v_mov_b32 v38, 0
    v_mov_b32 v39, 0
    v_mov_b32 v40, 0
    v_mov_b32 v41, 0
    v_mov_b32 v42, 0
    v_mov_b32 v43, 0
    v_mov_b32 v44, 0
    v_mov_b32 v45, 0
    v_mov_b32 v46, 0
    v_mov_b32 v47, 0
    v_mov_b32 v48, 0
    v_mov_b32 v49, 0
    v_mov_b32 v50, 0
    v_mov_b32 v51, 0
    v_mov_b32 v52, 0
    v_mov_b32 v53, 0
    v_mov_b32 v54, 0
    v_mov_b32 v55, 0
    v_mov_b32 v56, 0
    v_mov_b32 v57, 0
    v_mov_b32 v58, 0
    v_mov_b32 v59, 0
    v_mov_b32 v60, 0
    v_mov_b32 v61, 0
    v_mov_b32 v62, 0
    v_mov_b32 v63, 0
    v_mov_b32 v64, 0
    v_mov_b32 v65, 0
    v_mov_b32 v66, 0
    v_mov_b32 v67, 0
    v_mov_b32 v68, 0
    v_mov_b32 v69, 0
    v_mov_b32 v70, 0
    v_mov_b32 v71, 0
    v_mov_b32 v72, 0
    v_mov_b32 v73, 0
    v_mov_b32 v74, 0
    v_mov_b32 v75, 0
    v_mov_b32 v76, 0
    v_mov_b32 v77, 0
    v_mov_b32 v78, 0
    v_mov_b32 v79, 0
    v_mov_b32 v80, 0
    v_mov_b32 v81, 0
    v_mov_b32 v82, 0
    v_mov_b32 v83, 0
    v_mov_b32 v84, 0
    v_mov_b32 v85, 0
    v_mov_b32 v86, 0
    v_mov_b32 v87, 0
    v_mov_b32 v88, 0
    v_mov_b32 v89, 0
    v_mov_b32 v90, 0
    v_mov_b32 v91, 0
    v_mov_b32 v92, 0
    v_mov_b32 v93, 0
    v_mov_b32 v94, 0
    v_mov_b32 v95, 0
    v_mov_b32 v96, 0
    v_mov_b32 v97, 0
    v_mov_b32 v98, 0
    v_mov_b32 v99, 0
    v_mov_b32 v100, 0
    v_mov_b32 v101, 0
    v_mov_b32 v102, 0
    v_mov_b32 v103, 0
    v_mov_b32 v104, 0
    v_mov_b32 v105, 0
    v_mov_b32 v106, 0
    v_mov_b32 v107, 0
    buffer_load_dword v10, v9, s[80:83], s17 offen sc1
    s_waitcnt vmcnt(0)
    s_mov_b32 s19, 0x80000
L_fw_x:
    v_cmp_gt_u32 vcc, 32, v10
    s_nop 1
    s_cmp_eq_u64 vcc, 0
    s_cbranch_scc1 L_fwd_x
    s_sleep 4
    buffer_load_dword v10, v9, s[80:83], s17 offen sc1
    s_waitcnt vmcnt(0)
    s_sub_u32 s19, s19, 1
    s_cmp_lg_u32 s19, 0
    s_cbranch_scc1 L_fw_x
L_fwd_x:
    s_branch L_x_done
L_x_last:
    v_mov_b32 v31, 0
    v_mov_b32 v32, 0
    v_mov_b32 v33, 0
    v_mov_b32 v34, 0
    v_mov_b32 v35, 0
    v_mov_b32 v36, 0
    v_mov_b32 v37, 0
    v_mov_b32 v38, 0
    v_mov_b32 v39, 0
    v_mov_b32 v40, 0
    v_mov_b32 v41, 0
    v_mov_b32 v42, 0
    v_mov_b32 v43, 0
    v_mov_b32 v44, 0
    v_mov_b32 v45, 0
    v_mov_b32 v46, 0
    v_mov_b32 v47, 0
    v_mov_b32 v48, 0
    v_mov_b32 v49, 0
    v_mov_b32 v50, 0
    v_mov_b32 v51, 0
    v_mov_b32 v52, 0
    v_mov_b32 v53, 0
    v_mov_b32 v54, 0
    v_mov_b32 v55, 0
    v_mov_b32 v56, 0
    v_mov_b32 v57, 0
    v_mov_b32 v58, 0
    v_mov_b32 v59, 0
    v_mov_b32 v60, 0
    v_mov_b32 v61, 0
    v_mov_b32 v62, 0
    v_mov_b32 v63, 0
    v_mov_b32 v64, 0
    v_mov_b32 v65, 0
    v_mov_b32 v66, 0
    v_mov_b32 v67, 0
    v_mov_b32 v68, 0
    v_mov_b32 v69, 0
    v_mov_b32 v70, 0
    v_mov_b32 v71, 0
    v_mov_b32 v72, 0
    v_mov_b32 v73, 0
    v_mov_b32 v74, 0
    v_mov_b32 v75, 0
    v_mov_b32 v76, 0
    v_mov_b32 v77, 0
    v_mov_b32 v78, 0
    v_mov_b32 v79, 0
    v_mov_b32 v80, 0
    v_mov_b32 v81, 0
    v_mov_b32 v82, 0
    v_mov_b32 v83, 0
    v_mov_b32 v84, 0
    v_mov_b32 v85, 0
    v_mov_b32 v86, 0
    v_mov_b32 v87, 0
    v_mov_b32 v88, 0
    v_mov_b32 v89, 0
    v_mov_b32 v90, 0
    v_mov_b32 v91, 0
    v_mov_b32 v92, 0
    v_mov_b32 v93, 0
    v_mov_b32 v94, 0
    v_mov_b32 v95, 0
    v_mov_b32 v96, 0
    v_mov_b32 v97, 0
    v_mov_b32 v98, 0
    v_mov_b32 v99, 0
    v_mov_b32 v100, 0
    v_mov_b32 v101, 0
    v_mov_b32 v102, 0
    v_mov_b32 v103, 0
    v_mov_b32 v104, 0
    v_mov_b32 v105, 0
    v_mov_b32 v106, 0
    v_mov_b32 v107, 0
    s_branch L_x_done
L_x_others:
    s_add_u32 m0, s54, 36864
    s_nop 0
    buffer_load_dwordx4 v3, s[24:27], s44 offen lds
    s_add_u32 s44, s44, s49
    s_add_u32 m0, s55, 36864
    s_nop 0
    buffer_load_dwordx4 v4, s[28:31], s45 offen lds
    s_add_u32 s45, s45, s50
    s_add_u32 m0, s56, 36864
    s_nop 0
    buffer_load_dwordx4 v5, s[32:35], s46 offen lds
    s_add_u32 s46, s46, s51
    s_add_u32 m0, s57, 36864
    s_nop 0
    buffer_load_dwordx4 v6, s[36:39], s47 offen lds
    s_add_u32 s47, s47, s52
    s_add_u32 m0, s58, 36864
    s_nop 0
    buffer_load_dwordx4 v7, s[40:43], s48 offen lds
    s_add_u32 s48, s48, s53
    s_add_u32 m0, s54, 73728
    s_nop 0
    buffer_load_dwordx4 v3, s[24:27], s44 offen lds
    s_add_u32 s44, s44, s49
    s_add_u32 m0, s55, 73728
    s_nop 0
    buffer_load_dwordx4 v4, s[28:31], s45 offen lds
    s_add_u32 s45, s45, s50
    s_add_u32 m0, s56, 73728
    s_nop 0
    buffer_load_dwordx4 v5, s[32:35], s46 offen lds
    s_add_u32 s46, s46, s51
    s_add_u32 m0, s57, 73728
    s_nop 0
    buffer_load_dwordx4 v6, s[36:39], s47 offen lds
    s_add_u32 s47, s47, s52
    s_add_u32 m0, s58, 73728
    s_nop 0
    buffer_load_dwordx4 v7, s[40:43], s48 offen lds
    s_add_u32 s48, s48, s53
    s_add_u32 m0, s54, 110592
    s_nop 0
    buffer_load_dwordx4 v3, s[24:27], s44 offen lds
    s_add_u32 s44, s44, s49
    s_add_u32 m0, s55, 110592
    s_nop 0
    buffer_load_dwordx4 v4, s[28:31], s45 offen lds
    s_add_u32 s45, s45, s50
    s_add_u32 m0, s56, 110592
    s_nop 0
    buffer_load_dwordx4 v5, s[32:35], s46 offen lds
    s_add_u32 s46, s46, s51
    s_add_u32 m0, s57, 110592
    s_nop 0
    buffer_load_dwordx4 v6, s[36:39], s47 offen lds
    s_add_u32 s47, s47, s52
    s_add_u32 m0, s58, 110592
    s_nop 0
    buffer_load_dwordx4 v7, s[40:43], s48 offen lds
    s_add_u32 s48, s48, s53
    v_mov_b32 v31, 0
    v_mov_b32 v32, 0
    v_mov_b32 v33, 0
    v_mov_b32 v34, 0
    v_mov_b32 v35, 0
    v_mov_b32 v36, 0
    v_mov_b32 v37, 0
    v_mov_b32 v38, 0
    v_mov_b32 v39, 0
    v_mov_b32 v40, 0
    v_mov_b32 v41, 0
    v_mov_b32 v42, 0
    v_mov_b32 v43, 0
    v_mov_b32 v44, 0
    v_mov_b32 v45, 0
    v_mov_b32 v46, 0
    v_mov_b32 v47, 0
    v_mov_b32 v48, 0
    v_mov_b32 v49, 0
    v_mov_b32 v50, 0
    v_mov_b32 v51, 0
    v_mov_b32 v52, 0
    v_mov_b32 v53, 0
    v_mov_b32 v54, 0
    v_mov_b32 v55, 0
    v_mov_b32 v56, 0
    v_mov_b32 v57, 0
    v_mov_b32 v58, 0
    v_mov_b32 v59, 0
    v_mov_b32 v60, 0
    v_mov_b32 v61, 0
    v_mov_b32 v62, 0
    v_mov_b32 v63, 0
    v_mov_b32 v64, 0
    v_mov_b32 v65, 0
    v_mov_b32 v66, 0
    v_mov_b32 v67, 0
    v_mov_b32 v68, 0
    v_mov_b32 v69, 0
    v_mov_b32 v70, 0
    v_mov_b32 v71, 0
    v_mov_b32 v72, 0
    v_mov_b32 v73, 0
    v_mov_b32 v74, 0
    v_mov_b32 v75, 0
    v_mov_b32 v76, 0
    v_mov_b32 v77, 0
    v_mov_b32 v78, 0
    v_mov_b32 v79, 0
    v_mov_b32 v80, 0
    v_mov_b32 v81, 0
    v_mov_b32 v82, 0
    v_mov_b32 v83, 0
    v_mov_b32 v84, 0
    v_mov_b32 v85, 0
    v_mov_b32 v86, 0
    v_mov_b32 v87, 0
    v_mov_b32 v88, 0
    v_mov_b32 v89, 0
    v_mov_b32 v90, 0
    v_mov_b32 v91, 0
    v_mov_b32 v92, 0
    v_mov_b32 v93, 0
    v_mov_b32 v94, 0
    v_mov_b32 v95, 0
    v_mov_b32 v96, 0
    v_mov_b32 v97, 0
    v_mov_b32 v98, 0
    v_mov_b32 v99, 0
    v_mov_b32 v100, 0
    v_mov_b32 v101, 0
    v_mov_b32 v102, 0
    v_mov_b32 v103, 0
    v_mov_b32 v104, 0
    v_mov_b32 v105, 0
    v_mov_b32 v106, 0
    v_mov_b32 v107, 0
L_x_done:
    s_barrier
    s_mov_b32 s80, s6
    s_mov_b32 s81, s7
    s_mov_b32 s82, 0x0
    s_mov_b32 s83, 0x00020000
    s_add_u32 m0, s60, 0
    s_nop 0
    buffer_load_dwordx4 v1, s[20:23], s59 offen sc1 lds
    buffer_load_dwordx4 v1, s[20:23], s59 offen offset:1024 sc1 lds
    s_add_u32 m0, s60, 2048
    s_nop 0
    buffer_load_dwordx4 v2, s[20:23], s59 offen sc1 lds
    buffer_load_dwordx4 v2, s[20:23], s59 offen offset:1024 sc1 lds
    s_add_u32 s59, s59, 2048
    s_add_u32 m0, s60, 36864
    s_nop 0
    buffer_load_dwordx4 v1, s[20:23], s59 offen sc1 lds
    buffer_load_dwordx4 v1, s[20:23], s59 offen offset:1024 sc1 lds
    s_add_u32 m0, s60, 38912
    s_nop 0
    buffer_load_dwordx4 v2, s[20:23], s59 offen sc1 lds
    buffer_load_dwordx4 v2, s[20:23], s59 offen offset:1024 sc1 lds
    s_add_u32 s59, s59, 2048
    s_add_u32 m0, s60, 73728
    s_nop 0
    buffer_load_dwordx4 v1, s[20:23], s59 offen sc1 lds
    buffer_load_dwordx4 v1, s[20:23], s59 offen offset:1024 sc1 lds
    s_add_u32 m0, s60, 75776
    s_nop 0
    buffer_load_dwordx4 v2, s[20:23], s59 offen sc1 lds
    buffer_load_dwordx4 v2, s[20:23], s59 offen offset:1024 sc1 lds
    s_add_u32 s59, s59, 2048
    s_add_u32 m0, s60, 110592
    s_nop 0
    buffer_load_dwordx4 v1, s[20:23], s59 offen sc1 lds
    buffer_load_dwordx4 v1, s[20:23], s59 offen offset:1024 sc1 lds
    s_add_u32 m0, s60, 112640
    s_nop 0
    buffer_load_dwordx4 v2, s[20:23], s59 offen sc1 lds
    buffer_load_dwordx4 v2, s[20:23], s59 offen offset:1024 sc1 lds
    s_add_u32 s59, s59, 2048
    s_mov_b32 s82, 0x700000
    s_mov_b32 s86, 0x700000
    s_mov_b32 s90, 0x600000
    s_mov_b32 s92, 917504
    s_mov_b32 s93, 917504
    s_mov_b32 s94, 786432
    s_add_u32 s64, s10, 0x400000
    s_addc_u32 s65, s11, 0
    s_mov_b32 s66, 0xc00000
    s_mov_b32 s67, 0x00020000
    v_lshrrev_b32 v10, 4, v0
    v_and_b32 v11, 15, v0
    v_lshlrev_b32 v22, 9, v10
    v_lshl_add_u32 v22, v11, 4, v22
    s_lshl_b32 s17, s15, 13
    v_add_u32 v8, s17, v22
    v_add_u32 v9, 73728, v8
    v_lshrrev_b32 v24, 4, v0
    v_bfe_u32 v25, v0, 2, 2
    v_lshl_add_u32 v26, v24, 2, v25
    v_and_b32 v27, 3, v0
    v_lshlrev_b32 v27, 3, v27
    v_add_u32 v27, s18, v27
    v_and_b32 v28, 1, v24
    v_lshl_add_u32 v29, v26, 6, v27
    v_lshl_add_u32 v10, v28, 5, v29
    v_add_u32 v11, 73728, v10
    v_xor_b32 v12, 32, v10
    v_add_u32 v13, 73728, v12
    v_mov_b32 v24, 0
    v_mov_b32 v25, 0
    v_mov_b32 v26, 0
    v_mov_b32 v27, 0
    v_mov_b32 v28, 0
    v_mov_b32 v29, 0
    v_mov_b32 v30, 0
    s_waitcnt vmcnt(12)
    s_barrier
    ds_read_b64_tr_b16 a[88:89], v10 offset:0
    ds_read_b64_tr_b16 a[90:91], v10 offset:1024
    ds_read_b128 a[128:131], v8 offset:0
    ds_read_b128 a[132:135], v8 offset:256
    ds_read_b128 a[136:139], v8 offset:2048
    ds_read_b128 a[140:143], v8 offset:2304
    ds_read_b128 a[144:147], v8 offset:4096
    ds_read_b128 a[148:151], v8 offset:4352
    ds_read_b128 a[152:155], v8 offset:6144
    ds_read_b128 a[156:159], v8 offset:6400
    ds_read_b64_tr_b16 a[92:93], v12 offset:0
    ds_read_b64_tr_b16 a[94:95], v12 offset:1024
    ds_read_b64_tr_b16 a[96:97], v10 offset:2048
    ds_read_b64_tr_b16 a[98:99], v10 offset:3072
    ds_read_b64_tr_b16 a[100:101], v12 offset:2048
    ds_read_b64_tr_b16 a[102:103], v12 offset:3072
    ds_read_b64_tr_b16 a[104:105], v10 offset:4096
    ds_read_b64_tr_b16 a[106:107], v10 offset:5120
    ds_read_b64_tr_b16 a[108:109], v12 offset:4096
    ds_read_b64_tr_b16 a[110:111], v12 offset:5120
    ds_read_b64_tr_b16 a[112:113], v10 offset:6144
    ds_read_b64_tr_b16 a[114:115], v10 offset:7168
    ds_read_b64_tr_b16 a[116:117], v12 offset:6144
    ds_read_b64_tr_b16 a[118:119], v12 offset:7168
    ds_read_b64_tr_b16 a[120:121], v10 offset:8192
    ds_read_b64_tr_b16 a[122:123], v10 offset:9216
    ds_read_b64_tr_b16 a[124:125], v12 offset:8192
    ds_read_b64_tr_b16 a[126:127], v12 offset:9216
    s_mov_b32 s61, 3
L_g1_loop1:
    s_waitcnt lgkmcnt(0)
    v_mfma_f32_16x16x32_bf16 a[84:87], a[88:91], a[128:131], a[84:87]
    s_cmp_eq_u32 s61, 3
    s_cbranch_scc1 L_g1_ft1_0
L_g1_ft1_0r:
    v_mfma_f32_16x16x32_bf16 a[80:83], a[88:91], a[132:135], a[80:83]
    s_waitcnt vmcnt(24)
    s_barrier
    v_mfma_f32_16x16x32_bf16 a[76:79], a[88:91], a[136:139], a[76:79]
    ds_read_b64_tr_b16 a[160:161], v10 offset:36864
    v_mfma_f32_16x16x32_bf16 a[72:75], a[88:91], a[140:143], a[72:75]
    v_mfma_f32_16x16x32_bf16 a[68:71], a[88:91], a[144:147], a[68:71]
    ds_read_b64_tr_b16 a[162:163], v10 offset:37888
    v_mfma_f32_16x16x32_bf16 a[64:67], a[88:91], a[148:151], a[64:67]
    s_add_u32 m0, s54, 0
    v_mfma_f32_16x16x32_bf16 a[60:63], a[88:91], a[152:155], a[60:63]
    ds_read_b128 a[200:203], v8 offset:36864
    v_mfma_f32_16x16x32_bf16 a[56:59], a[88:91], a[156:159], a[56:59]
    v_mfma_f32_16x16x32_bf16 a[52:55], a[92:95], a[128:131], a[52:55]
    ds_read_b128 a[204:207], v8 offset:37120
    v_mfma_f32_16x16x32_bf16 a[48:51], a[92:95], a[132:135], a[48:51]
    buffer_load_dwordx4 v3, s[24:27], s44 offen lds
    s_add_u32 s44, s44, s49
    v_mfma_f32_16x16x32_bf16 a[44:47], a[92:95], a[136:139], a[44:47]
    ds_read_b128 a[208:211], v8 offset:38912
    v_mfma_f32_16x16x32_bf16 a[40:43], a[92:95], a[140:143], a[40:43]
    v_mfma_f32_16x16x32_bf16 a[36:39], a[92:95], a[144:147], a[36:39]
    ds_read_b128 a[212:215], v8 offset:39168
    v_mfma_f32_16x16x32_bf16 a[32:35], a[92:95], a[148:151], a[32:35]
    s_add_u32 m0, s55, 0
    v_mfma_f32_16x16x32_bf16 a[28:31], a[92:95], a[152:155], a[28:31]
    ds_read_b128 a[216:219], v8 offset:40960
    v_mfma_f32_16x16x32_bf16 a[24:27], a[92:95], a[156:159], a[24:27]
    v_mfma_f32_16x16x32_bf16 a[20:23], a[96:99], a[128:131], a[20:23]
    ds_read_b128 a[220:223], v8 offset:41216
    v_mfma_f32_16x16x32_bf16 a[16:19], a[96:99], a[132:135], a[16:19]
    buffer_load_dwordx4 v4, s[28:31], s45 offen lds
    s_add_u32 s45, s45, s50
    v_mfma_f32_16x16x32_bf16 a[12:15], a[96:99], a[136:139], a[12:15]
    ds_read_b128 a[224:227], v8 offset:43008
    v_mfma_f32_16x16x32_bf16 a[8:11], a[96:99], a[140:143], a[8:11]
    v_mfma_f32_16x16x32_bf16 a[4:7], a[96:99], a[144:147], a[4:7]
    ds_read_b128 a[228:231], v8 offset:43264
    v_mfma_f32_16x16x32_bf16 a[0:3], a[96:99], a[148:151], a[0:3]
    s_add_u32 m0, s56, 0
    v_mfma_f32_16x16x32_bf16 v[252:255], a[96:99], a[152:155], v[252:255]
    ds_read_b64_tr_b16 a[164:165], v12 offset:36864
    v_mfma_f32_16x16x32_bf16 v[248:251], a[96:99], a[156:159], v[248:251]
    v_mfma_f32_16x16x32_bf16 v[244:247], a[100:103], a[128:131], v[244:247]
    ds_read_b64_tr_b16 a[166:167], v12 offset:37888
    v_mfma_f32_16x16x32_bf16 v[240:243], a[100:103], a[132:135], v[240:243]
    buffer_load_dwordx4 v5, s[32:35], s46 offen lds
    s_add_u32 s46, s46, s51
    v_mfma_f32_16x16x32_bf16 v[236:239], a[100:103], a[136:139], v[236:239]
    ds_read_b64_tr_b16 a[168:169], v10 offset:38912
    v_mfma_f32_16x16x32_bf16 v[232:235], a[100:103], a[140:143], v[232:235]
    v_mfma_f32_16x16x32_bf16 v[228:231], a[100:103], a[144:147], v[228:231]
    ds_read_b64_tr_b16 a[170:171], v10 offset:39936
    v_mfma_f32_16x16x32_bf16 v[224:227], a[100:103], a[148:151], v[224:227]
    s_add_u32 m0, s57, 0
    v_mfma_f32_16x16x32_bf16 v[220:223], a[100:103], a[152:155], v[220:223]
    ds_read_b64_tr_b16 a[172:173], v12 offset:38912
    v_mfma_f32_16x16x32_bf16 v[216:219], a[100:103], a[156:159], v[216:219]
    v_mfma_f32_16x16x32_bf16 v[212:215], a[104:107], a[128:131], v[212:215]
    ds_read_b64_tr_b16 a[174:175], v12 offset:39936
    v_mfma_f32_16x16x32_bf16 v[208:211], a[104:107], a[132:135], v[208:211]
    buffer_load_dwordx4 v6, s[36:39], s47 offen lds
    s_add_u32 s47, s47, s52
    v_mfma_f32_16x16x32_bf16 v[204:207], a[104:107], a[136:139], v[204:207]
    ds_read_b64_tr_b16 a[176:177], v10 offset:40960
    v_mfma_f32_16x16x32_bf16 v[200:203], a[104:107], a[140:143], v[200:203]
    v_mfma_f32_16x16x32_bf16 v[196:199], a[104:107], a[144:147], v[196:199]
    ds_read_b64_tr_b16 a[178:179], v10 offset:41984
    v_mfma_f32_16x16x32_bf16 v[192:195], a[104:107], a[148:151], v[192:195]
    s_add_u32 m0, s58, 0
    v_mfma_f32_16x16x32_bf16 v[188:191], a[104:107], a[152:155], v[188:191]
    ds_read_b64_tr_b16 a[180:181], v12 offset:40960
    v_mfma_f32_16x16x32_bf16 v[184:187], a[104:107], a[156:159], v[184:187]
    v_mfma_f32_16x16x32_bf16 v[180:183], a[108:111], a[128:131], v[180:183]
    ds_read_b64_tr_b16 a[182:183], v12 offset:41984
    v_mfma_f32_16x16x32_bf16 v[176:179], a[108:111], a[132:135], v[176:179]
    buffer_load_dwordx4 v7, s[40:43], s48 offen lds
    s_add_u32 s48, s48, s53
    v_mfma_f32_16x16x32_bf16 v[172:175], a[108:111], a[136:139], v[172:175]
    ds_read_b64_tr_b16 a[184:185], v10 offset:43008
    v_mfma_f32_16x16x32_bf16 v[168:171], a[108:111], a[140:143], v[168:171]
    v_mfma_f32_16x16x32_bf16 v[164:167], a[108:111], a[144:147], v[164:167]
    ds_read_b64_tr_b16 a[186:187], v10 offset:44032
    v_mfma_f32_16x16x32_bf16 v[160:163], a[108:111], a[148:151], v[160:163]
    s_add_u32 m0, s60, 0
    v_mfma_f32_16x16x32_bf16 v[156:159], a[108:111], a[152:155], v[156:159]
    ds_read_b64_tr_b16 a[188:189], v12 offset:43008
    v_mfma_f32_16x16x32_bf16 v[152:155], a[108:111], a[156:159], v[152:155]
    v_mfma_f32_16x16x32_bf16 v[148:151], a[112:115], a[128:131], v[148:151]
    ds_read_b64_tr_b16 a[190:191], v12 offset:44032
    v_mfma_f32_16x16x32_bf16 v[144:147], a[112:115], a[132:135], v[144:147]
    buffer_load_dwordx4 v1, s[20:23], s59 offen sc1 lds
    v_mfma_f32_16x16x32_bf16 v[140:143], a[112:115], a[136:139], v[140:143]
    ds_read_b64_tr_b16 a[192:193], v10 offset:45056
    v_mfma_f32_16x16x32_bf16 v[136:139], a[112:115], a[140:143], v[136:139]
    v_mfma_f32_16x16x32_bf16 v[132:135], a[112:115], a[144:147], v[132:135]
    ds_read_b64_tr_b16 a[194:195], v10 offset:46080
    v_mfma_f32_16x16x32_bf16 v[128:131], a[112:115], a[148:151], v[128:131]
    buffer_load_dwordx4 v1, s[20:23], s59 offen offset:1024 sc1 lds
    v_mfma_f32_16x16x32_bf16 v[124:127], a[112:115], a[152:155], v[124:127]
    ds_read_b64_tr_b16 a[196:197], v12 offset:45056
    v_mfma_f32_16x16x32_bf16 v[120:123], a[112:115], a[156:159], v[120:123]
    v_mfma_f32_16x16x32_bf16 v[116:119], a[116:119], a[128:131], v[116:119]
    ds_read_b64_tr_b16 a[198:199], v12 offset:46080
    v_mfma_f32_16x16x32_bf16 v[112:115], a[116:119], a[132:135], v[112:115]
    s_add_u32 m0, s60, 2048
    v_mfma_f32_16x16x32_bf16 v[108:111], a[116:119], a[136:139], v[108:111]
    v_mfma_f32_16x16x32_bf16 v[104:107], a[116:119], a[140:143], v[104:107]
    v_mfma_f32_16x16x32_bf16 v[100:103], a[116:119], a[144:147], v[100:103]
    v_mfma_f32_16x16x32_bf16 v[96:99], a[116:119], a[148:151], v[96:99]
    buffer_load_dwordx4 v2, s[20:23], s59 offen sc1 lds
    v_mfma_f32_16x16x32_bf16 v[92:95], a[116:119], a[152:155], v[92:95]
    v_mfma_f32_16x16x32_bf16 v[88:91], a[116:119], a[156:159], v[88:91]
    v_mfma_f32_16x16x32_bf16 v[84:87], a[120:123], a[128:131], v[84:87]
    v_mfma_f32_16x16x32_bf16 v[80:83], a[120:123], a[132:135], v[80:83]
    buffer_load_dwordx4 v2, s[20:23], s59 offen offset:1024 sc1 lds
    s_add_u32 s59, s59, 2048
    v_mfma_f32_16x16x32_bf16 v[76:79], a[120:123], a[136:139], v[76:79]
    v_mfma_f32_16x16x32_bf16 v[72:75], a[120:123], a[140:143], v[72:75]
    v_mfma_f32_16x16x32_bf16 v[68:71], a[120:123], a[144:147], v[68:71]
    v_mfma_f32_16x16x32_bf16 v[64:67], a[120:123], a[148:151], v[64:67]
    buffer_load_dwordx4 a[232:235], v23, s[80:83], s92 offen
    s_add_u32 s92, s92, 0x100000
    v_mfma_f32_16x16x32_bf16 v[60:63], a[120:123], a[152:155], v[60:63]
    v_mfma_f32_16x16x32_bf16 v[56:59], a[120:123], a[156:159], v[56:59]
    v_mfma_f32_16x16x32_bf16 v[52:55], a[124:127], a[128:131], v[52:55]
    v_mfma_f32_16x16x32_bf16 v[48:51], a[124:127], a[132:135], v[48:51]
    buffer_load_dwordx4 a[232:235], v23, s[84:87], s93 offen
    s_add_u32 s93, s93, 0x100000
    v_mfma_f32_16x16x32_bf16 v[44:47], a[124:127], a[136:139], v[44:47]
    v_mfma_f32_16x16x32_bf16 v[40:43], a[124:127], a[140:143], v[40:43]
    v_mfma_f32_16x16x32_bf16 v[36:39], a[124:127], a[144:147], v[36:39]
    v_mfma_f32_16x16x32_bf16 v[32:35], a[124:127], a[148:151], v[32:35]
    v_mfma_f32_16x16x32_bf16 v[28:31], a[124:127], a[152:155], v[28:31]
    v_mfma_f32_16x16x32_bf16 v[24:27], a[124:127], a[156:159], v[24:27]
    s_waitcnt lgkmcnt(0)
    v_mfma_f32_16x16x32_bf16 a[84:87], a[160:163], a[200:203], a[84:87]
    s_cmp_eq_u32 s61, 3
    s_cbranch_scc1 L_g1_ft1_1
L_g1_ft1_1r:
    v_mfma_f32_16x16x32_bf16 a[80:83], a[160:163], a[204:207], a[80:83]
    s_waitcnt vmcnt(24)
    s_barrier
    v_mfma_f32_16x16x32_bf16 a[76:79], a[160:163], a[208:211], a[76:79]
    ds_read_b64_tr_b16 a[88:89], v11 offset:0
    v_mfma_f32_16x16x32_bf16 a[72:75], a[160:163], a[212:215], a[72:75]
    v_mfma_f32_16x16x32_bf16 a[68:71], a[160:163], a[216:219], a[68:71]
    ds_read_b64_tr_b16 a[90:91], v11 offset:1024
    v_mfma_f32_16x16x32_bf16 a[64:67], a[160:163], a[220:223], a[64:67]
    s_add_u32 m0, s54, 36864
    v_mfma_f32_16x16x32_bf16 a[60:63], a[160:163], a[224:227], a[60:63]
    ds_read_b128 a[128:131], v9 offset:0
    v_mfma_f32_16x16x32_bf16 a[56:59], a[160:163], a[228:231], a[56:59]
    v_mfma_f32_16x16x32_bf16 a[52:55], a[164:167], a[200:203], a[52:55]
    ds_read_b128 a[132:135], v9 offset:256
    v_mfma_f32_16x16x32_bf16 a[48:51], a[164:167], a[204:207], a[48:51]
    buffer_load_dwordx4 v3, s[24:27], s44 offen lds
    s_add_u32 s44, s44, s49
    v_mfma_f32_16x16x32_bf16 a[44:47], a[164:167], a[208:211], a[44:47]
    ds_read_b128 a[136:139], v9 offset:2048
    v_mfma_f32_16x16x32_bf16 a[40:43], a[164:167], a[212:215], a[40:43]
    v_mfma_f32_16x16x32_bf16 a[36:39], a[164:167], a[216:219], a[36:39]
    ds_read_b128 a[140:143], v9 offset:2304
    v_mfma_f32_16x16x32_bf16 a[32:35], a[164:167], a[220:223], a[32:35]
    s_add_u32 m0, s55, 36864
    v_mfma_f32_16x16x32_bf16 a[28:31], a[164:167], a[224:227], a[28:31]
    ds_read_b128 a[144:147], v9 offset:4096
    v_mfma_f32_16x16x32_bf16 a[24:27], a[164:167], a[228:231], a[24:27]
    v_mfma_f32_16x16x32_bf16 a[20:23], a[168:171], a[200:203], a[20:23]
    ds_read_b128 a[148:151], v9 offset:4352
    v_mfma_f32_16x16x32_bf16 a[16:19], a[168:171], a[204:207], a[16:19]
    buffer_load_dwordx4 v4, s[28:31], s45 offen lds
    s_add_u32 s45, s45, s50
    v_mfma_f32_16x16x32_bf16 a[12:15], a[168:171], a[208:211], a[12:15]
    ds_read_b128 a[152:155], v9 offset:6144
    v_mfma_f32_16x16x32_bf16 a[8:11], a[168:171], a[212:215], a[8:11]
    v_mfma_f32_16x16x32_bf16 a[4:7], a[168:171], a[216:219], a[4:7]
    ds_read_b128 a[156:159], v9 offset:6400
    v_mfma_f32_16x16x32_bf16 a[0:3], a[168:171], a[220:223], a[0:3]
    s_add_u32 m0, s56, 36864
    v_mfma_f32_16x16x32_bf16 v[252:255], a[168:171], a[224:227], v[252:255]
    ds_read_b64_tr_b16 a[92:93], v13 offset:0
    v_mfma_f32_16x16x32_bf16 v[248:251], a[168:171], a[228:231], v[248:251]
    v_mfma_f32_16x16x32_bf16 v[244:247], a[172:175], a[200:203], v[244:247]
    ds_read_b64_tr_b16 a[94:95], v13 offset:1024
    v_mfma_f32_16x16x32_bf16 v[240:243], a[172:175], a[204:207], v[240:243]
    buffer_load_dwordx4 v5, s[32:35], s46 offen lds
    s_add_u32 s46, s46, s51
    v_mfma_f32_16x16x32_bf16 v[236:239], a[172:175], a[208:211], v[236:239]
    ds_read_b64_tr_b16 a[96:97], v11 offset:2048
    v_mfma_f32_16x16x32_bf16 v[232:235], a[172:175], a[212:215], v[232:235]
    v_mfma_f32_16x16x32_bf16 v[228:231], a[172:175], a[216:219], v[228:231]
    ds_read_b64_tr_b16 a[98:99], v11 offset:3072
    v_mfma_f32_16x16x32_bf16 v[224:227], a[172:175], a[220:223], v[224:227]
    s_add_u32 m0, s57, 36864
    v_mfma_f32_16x16x32_bf16 v[220:223], a[172:175], a[224:227], v[220:223]
    ds_read_b64_tr_b16 a[100:101], v13 offset:2048
    v_mfma_f32_16x16x32_bf16 v[216:219], a[172:175], a[228:231], v[216:219]
    v_mfma_f32_16x16x32_bf16 v[212:215], a[176:179], a[200:203], v[212:215]
    ds_read_b64_tr_b16 a[102:103], v13 offset:3072
    v_mfma_f32_16x16x32_bf16 v[208:211], a[176:179], a[204:207], v[208:211]
    buffer_load_dwordx4 v6, s[36:39], s47 offen lds
    s_add_u32 s47, s47, s52
    v_mfma_f32_16x16x32_bf16 v[204:207], a[176:179], a[208:211], v[204:207]
    ds_read_b64_tr_b16 a[104:105], v11 offset:4096
    v_mfma_f32_16x16x32_bf16 v[200:203], a[176:179], a[212:215], v[200:203]
    v_mfma_f32_16x16x32_bf16 v[196:199], a[176:179], a[216:219], v[196:199]
    ds_read_b64_tr_b16 a[106:107], v11 offset:5120
    v_mfma_f32_16x16x32_bf16 v[192:195], a[176:179], a[220:223], v[192:195]
    s_add_u32 m0, s58, 36864
    v_mfma_f32_16x16x32_bf16 v[188:191], a[176:179], a[224:227], v[188:191]
    ds_read_b64_tr_b16 a[108:109], v13 offset:4096
    v_mfma_f32_16x16x32_bf16 v[184:187], a[176:179], a[228:231], v[184:187]
    v_mfma_f32_16x16x32_bf16 v[180:183], a[180:183], a[200:203], v[180:183]
    ds_read_b64_tr_b16 a[110:111], v13 offset:5120
    v_mfma_f32_16x16x32_bf16 v[176:179], a[180:183], a[204:207], v[176:179]
    buffer_load_dwordx4 v7, s[40:43], s48 offen lds
    s_add_u32 s48, s48, s53
    v_mfma_f32_16x16x32_bf16 v[172:175], a[180:183], a[208:211], v[172:175]
    ds_read_b64_tr_b16 a[112:113], v11 offset:6144
    v_mfma_f32_16x16x32_bf16 v[168:171], a[180:183], a[212:215], v[168:171]
    v_mfma_f32_16x16x32_bf16 v[164:167], a[180:183], a[216:219], v[164:167]
    ds_read_b64_tr_b16 a[114:115], v11 offset:7168
    v_mfma_f32_16x16x32_bf16 v[160:163], a[180:183], a[220:223], v[160:163]
    s_add_u32 m0, s60, 36864
    v_mfma_f32_16x16x32_bf16 v[156:159], a[180:183], a[224:227], v[156:159]
    ds_read_b64_tr_b16 a[116:117], v13 offset:6144
    v_mfma_f32_16x16x32_bf16 v[152:155], a[180:183], a[228:231], v[152:155]
    v_mfma_f32_16x16x32_bf16 v[148:151], a[184:187], a[200:203], v[148:151]
    ds_read_b64_tr_b16 a[118:119], v13 offset:7168
    v_mfma_f32_16x16x32_bf16 v[144:147], a[184:187], a[204:207], v[144:147]
    buffer_load_dwordx4 v1, s[20:23], s59 offen sc1 lds
    v_mfma_f32_16x16x32_bf16 v[140:143], a[184:187], a[208:211], v[140:143]
    ds_read_b64_tr_b16 a[120:121], v11 offset:8192
    v_mfma_f32_16x16x32_bf16 v[136:139], a[184:187], a[212:215], v[136:139]
    v_mfma_f32_16x16x32_bf16 v[132:135], a[184:187], a[216:219], v[132:135]
    ds_read_b64_tr_b16 a[122:123], v11 offset:9216
    v_mfma_f32_16x16x32_bf16 v[128:131], a[184:187], a[220:223], v[128:131]
    buffer_load_dwordx4 v1, s[20:23], s59 offen offset:1024 sc1 lds
    v_mfma_f32_16x16x32_bf16 v[124:127], a[184:187], a[224:227], v[124:127]
    ds_read_b64_tr_b16 a[124:125], v13 offset:8192
    v_mfma_f32_16x16x32_bf16 v[120:123], a[184:187], a[228:231], v[120:123]
    v_mfma_f32_16x16x32_bf16 v[116:119], a[188:191], a[200:203], v[116:119]
    ds_read_b64_tr_b16 a[126:127], v13 offset:9216
    v_mfma_f32_16x16x32_bf16 v[112:115], a[188:191], a[204:207], v[112:115]
    s_add_u32 m0, s60, 38912
    v_mfma_f32_16x16x32_bf16 v[108:111], a[188:191], a[208:211], v[108:111]
    v_mfma_f32_16x16x32_bf16 v[104:107], a[188:191], a[212:215], v[104:107]
    v_mfma_f32_16x16x32_bf16 v[100:103], a[188:191], a[216:219], v[100:103]
    v_mfma_f32_16x16x32_bf16 v[96:99], a[188:191], a[220:223], v[96:99]
    buffer_load_dwordx4 v2, s[20:23], s59 offen sc1 lds
    v_mfma_f32_16x16x32_bf16 v[92:95], a[188:191], a[224:227], v[92:95]
    v_mfma_f32_16x16x32_bf16 v[88:91], a[188:191], a[228:231], v[88:91]
    v_mfma_f32_16x16x32_bf16 v[84:87], a[192:195], a[200:203], v[84:87]
    v_mfma_f32_16x16x32_bf16 v[80:83], a[192:195], a[204:207], v[80:83]
    buffer_load_dwordx4 v2, s[20:23], s59 offen offset:1024 sc1 lds
    s_add_u32 s59, s59, 2048
    v_mfma_f32_16x16x32_bf16 v[76:79], a[192:195], a[208:211], v[76:79]
    v_mfma_f32_16x16x32_bf16 v[72:75], a[192:195], a[212:215], v[72:75]
    v_mfma_f32_16x16x32_bf16 v[68:71], a[192:195], a[216:219], v[68:71]
    v_mfma_f32_16x16x32_bf16 v[64:67], a[192:195], a[220:223], v[64:67]
    buffer_load_dwordx4 a[232:235], v23, s[88:91], s94 offen
    s_add_u32 s94, s94, 0x100000
    v_mfma_f32_16x16x32_bf16 v[60:63], a[192:195], a[224:227], v[60:63]
    v_mfma_f32_16x16x32_bf16 v[56:59], a[192:195], a[228:231], v[56:59]
    v_mfma_f32_16x16x32_bf16 v[52:55], a[196:199], a[200:203], v[52:55]
    v_mfma_f32_16x16x32_bf16 v[48:51], a[196:199], a[204:207], v[48:51]
    buffer_load_dwordx4 a[232:235], v23, s[80:83], s92 offen
    s_add_u32 s92, s92, 0x100000
    v_mfma_f32_16x16x32_bf16 v[44:47], a[196:199], a[208:211], v[44:47]
    v_mfma_f32_16x16x32_bf16 v[40:43], a[196:199], a[212:215], v[40:43]
    v_mfma_f32_16x16x32_bf16 v[36:39], a[196:199], a[216:219], v[36:39]
    v_mfma_f32_16x16x32_bf16 v[32:35], a[196:199], a[220:223], v[32:35]
    v_mfma_f32_16x16x32_bf16 v[28:31], a[196:199], a[224:227], v[28:31]
    v_mfma_f32_16x16x32_bf16 v[24:27], a[196:199], a[228:231], v[24:27]
    s_waitcnt lgkmcnt(0)
    v_mfma_f32_16x16x32_bf16 a[84:87], a[88:91], a[128:131], a[84:87]
    s_cmp_eq_u32 s61, 3
    s_cbranch_scc1 L_g1_ft1_2
L_g1_ft1_2r:
    v_mfma_f32_16x16x32_bf16 a[80:83], a[88:91], a[132:135], a[80:83]
    s_waitcnt vmcnt(24)
    s_barrier
    v_mfma_f32_16x16x32_bf16 a[76:79], a[88:91], a[136:139], a[76:79]
    ds_read_b64_tr_b16 a[160:161], v11 offset:36864
    v_mfma_f32_16x16x32_bf16 a[72:75], a[88:91], a[140:143], a[72:75]
    v_mfma_f32_16x16x32_bf16 a[68:71], a[88:91], a[144:147], a[68:71]
    ds_read_b64_tr_b16 a[162:163], v11 offset:37888
    v_mfma_f32_16x16x32_bf16 a[64:67], a[88:91], a[148:151], a[64:67]
    s_add_u32 m0, s54, 73728
    v_mfma_f32_16x16x32_bf16 a[60:63], a[88:91], a[152:155], a[60:63]
    ds_read_b128 a[200:203], v9 offset:36864
    v_mfma_f32_16x16x32_bf16 a[56:59], a[88:91], a[156:159], a[56:59]
    v_mfma_f32_16x16x32_bf16 a[52:55], a[92:95], a[128:131], a[52:55]
    ds_read_b128 a[204:207], v9 offset:37120
    v_mfma_f32_16x16x32_bf16 a[48:51], a[92:95], a[132:135], a[48:51]
    buffer_load_dwordx4 v3, s[24:27], s44 offen lds
    s_add_u32 s44, s44, s49
    v_mfma_f32_16x16x32_bf16 a[44:47], a[92:95], a[136:139], a[44:47]
    ds_read_b128 a[208:211], v9 offset:38912
    v_mfma_f32_16x16x32_bf16 a[40:43], a[92:95], a[140:143], a[40:43]
    v_mfma_f32_16x16x32_bf16 a[36:39], a[92:95], a[144:147], a[36:39]
    ds_read_b128 a[212:215], v9 offset:39168
    v_mfma_f32_16x16x32_bf16 a[32:35], a[92:95], a[148:151], a[32:35]
    s_add_u32 m0, s55, 73728
    v_mfma_f32_16x16x32_bf16 a[28:31], a[92:95], a[152:155], a[28:31]
    ds_read_b128 a[216:219], v9 offset:40960
    v_mfma_f32_16x16x32_bf16 a[24:27], a[92:95], a[156:159], a[24:27]
    v_mfma_f32_16x16x32_bf16 a[20:23], a[96:99], a[128:131], a[20:23]
    ds_read_b128 a[220:223], v9 offset:41216
    v_mfma_f32_16x16x32_bf16 a[16:19], a[96:99], a[132:135], a[16:19]
    buffer_load_dwordx4 v4, s[28:31], s45 offen lds
    s_add_u32 s45, s45, s50
    v_mfma_f32_16x16x32_bf16 a[12:15], a[96:99], a[136:139], a[12:15]
    ds_read_b128 a[224:227], v9 offset:43008
    v_mfma_f32_16x16x32_bf16 a[8:11], a[96:99], a[140:143], a[8:11]
    v_mfma_f32_16x16x32_bf16 a[4:7], a[96:99], a[144:147], a[4:7]
    ds_read_b128 a[228:231], v9 offset:43264
    v_mfma_f32_16x16x32_bf16 a[0:3], a[96:99], a[148:151], a[0:3]
    s_add_u32 m0, s56, 73728
    v_mfma_f32_16x16x32_bf16 v[252:255], a[96:99], a[152:155], v[252:255]
    ds_read_b64_tr_b16 a[164:165], v13 offset:36864
    v_mfma_f32_16x16x32_bf16 v[248:251], a[96:99], a[156:159], v[248:251]
    v_mfma_f32_16x16x32_bf16 v[244:247], a[100:103], a[128:131], v[244:247]
    ds_read_b64_tr_b16 a[166:167], v13 offset:37888
    v_mfma_f32_16x16x32_bf16 v[240:243], a[100:103], a[132:135], v[240:243]
    buffer_load_dwordx4 v5, s[32:35], s46 offen lds
    s_add_u32 s46, s46, s51
    v_mfma_f32_16x16x32_bf16 v[236:239], a[100:103], a[136:139], v[236:239]
    ds_read_b64_tr_b16 a[168:169], v11 offset:38912
    v_mfma_f32_16x16x32_bf16 v[232:235], a[100:103], a[140:143], v[232:235]
    v_mfma_f32_16x16x32_bf16 v[228:231], a[100:103], a[144:147], v[228:231]
    ds_read_b64_tr_b16 a[170:171], v11 offset:39936
    v_mfma_f32_16x16x32_bf16 v[224:227], a[100:103], a[148:151], v[224:227]
    s_add_u32 m0, s57, 73728
    v_mfma_f32_16x16x32_bf16 v[220:223], a[100:103], a[152:155], v[220:223]
    ds_read_b64_tr_b16 a[172:173], v13 offset:38912
    v_mfma_f32_16x16x32_bf16 v[216:219], a[100:103], a[156:159], v[216:219]
    v_mfma_f32_16x16x32_bf16 v[212:215], a[104:107], a[128:131], v[212:215]
    ds_read_b64_tr_b16 a[174:175], v13 offset:39936
    v_mfma_f32_16x16x32_bf16 v[208:211], a[104:107], a[132:135], v[208:211]
    buffer_load_dwordx4 v6, s[36:39], s47 offen lds
    s_add_u32 s47, s47, s52
    v_mfma_f32_16x16x32_bf16 v[204:207], a[104:107], a[136:139], v[204:207]
    ds_read_b64_tr_b16 a[176:177], v11 offset:40960
    v_mfma_f32_16x16x32_bf16 v[200:203], a[104:107], a[140:143], v[200:203]
    v_mfma_f32_16x16x32_bf16 v[196:199], a[104:107], a[144:147], v[196:199]
    ds_read_b64_tr_b16 a[178:179], v11 offset:41984
    v_mfma_f32_16x16x32_bf16 v[192:195], a[104:107], a[148:151], v[192:195]
    s_add_u32 m0, s58, 73728
    v_mfma_f32_16x16x32_bf16 v[188:191], a[104:107], a[152:155], v[188:191]
    ds_read_b64_tr_b16 a[180:181], v13 offset:40960
    v_mfma_f32_16x16x32_bf16 v[184:187], a[104:107], a[156:159], v[184:187]
    v_mfma_f32_16x16x32_bf16 v[180:183], a[108:111], a[128:131], v[180:183]
    ds_read_b64_tr_b16 a[182:183], v13 offset:41984
    v_mfma_f32_16x16x32_bf16 v[176:179], a[108:111], a[132:135], v[176:179]
    buffer_load_dwordx4 v7, s[40:43], s48 offen lds
    s_add_u32 s48, s48, s53
    v_mfma_f32_16x16x32_bf16 v[172:175], a[108:111], a[136:139], v[172:175]
    ds_read_b64_tr_b16 a[184:185], v11 offset:43008
    v_mfma_f32_16x16x32_bf16 v[168:171], a[108:111], a[140:143], v[168:171]
    v_mfma_f32_16x16x32_bf16 v[164:167], a[108:111], a[144:147], v[164:167]
    ds_read_b64_tr_b16 a[186:187], v11 offset:44032
    v_mfma_f32_16x16x32_bf16 v[160:163], a[108:111], a[148:151], v[160:163]
    s_add_u32 m0, s60, 73728
    v_mfma_f32_16x16x32_bf16 v[156:159], a[108:111], a[152:155], v[156:159]
    ds_read_b64_tr_b16 a[188:189], v13 offset:43008
    v_mfma_f32_16x16x32_bf16 v[152:155], a[108:111], a[156:159], v[152:155]
    v_mfma_f32_16x16x32_bf16 v[148:151], a[112:115], a[128:131], v[148:151]
    ds_read_b64_tr_b16 a[190:191], v13 offset:44032
    v_mfma_f32_16x16x32_bf16 v[144:147], a[112:115], a[132:135], v[144:147]
    buffer_load_dwordx4 v1, s[20:23], s59 offen sc1 lds
    v_mfma_f32_16x16x32_bf16 v[140:143], a[112:115], a[136:139], v[140:143]
    ds_read_b64_tr_b16 a[192:193], v11 offset:45056
    v_mfma_f32_16x16x32_bf16 v[136:139], a[112:115], a[140:143], v[136:139]
    v_mfma_f32_16x16x32_bf16 v[132:135], a[112:115], a[144:147], v[132:135]
    ds_read_b64_tr_b16 a[194:195], v11 offset:46080
    v_mfma_f32_16x16x32_bf16 v[128:131], a[112:115], a[148:151], v[128:131]
    buffer_load_dwordx4 v1, s[20:23], s59 offen offset:1024 sc1 lds
    v_mfma_f32_16x16x32_bf16 v[124:127], a[112:115], a[152:155], v[124:127]
    ds_read_b64_tr_b16 a[196:197], v13 offset:45056
    v_mfma_f32_16x16x32_bf16 v[120:123], a[112:115], a[156:159], v[120:123]
    v_mfma_f32_16x16x32_bf16 v[116:119], a[116:119], a[128:131], v[116:119]
    ds_read_b64_tr_b16 a[198:199], v13 offset:46080
    v_mfma_f32_16x16x32_bf16 v[112:115], a[116:119], a[132:135], v[112:115]
    s_add_u32 m0, s60, 75776
    v_mfma_f32_16x16x32_bf16 v[108:111], a[116:119], a[136:139], v[108:111]
    v_mfma_f32_16x16x32_bf16 v[104:107], a[116:119], a[140:143], v[104:107]
    v_mfma_f32_16x16x32_bf16 v[100:103], a[116:119], a[144:147], v[100:103]
    v_mfma_f32_16x16x32_bf16 v[96:99], a[116:119], a[148:151], v[96:99]
    buffer_load_dwordx4 v2, s[20:23], s59 offen sc1 lds
    v_mfma_f32_16x16x32_bf16 v[92:95], a[116:119], a[152:155], v[92:95]
    v_mfma_f32_16x16x32_bf16 v[88:91], a[116:119], a[156:159], v[88:91]
    v_mfma_f32_16x16x32_bf16 v[84:87], a[120:123], a[128:131], v[84:87]
    v_mfma_f32_16x16x32_bf16 v[80:83], a[120:123], a[132:135], v[80:83]
    buffer_load_dwordx4 v2, s[20:23], s59 offen offset:1024 sc1 lds
    s_add_u32 s59, s59, 2048
    v_mfma_f32_16x16x32_bf16 v[76:79], a[120:123], a[136:139], v[76:79]
    v_mfma_f32_16x16x32_bf16 v[72:75], a[120:123], a[140:143], v[72:75]
    v_mfma_f32_16x16x32_bf16 v[68:71], a[120:123], a[144:147], v[68:71]
    v_mfma_f32_16x16x32_bf16 v[64:67], a[120:123], a[148:151], v[64:67]
    buffer_load_dwordx4 a[232:235], v23, s[84:87], s93 offen
    s_add_u32 s93, s93, 0x100000
    v_mfma_f32_16x16x32_bf16 v[60:63], a[120:123], a[152:155], v[60:63]
    v_mfma_f32_16x16x32_bf16 v[56:59], a[120:123], a[156:159], v[56:59]
    v_mfma_f32_16x16x32_bf16 v[52:55], a[124:127], a[128:131], v[52:55]
    v_mfma_f32_16x16x32_bf16 v[48:51], a[124:127], a[132:135], v[48:51]
    buffer_load_dwordx4 a[232:235], v23, s[88:91], s94 offen
    s_add_u32 s94, s94, 0x100000
    v_mfma_f32_16x16x32_bf16 v[44:47], a[124:127], a[136:139], v[44:47]
    v_mfma_f32_16x16x32_bf16 v[40:43], a[124:127], a[140:143], v[40:43]
    v_mfma_f32_16x16x32_bf16 v[36:39], a[124:127], a[144:147], v[36:39]
    v_mfma_f32_16x16x32_bf16 v[32:35], a[124:127], a[148:151], v[32:35]
    v_mfma_f32_16x16x32_bf16 v[28:31], a[124:127], a[152:155], v[28:31]
    v_mfma_f32_16x16x32_bf16 v[24:27], a[124:127], a[156:159], v[24:27]
    s_waitcnt lgkmcnt(0)
    v_mfma_f32_16x16x32_bf16 a[84:87], a[160:163], a[200:203], a[84:87]
    v_mfma_f32_16x16x32_bf16 a[80:83], a[160:163], a[204:207], a[80:83]
    s_waitcnt vmcnt(24)
    s_barrier
    v_mfma_f32_16x16x32_bf16 a[76:79], a[160:163], a[208:211], a[76:79]
    ds_read_b64_tr_b16 a[88:89], v10 offset:0
    v_mfma_f32_16x16x32_bf16 a[72:75], a[160:163], a[212:215], a[72:75]
    v_mfma_f32_16x16x32_bf16 a[68:71], a[160:163], a[216:219], a[68:71]
    ds_read_b64_tr_b16 a[90:91], v10 offset:1024
    v_mfma_f32_16x16x32_bf16 a[64:67], a[160:163], a[220:223], a[64:67]
    s_add_u32 m0, s54, 110592
    v_mfma_f32_16x16x32_bf16 a[60:63], a[160:163], a[224:227], a[60:63]
    ds_read_b128 a[128:131], v8 offset:0
    v_mfma_f32_16x16x32_bf16 a[56:59], a[160:163], a[228:231], a[56:59]
    v_mfma_f32_16x16x32_bf16 a[52:55], a[164:167], a[200:203], a[52:55]
    ds_read_b128 a[132:135], v8 offset:256
    v_mfma_f32_16x16x32_bf16 a[48:51], a[164:167], a[204:207], a[48:51]
    buffer_load_dwordx4 v3, s[24:27], s44 offen lds
    s_add_u32 s44, s44, s49
    v_mfma_f32_16x16x32_bf16 a[44:47], a[164:167], a[208:211], a[44:47]
    ds_read_b128 a[136:139], v8 offset:2048
    v_mfma_f32_16x16x32_bf16 a[40:43], a[164:167], a[212:215], a[40:43]
    v_mfma_f32_16x16x32_bf16 a[36:39], a[164:167], a[216:219], a[36:39]
    ds_read_b128 a[140:143], v8 offset:2304
    v_mfma_f32_16x16x32_bf16 a[32:35], a[164:167], a[220:223], a[32:35]
    s_add_u32 m0, s55, 110592
    v_mfma_f32_16x16x32_bf16 a[28:31], a[164:167], a[224:227], a[28:31]
    ds_read_b128 a[144:147], v8 offset:4096
    v_mfma_f32_16x16x32_bf16 a[24:27], a[164:167], a[228:231], a[24:27]
    v_mfma_f32_16x16x32_bf16 a[20:23], a[168:171], a[200:203], a[20:23]
    ds_read_b128 a[148:151], v8 offset:4352
    v_mfma_f32_16x16x32_bf16 a[16:19], a[168:171], a[204:207], a[16:19]
    buffer_load_dwordx4 v4, s[28:31], s45 offen lds
    s_add_u32 s45, s45, s50
    v_mfma_f32_16x16x32_bf16 a[12:15], a[168:171], a[208:211], a[12:15]
    ds_read_b128 a[152:155], v8 offset:6144
    v_mfma_f32_16x16x32_bf16 a[8:11], a[168:171], a[212:215], a[8:11]
    v_mfma_f32_16x16x32_bf16 a[4:7], a[168:171], a[216:219], a[4:7]
    ds_read_b128 a[156:159], v8 offset:6400
    v_mfma_f32_16x16x32_bf16 a[0:3], a[168:171], a[220:223], a[0:3]
    s_add_u32 m0, s56, 110592
    v_mfma_f32_16x16x32_bf16 v[252:255], a[168:171], a[224:227], v[252:255]
    ds_read_b64_tr_b16 a[92:93], v12 offset:0
    v_mfma_f32_16x16x32_bf16 v[248:251], a[168:171], a[228:231], v[248:251]
    v_mfma_f32_16x16x32_bf16 v[244:247], a[172:175], a[200:203], v[244:247]
    ds_read_b64_tr_b16 a[94:95], v12 offset:1024
    v_mfma_f32_16x16x32_bf16 v[240:243], a[172:175], a[204:207], v[240:243]
    buffer_load_dwordx4 v5, s[32:35], s46 offen lds
    s_add_u32 s46, s46, s51
    v_mfma_f32_16x16x32_bf16 v[236:239], a[172:175], a[208:211], v[236:239]
    ds_read_b64_tr_b16 a[96:97], v10 offset:2048
    v_mfma_f32_16x16x32_bf16 v[232:235], a[172:175], a[212:215], v[232:235]
    v_mfma_f32_16x16x32_bf16 v[228:231], a[172:175], a[216:219], v[228:231]
    ds_read_b64_tr_b16 a[98:99], v10 offset:3072
    v_mfma_f32_16x16x32_bf16 v[224:227], a[172:175], a[220:223], v[224:227]
    s_add_u32 m0, s57, 110592
    v_mfma_f32_16x16x32_bf16 v[220:223], a[172:175], a[224:227], v[220:223]
    ds_read_b64_tr_b16 a[100:101], v12 offset:2048
    v_mfma_f32_16x16x32_bf16 v[216:219], a[172:175], a[228:231], v[216:219]
    v_mfma_f32_16x16x32_bf16 v[212:215], a[176:179], a[200:203], v[212:215]
    ds_read_b64_tr_b16 a[102:103], v12 offset:3072
    v_mfma_f32_16x16x32_bf16 v[208:211], a[176:179], a[204:207], v[208:211]
    buffer_load_dwordx4 v6, s[36:39], s47 offen lds
    s_add_u32 s47, s47, s52
    v_mfma_f32_16x16x32_bf16 v[204:207], a[176:179], a[208:211], v[204:207]
    ds_read_b64_tr_b16 a[104:105], v10 offset:4096
    v_mfma_f32_16x16x32_bf16 v[200:203], a[176:179], a[212:215], v[200:203]
    v_mfma_f32_16x16x32_bf16 v[196:199], a[176:179], a[216:219], v[196:199]
    ds_read_b64_tr_b16 a[106:107], v10 offset:5120
    v_mfma_f32_16x16x32_bf16 v[192:195], a[176:179], a[220:223], v[192:195]
    s_add_u32 m0, s58, 110592
    v_mfma_f32_16x16x32_bf16 v[188:191], a[176:179], a[224:227], v[188:191]
    ds_read_b64_tr_b16 a[108:109], v12 offset:4096
    v_mfma_f32_16x16x32_bf16 v[184:187], a[176:179], a[228:231], v[184:187]
    v_mfma_f32_16x16x32_bf16 v[180:183], a[180:183], a[200:203], v[180:183]
    ds_read_b64_tr_b16 a[110:111], v12 offset:5120
    v_mfma_f32_16x16x32_bf16 v[176:179], a[180:183], a[204:207], v[176:179]
    buffer_load_dwordx4 v7, s[40:43], s48 offen lds
    s_add_u32 s48, s48, s53
    v_mfma_f32_16x16x32_bf16 v[172:175], a[180:183], a[208:211], v[172:175]
    ds_read_b64_tr_b16 a[112:113], v10 offset:6144
    v_mfma_f32_16x16x32_bf16 v[168:171], a[180:183], a[212:215], v[168:171]
    v_mfma_f32_16x16x32_bf16 v[164:167], a[180:183], a[216:219], v[164:167]
    ds_read_b64_tr_b16 a[114:115], v10 offset:7168
    v_mfma_f32_16x16x32_bf16 v[160:163], a[180:183], a[220:223], v[160:163]
    s_add_u32 m0, s60, 110592
    v_mfma_f32_16x16x32_bf16 v[156:159], a[180:183], a[224:227], v[156:159]
    ds_read_b64_tr_b16 a[116:117], v12 offset:6144
    v_mfma_f32_16x16x32_bf16 v[152:155], a[180:183], a[228:231], v[152:155]
    v_mfma_f32_16x16x32_bf16 v[148:151], a[184:187], a[200:203], v[148:151]
    ds_read_b64_tr_b16 a[118:119], v12 offset:7168
    v_mfma_f32_16x16x32_bf16 v[144:147], a[184:187], a[204:207], v[144:147]
    buffer_load_dwordx4 v1, s[20:23], s59 offen sc1 lds
    v_mfma_f32_16x16x32_bf16 v[140:143], a[184:187], a[208:211], v[140:143]
    ds_read_b64_tr_b16 a[120:121], v10 offset:8192
    v_mfma_f32_16x16x32_bf16 v[136:139], a[184:187], a[212:215], v[136:139]
    v_mfma_f32_16x16x32_bf16 v[132:135], a[184:187], a[216:219], v[132:135]
    ds_read_b64_tr_b16 a[122:123], v10 offset:9216
    v_mfma_f32_16x16x32_bf16 v[128:131], a[184:187], a[220:223], v[128:131]
    buffer_load_dwordx4 v1, s[20:23], s59 offen offset:1024 sc1 lds
    v_mfma_f32_16x16x32_bf16 v[124:127], a[184:187], a[224:227], v[124:127]
    ds_read_b64_tr_b16 a[124:125], v12 offset:8192
    v_mfma_f32_16x16x32_bf16 v[120:123], a[184:187], a[228:231], v[120:123]
    v_mfma_f32_16x16x32_bf16 v[116:119], a[188:191], a[200:203], v[116:119]
    ds_read_b64_tr_b16 a[126:127], v12 offset:9216
    v_mfma_f32_16x16x32_bf16 v[112:115], a[188:191], a[204:207], v[112:115]
    s_add_u32 m0, s60, 112640
    v_mfma_f32_16x16x32_bf16 v[108:111], a[188:191], a[208:211], v[108:111]
    v_mfma_f32_16x16x32_bf16 v[104:107], a[188:191], a[212:215], v[104:107]
    v_mfma_f32_16x16x32_bf16 v[100:103], a[188:191], a[216:219], v[100:103]
    v_mfma_f32_16x16x32_bf16 v[96:99], a[188:191], a[220:223], v[96:99]
    buffer_load_dwordx4 v2, s[20:23], s59 offen sc1 lds
    v_mfma_f32_16x16x32_bf16 v[92:95], a[188:191], a[224:227], v[92:95]
    v_mfma_f32_16x16x32_bf16 v[88:91], a[188:191], a[228:231], v[88:91]
    v_mfma_f32_16x16x32_bf16 v[84:87], a[192:195], a[200:203], v[84:87]
    v_mfma_f32_16x16x32_bf16 v[80:83], a[192:195], a[204:207], v[80:83]
    buffer_load_dwordx4 v2, s[20:23], s59 offen offset:1024 sc1 lds
    s_add_u32 s59, s59, 2048
    v_mfma_f32_16x16x32_bf16 v[76:79], a[192:195], a[208:211], v[76:79]
    v_mfma_f32_16x16x32_bf16 v[72:75], a[192:195], a[212:215], v[72:75]
    v_mfma_f32_16x16x32_bf16 v[68:71], a[192:195], a[216:219], v[68:71]
    v_mfma_f32_16x16x32_bf16 v[64:67], a[192:195], a[220:223], v[64:67]
    buffer_load_dwordx4 a[232:235], v23, s[80:83], s92 offen
    s_add_u32 s92, s92, 0x100000
    v_mfma_f32_16x16x32_bf16 v[60:63], a[192:195], a[224:227], v[60:63]
    v_mfma_f32_16x16x32_bf16 v[56:59], a[192:195], a[228:231], v[56:59]
    v_mfma_f32_16x16x32_bf16 v[52:55], a[196:199], a[200:203], v[52:55]
    v_mfma_f32_16x16x32_bf16 v[48:51], a[196:199], a[204:207], v[48:51]
    buffer_load_dwordx4 a[232:235], v23, s[84:87], s93 offen
    s_add_u32 s93, s93, 0x100000
    v_mfma_f32_16x16x32_bf16 v[44:47], a[196:199], a[208:211], v[44:47]
    v_mfma_f32_16x16x32_bf16 v[40:43], a[196:199], a[212:215], v[40:43]
    v_mfma_f32_16x16x32_bf16 v[36:39], a[196:199], a[216:219], v[36:39]
    v_mfma_f32_16x16x32_bf16 v[32:35], a[196:199], a[220:223], v[32:35]
    v_mfma_f32_16x16x32_bf16 v[28:31], a[196:199], a[224:227], v[28:31]
    v_mfma_f32_16x16x32_bf16 v[24:27], a[196:199], a[228:231], v[24:27]
    s_sub_u32 s61, s61, 1
    s_cmp_lg_u32 s61, 0
    s_cbranch_scc1 L_g1_loop1
    s_mov_b32 s61, 4
    s_mov_b32 s80, s70
    s_mov_b32 s81, s71
    s_mov_b32 s82, 0x100
    s_mov_b32 s83, 0x00020000
    v_and_b32 v23, 7, v0
    v_lshlrev_b32 v23, 5, v23
    s_mov_b32 s88, 0
    buffer_load_dword a237, v23, s[80:83], s88 offen sc1
L_g1_loopn1:
    s_waitcnt lgkmcnt(0)
    v_mfma_f32_16x16x32_bf16 a[84:87], a[88:91], a[128:131], a[84:87]
    v_mfma_f32_16x16x32_bf16 a[80:83], a[88:91], a[132:135], a[80:83]
    s_waitcnt vmcnt(18)
    s_barrier
    v_mfma_f32_16x16x32_bf16 a[76:79], a[88:91], a[136:139], a[76:79]
    ds_read_b64_tr_b16 a[160:161], v10 offset:36864
    v_mfma_f32_16x16x32_bf16 a[72:75], a[88:91], a[140:143], a[72:75]
    v_mfma_f32_16x16x32_bf16 a[68:71], a[88:91], a[144:147], a[68:71]
    ds_read_b64_tr_b16 a[162:163], v10 offset:37888
    v_mfma_f32_16x16x32_bf16 a[64:67], a[88:91], a[148:151], a[64:67]
    s_add_u32 m0, s54, 0
    v_mfma_f32_16x16x32_bf16 a[60:63], a[88:91], a[152:155], a[60:63]
    ds_read_b128 a[200:203], v8 offset:36864
    v_mfma_f32_16x16x32_bf16 a[56:59], a[88:91], a[156:159], a[56:59]
    v_mfma_f32_16x16x32_bf16 a[52:55], a[92:95], a[128:131], a[52:55]
    ds_read_b128 a[204:207], v8 offset:37120
    v_mfma_f32_16x16x32_bf16 a[48:51], a[92:95], a[132:135], a[48:51]
    buffer_load_dwordx4 v3, s[24:27], s44 offen lds
    s_add_u32 s44, s44, s49
    v_mfma_f32_16x16x32_bf16 a[44:47], a[92:95], a[136:139], a[44:47]
    ds_read_b128 a[208:211], v8 offset:38912
    v_mfma_f32_16x16x32_bf16 a[40:43], a[92:95], a[140:143], a[40:43]
    v_mfma_f32_16x16x32_bf16 a[36:39], a[92:95], a[144:147], a[36:39]
    ds_read_b128 a[212:215], v8 offset:39168
    v_mfma_f32_16x16x32_bf16 a[32:35], a[92:95], a[148:151], a[32:35]
    s_add_u32 m0, s55, 0
    v_mfma_f32_16x16x32_bf16 a[28:31], a[92:95], a[152:155], a[28:31]
    ds_read_b128 a[216:219], v8 offset:40960
    v_mfma_f32_16x16x32_bf16 a[24:27], a[92:95], a[156:159], a[24:27]
    v_mfma_f32_16x16x32_bf16 a[20:23], a[96:99], a[128:131], a[20:23]
    ds_read_b128 a[220:223], v8 offset:41216
    v_mfma_f32_16x16x32_bf16 a[16:19], a[96:99], a[132:135], a[16:19]
    buffer_load_dwordx4 v4, s[28:31], s45 offen lds
    s_add_u32 s45, s45, s50
    v_mfma_f32_16x16x32_bf16 a[12:15], a[96:99], a[136:139], a[12:15]
    ds_read_b128 a[224:227], v8 offset:43008
    v_mfma_f32_16x16x32_bf16 a[8:11], a[96:99], a[140:143], a[8:11]
    v_mfma_f32_16x16x32_bf16 a[4:7], a[96:99], a[144:147], a[4:7]
    ds_read_b128 a[228:231], v8 offset:43264
    v_mfma_f32_16x16x32_bf16 a[0:3], a[96:99], a[148:151], a[0:3]
    s_add_u32 m0, s56, 0
    v_mfma_f32_16x16x32_bf16 v[252:255], a[96:99], a[152:155], v[252:255]
    ds_read_b64_tr_b16 a[164:165], v12 offset:36864
    v_mfma_f32_16x16x32_bf16 v[248:251], a[96:99], a[156:159], v[248:251]
    v_mfma_f32_16x16x32_bf16 v[244:247], a[100:103], a[128:131], v[244:247]
    ds_read_b64_tr_b16 a[166:167], v12 offset:37888
    v_mfma_f32_16x16x32_bf16 v[240:243], a[100:103], a[132:135], v[240:243]
    buffer_load_dwordx4 v5, s[32:35], s46 offen lds
    s_add_u32 s46, s46, s51
    v_mfma_f32_16x16x32_bf16 v[236:239], a[100:103], a[136:139], v[236:239]
    ds_read_b64_tr_b16 a[168:169], v10 offset:38912
    v_mfma_f32_16x16x32_bf16 v[232:235], a[100:103], a[140:143], v[232:235]
    v_mfma_f32_16x16x32_bf16 v[228:231], a[100:103], a[144:147], v[228:231]
    ds_read_b64_tr_b16 a[170:171], v10 offset:39936
    v_mfma_f32_16x16x32_bf16 v[224:227], a[100:103], a[148:151], v[224:227]
    s_add_u32 m0, s57, 0
    v_mfma_f32_16x16x32_bf16 v[220:223], a[100:103], a[152:155], v[220:223]
    ds_read_b64_tr_b16 a[172:173], v12 offset:38912
    v_mfma_f32_16x16x32_bf16 v[216:219], a[100:103], a[156:159], v[216:219]
    v_mfma_f32_16x16x32_bf16 v[212:215], a[104:107], a[128:131], v[212:215]
    ds_read_b64_tr_b16 a[174:175], v12 offset:39936
    v_mfma_f32_16x16x32_bf16 v[208:211], a[104:107], a[132:135], v[208:211]
    buffer_load_dwordx4 v6, s[36:39], s47 offen lds
    s_add_u32 s47, s47, s52
    v_mfma_f32_16x16x32_bf16 v[204:207], a[104:107], a[136:139], v[204:207]
    ds_read_b64_tr_b16 a[176:177], v10 offset:40960
    v_mfma_f32_16x16x32_bf16 v[200:203], a[104:107], a[140:143], v[200:203]
    v_mfma_f32_16x16x32_bf16 v[196:199], a[104:107], a[144:147], v[196:199]
    ds_read_b64_tr_b16 a[178:179], v10 offset:41984
    v_mfma_f32_16x16x32_bf16 v[192:195], a[104:107], a[148:151], v[192:195]
    s_add_u32 m0, s58, 0
    v_mfma_f32_16x16x32_bf16 v[188:191], a[104:107], a[152:155], v[188:191]
    ds_read_b64_tr_b16 a[180:181], v12 offset:40960
    v_mfma_f32_16x16x32_bf16 v[184:187], a[104:107], a[156:159], v[184:187]
    v_mfma_f32_16x16x32_bf16 v[180:183], a[108:111], a[128:131], v[180:183]
    ds_read_b64_tr_b16 a[182:183], v12 offset:41984
    v_mfma_f32_16x16x32_bf16 v[176:179], a[108:111], a[132:135], v[176:179]
    buffer_load_dwordx4 v7, s[40:43], s48 offen lds
    s_add_u32 s48, s48, s53
    v_mfma_f32_16x16x32_bf16 v[172:175], a[108:111], a[136:139], v[172:175]
    ds_read_b64_tr_b16 a[184:185], v10 offset:43008
    v_mfma_f32_16x16x32_bf16 v[168:171], a[108:111], a[140:143], v[168:171]
    v_mfma_f32_16x16x32_bf16 v[164:167], a[108:111], a[144:147], v[164:167]
    ds_read_b64_tr_b16 a[186:187], v10 offset:44032
    v_mfma_f32_16x16x32_bf16 v[160:163], a[108:111], a[148:151], v[160:163]
    s_add_u32 m0, s60, 0
    v_mfma_f32_16x16x32_bf16 v[156:159], a[108:111], a[152:155], v[156:159]
    ds_read_b64_tr_b16 a[188:189], v12 offset:43008
    v_mfma_f32_16x16x32_bf16 v[152:155], a[108:111], a[156:159], v[152:155]
    v_mfma_f32_16x16x32_bf16 v[148:151], a[112:115], a[128:131], v[148:151]
    ds_read_b64_tr_b16 a[190:191], v12 offset:44032
    v_mfma_f32_16x16x32_bf16 v[144:147], a[112:115], a[132:135], v[144:147]
    buffer_load_dwordx4 v1, s[20:23], s59 offen sc1 lds
    v_mfma_f32_16x16x32_bf16 v[140:143], a[112:115], a[136:139], v[140:143]
    ds_read_b64_tr_b16 a[192:193], v10 offset:45056
    v_mfma_f32_16x16x32_bf16 v[136:139], a[112:115], a[140:143], v[136:139]
    v_mfma_f32_16x16x32_bf16 v[132:135], a[112:115], a[144:147], v[132:135]
    ds_read_b64_tr_b16 a[194:195], v10 offset:46080
    v_mfma_f32_16x16x32_bf16 v[128:131], a[112:115], a[148:151], v[128:131]
    buffer_load_dwordx4 v1, s[20:23], s59 offen offset:1024 sc1 lds
    v_mfma_f32_16x16x32_bf16 v[124:127], a[112:115], a[152:155], v[124:127]
    ds_read_b64_tr_b16 a[196:197], v12 offset:45056
    v_mfma_f32_16x16x32_bf16 v[120:123], a[112:115], a[156:159], v[120:123]
    v_mfma_f32_16x16x32_bf16 v[116:119], a[116:119], a[128:131], v[116:119]
    ds_read_b64_tr_b16 a[198:199], v12 offset:46080
    v_mfma_f32_16x16x32_bf16 v[112:115], a[116:119], a[132:135], v[112:115]
    s_add_u32 m0, s60, 2048
    v_mfma_f32_16x16x32_bf16 v[108:111], a[116:119], a[136:139], v[108:111]
    v_mfma_f32_16x16x32_bf16 v[104:107], a[116:119], a[140:143], v[104:107]
    v_mfma_f32_16x16x32_bf16 v[100:103], a[116:119], a[144:147], v[100:103]
    v_mfma_f32_16x16x32_bf16 v[96:99], a[116:119], a[148:151], v[96:99]
    buffer_load_dwordx4 v2, s[20:23], s59 offen sc1 lds
    v_mfma_f32_16x16x32_bf16 v[92:95], a[116:119], a[152:155], v[92:95]
    v_mfma_f32_16x16x32_bf16 v[88:91], a[116:119], a[156:159], v[88:91]
    v_mfma_f32_16x16x32_bf16 v[84:87], a[120:123], a[128:131], v[84:87]
    v_mfma_f32_16x16x32_bf16 v[80:83], a[120:123], a[132:135], v[80:83]
    buffer_load_dwordx4 v2, s[20:23], s59 offen offset:1024 sc1 lds
    s_add_u32 s59, s59, 2048
    v_mfma_f32_16x16x32_bf16 v[76:79], a[120:123], a[136:139], v[76:79]
    v_mfma_f32_16x16x32_bf16 v[72:75], a[120:123], a[140:143], v[72:75]
    v_mfma_f32_16x16x32_bf16 v[68:71], a[120:123], a[144:147], v[68:71]
    v_mfma_f32_16x16x32_bf16 v[64:67], a[120:123], a[148:151], v[64:67]
    v_mfma_f32_16x16x32_bf16 v[60:63], a[120:123], a[152:155], v[60:63]
    v_mfma_f32_16x16x32_bf16 v[56:59], a[120:123], a[156:159], v[56:59]
    v_mfma_f32_16x16x32_bf16 v[52:55], a[124:127], a[128:131], v[52:55]
    v_mfma_f32_16x16x32_bf16 v[48:51], a[124:127], a[132:135], v[48:51]
    v_mfma_f32_16x16x32_bf16 v[44:47], a[124:127], a[136:139], v[44:47]
    v_mfma_f32_16x16x32_bf16 v[40:43], a[124:127], a[140:143], v[40:43]
    v_mfma_f32_16x16x32_bf16 v[36:39], a[124:127], a[144:147], v[36:39]
    v_mfma_f32_16x16x32_bf16 v[32:35], a[124:127], a[148:151], v[32:35]
    v_mfma_f32_16x16x32_bf16 v[28:31], a[124:127], a[152:155], v[28:31]
    v_mfma_f32_16x16x32_bf16 v[24:27], a[124:127], a[156:159], v[24:27]
    s_waitcnt lgkmcnt(0)
    v_mfma_f32_16x16x32_bf16 a[84:87], a[160:163], a[200:203], a[84:87]
    v_mfma_f32_16x16x32_bf16 a[80:83], a[160:163], a[204:207], a[80:83]
    s_waitcnt vmcnt(18)
    s_barrier
    v_mfma_f32_16x16x32_bf16 a[76:79], a[160:163], a[208:211], a[76:79]
    ds_read_b64_tr_b16 a[88:89], v11 offset:0
    v_mfma_f32_16x16x32_bf16 a[72:75], a[160:163], a[212:215], a[72:75]
    v_mfma_f32_16x16x32_bf16 a[68:71], a[160:163], a[216:219], a[68:71]
    ds_read_b64_tr_b16 a[90:91], v11 offset:1024
    v_mfma_f32_16x16x32_bf16 a[64:67], a[160:163], a[220:223], a[64:67]
    s_add_u32 m0, s54, 36864
    v_mfma_f32_16x16x32_bf16 a[60:63], a[160:163], a[224:227], a[60:63]
    ds_read_b128 a[128:131], v9 offset:0
    v_mfma_f32_16x16x32_bf16 a[56:59], a[160:163], a[228:231], a[56:59]
    v_mfma_f32_16x16x32_bf16 a[52:55], a[164:167], a[200:203], a[52:55]
    ds_read_b128 a[132:135], v9 offset:256
    v_mfma_f32_16x16x32_bf16 a[48:51], a[164:167], a[204:207], a[48:51]
    buffer_load_dwordx4 v3, s[24:27], s44 offen lds
    s_add_u32 s44, s44, s49
    v_mfma_f32_16x16x32_bf16 a[44:47], a[164:167], a[208:211], a[44:47]
    ds_read_b128 a[136:139], v9 offset:2048
    v_mfma_f32_16x16x32_bf16 a[40:43], a[164:167], a[212:215], a[40:43]
    v_mfma_f32_16x16x32_bf16 a[36:39], a[164:167], a[216:219], a[36:39]
    ds_read_b128 a[140:143], v9 offset:2304
    v_mfma_f32_16x16x32_bf16 a[32:35], a[164:167], a[220:223], a[32:35]
    s_add_u32 m0, s55, 36864
    v_mfma_f32_16x16x32_bf16 a[28:31], a[164:167], a[224:227], a[28:31]
    ds_read_b128 a[144:147], v9 offset:4096
    v_mfma_f32_16x16x32_bf16 a[24:27], a[164:167], a[228:231], a[24:27]
    v_mfma_f32_16x16x32_bf16 a[20:23], a[168:171], a[200:203], a[20:23]
    ds_read_b128 a[148:151], v9 offset:4352
    v_mfma_f32_16x16x32_bf16 a[16:19], a[168:171], a[204:207], a[16:19]
    buffer_load_dwordx4 v4, s[28:31], s45 offen lds
    s_add_u32 s45, s45, s50
    v_mfma_f32_16x16x32_bf16 a[12:15], a[168:171], a[208:211], a[12:15]
    ds_read_b128 a[152:155], v9 offset:6144
    v_mfma_f32_16x16x32_bf16 a[8:11], a[168:171], a[212:215], a[8:11]
    v_mfma_f32_16x16x32_bf16 a[4:7], a[168:171], a[216:219], a[4:7]
    ds_read_b128 a[156:159], v9 offset:6400
    v_mfma_f32_16x16x32_bf16 a[0:3], a[168:171], a[220:223], a[0:3]
    s_add_u32 m0, s56, 36864
    v_mfma_f32_16x16x32_bf16 v[252:255], a[168:171], a[224:227], v[252:255]
    ds_read_b64_tr_b16 a[92:93], v13 offset:0
    v_mfma_f32_16x16x32_bf16 v[248:251], a[168:171], a[228:231], v[248:251]
    v_mfma_f32_16x16x32_bf16 v[244:247], a[172:175], a[200:203], v[244:247]
    ds_read_b64_tr_b16 a[94:95], v13 offset:1024
    v_mfma_f32_16x16x32_bf16 v[240:243], a[172:175], a[204:207], v[240:243]
    buffer_load_dwordx4 v5, s[32:35], s46 offen lds
    s_add_u32 s46, s46, s51
    v_mfma_f32_16x16x32_bf16 v[236:239], a[172:175], a[208:211], v[236:239]
    ds_read_b64_tr_b16 a[96:97], v11 offset:2048
    v_mfma_f32_16x16x32_bf16 v[232:235], a[172:175], a[212:215], v[232:235]
    v_mfma_f32_16x16x32_bf16 v[228:231], a[172:175], a[216:219], v[228:231]
    ds_read_b64_tr_b16 a[98:99], v11 offset:3072
    v_mfma_f32_16x16x32_bf16 v[224:227], a[172:175], a[220:223], v[224:227]
    s_add_u32 m0, s57, 36864
    v_mfma_f32_16x16x32_bf16 v[220:223], a[172:175], a[224:227], v[220:223]
    ds_read_b64_tr_b16 a[100:101], v13 offset:2048
    v_mfma_f32_16x16x32_bf16 v[216:219], a[172:175], a[228:231], v[216:219]
    v_mfma_f32_16x16x32_bf16 v[212:215], a[176:179], a[200:203], v[212:215]
    ds_read_b64_tr_b16 a[102:103], v13 offset:3072
    v_mfma_f32_16x16x32_bf16 v[208:211], a[176:179], a[204:207], v[208:211]
    buffer_load_dwordx4 v6, s[36:39], s47 offen lds
    s_add_u32 s47, s47, s52
    v_mfma_f32_16x16x32_bf16 v[204:207], a[176:179], a[208:211], v[204:207]
    ds_read_b64_tr_b16 a[104:105], v11 offset:4096
    v_mfma_f32_16x16x32_bf16 v[200:203], a[176:179], a[212:215], v[200:203]
    v_mfma_f32_16x16x32_bf16 v[196:199], a[176:179], a[216:219], v[196:199]
    ds_read_b64_tr_b16 a[106:107], v11 offset:5120
    v_mfma_f32_16x16x32_bf16 v[192:195], a[176:179], a[220:223], v[192:195]
    s_add_u32 m0, s58, 36864
    v_mfma_f32_16x16x32_bf16 v[188:191], a[176:179], a[224:227], v[188:191]
    ds_read_b64_tr_b16 a[108:109], v13 offset:4096
    v_mfma_f32_16x16x32_bf16 v[184:187], a[176:179], a[228:231], v[184:187]
    v_mfma_f32_16x16x32_bf16 v[180:183], a[180:183], a[200:203], v[180:183]
    ds_read_b64_tr_b16 a[110:111], v13 offset:5120
    v_mfma_f32_16x16x32_bf16 v[176:179], a[180:183], a[204:207], v[176:179]
    buffer_load_dwordx4 v7, s[40:43], s48 offen lds
    s_add_u32 s48, s48, s53
    v_mfma_f32_16x16x32_bf16 v[172:175], a[180:183], a[208:211], v[172:175]
    ds_read_b64_tr_b16 a[112:113], v11 offset:6144
    v_mfma_f32_16x16x32_bf16 v[168:171], a[180:183], a[212:215], v[168:171]
    v_mfma_f32_16x16x32_bf16 v[164:167], a[180:183], a[216:219], v[164:167]
    ds_read_b64_tr_b16 a[114:115], v11 offset:7168
    v_mfma_f32_16x16x32_bf16 v[160:163], a[180:183], a[220:223], v[160:163]
    s_add_u32 m0, s60, 36864
    v_mfma_f32_16x16x32_bf16 v[156:159], a[180:183], a[224:227], v[156:159]
    ds_read_b64_tr_b16 a[116:117], v13 offset:6144
    v_mfma_f32_16x16x32_bf16 v[152:155], a[180:183], a[228:231], v[152:155]
    v_mfma_f32_16x16x32_bf16 v[148:151], a[184:187], a[200:203], v[148:151]
    ds_read_b64_tr_b16 a[118:119], v13 offset:7168
    v_mfma_f32_16x16x32_bf16 v[144:147], a[184:187], a[204:207], v[144:147]
    buffer_load_dwordx4 v1, s[20:23], s59 offen sc1 lds
    v_mfma_f32_16x16x32_bf16 v[140:143], a[184:187], a[208:211], v[140:143]
    ds_read_b64_tr_b16 a[120:121], v11 offset:8192
    v_mfma_f32_16x16x32_bf16 v[136:139], a[184:187], a[212:215], v[136:139]
    v_mfma_f32_16x16x32_bf16 v[132:135], a[184:187], a[216:219], v[132:135]
    ds_read_b64_tr_b16 a[122:123], v11 offset:9216
    v_mfma_f32_16x16x32_bf16 v[128:131], a[184:187], a[220:223], v[128:131]
    buffer_load_dwordx4 v1, s[20:23], s59 offen offset:1024 sc1 lds
    v_mfma_f32_16x16x32_bf16 v[124:127], a[184:187], a[224:227], v[124:127]
    ds_read_b64_tr_b16 a[124:125], v13 offset:8192
    v_mfma_f32_16x16x32_bf16 v[120:123], a[184:187], a[228:231], v[120:123]
    v_mfma_f32_16x16x32_bf16 v[116:119], a[188:191], a[200:203], v[116:119]
    ds_read_b64_tr_b16 a[126:127], v13 offset:9216
    v_mfma_f32_16x16x32_bf16 v[112:115], a[188:191], a[204:207], v[112:115]
    s_add_u32 m0, s60, 38912
    v_mfma_f32_16x16x32_bf16 v[108:111], a[188:191], a[208:211], v[108:111]
    v_mfma_f32_16x16x32_bf16 v[104:107], a[188:191], a[212:215], v[104:107]
    v_mfma_f32_16x16x32_bf16 v[100:103], a[188:191], a[216:219], v[100:103]
    v_mfma_f32_16x16x32_bf16 v[96:99], a[188:191], a[220:223], v[96:99]
    buffer_load_dwordx4 v2, s[20:23], s59 offen sc1 lds
    v_mfma_f32_16x16x32_bf16 v[92:95], a[188:191], a[224:227], v[92:95]
    v_mfma_f32_16x16x32_bf16 v[88:91], a[188:191], a[228:231], v[88:91]
    v_mfma_f32_16x16x32_bf16 v[84:87], a[192:195], a[200:203], v[84:87]
    v_mfma_f32_16x16x32_bf16 v[80:83], a[192:195], a[204:207], v[80:83]
    buffer_load_dwordx4 v2, s[20:23], s59 offen offset:1024 sc1 lds
    s_add_u32 s59, s59, 2048
    v_mfma_f32_16x16x32_bf16 v[76:79], a[192:195], a[208:211], v[76:79]
    v_mfma_f32_16x16x32_bf16 v[72:75], a[192:195], a[212:215], v[72:75]
    v_mfma_f32_16x16x32_bf16 v[68:71], a[192:195], a[216:219], v[68:71]
    v_mfma_f32_16x16x32_bf16 v[64:67], a[192:195], a[220:223], v[64:67]
    v_mfma_f32_16x16x32_bf16 v[60:63], a[192:195], a[224:227], v[60:63]
    v_mfma_f32_16x16x32_bf16 v[56:59], a[192:195], a[228:231], v[56:59]
    v_mfma_f32_16x16x32_bf16 v[52:55], a[196:199], a[200:203], v[52:55]
    v_mfma_f32_16x16x32_bf16 v[48:51], a[196:199], a[204:207], v[48:51]
    v_mfma_f32_16x16x32_bf16 v[44:47], a[196:199], a[208:211], v[44:47]
    v_mfma_f32_16x16x32_bf16 v[40:43], a[196:199], a[212:215], v[40:43]
    v_mfma_f32_16x16x32_bf16 v[36:39], a[196:199], a[216:219], v[36:39]
    v_mfma_f32_16x16x32_bf16 v[32:35], a[196:199], a[220:223], v[32:35]
    v_mfma_f32_16x16x32_bf16 v[28:31], a[196:199], a[224:227], v[28:31]
    v_mfma_f32_16x16x32_bf16 v[24:27], a[196:199], a[228:231], v[24:27]
    s_waitcnt lgkmcnt(0)
    v_mfma_f32_16x16x32_bf16 a[84:87], a[88:91], a[128:131], a[84:87]
    v_mfma_f32_16x16x32_bf16 a[80:83], a[88:91], a[132:135], a[80:83]
    s_waitcnt vmcnt(18)
    s_barrier
    v_mfma_f32_16x16x32_bf16 a[76:79], a[88:91], a[136:139], a[76:79]
    ds_read_b64_tr_b16 a[160:161], v11 offset:36864
    v_mfma_f32_16x16x32_bf16 a[72:75], a[88:91], a[140:143], a[72:75]
    v_mfma_f32_16x16x32_bf16 a[68:71], a[88:91], a[144:147], a[68:71]
    ds_read_b64_tr_b16 a[162:163], v11 offset:37888
    v_mfma_f32_16x16x32_bf16 a[64:67], a[88:91], a[148:151], a[64:67]
    s_add_u32 m0, s54, 73728
    v_mfma_f32_16x16x32_bf16 a[60:63], a[88:91], a[152:155], a[60:63]
    ds_read_b128 a[200:203], v9 offset:36864
    v_mfma_f32_16x16x32_bf16 a[56:59], a[88:91], a[156:159], a[56:59]
    v_mfma_f32_16x16x32_bf16 a[52:55], a[92:95], a[128:131], a[52:55]
    ds_read_b128 a[204:207], v9 offset:37120
    v_mfma_f32_16x16x32_bf16 a[48:51], a[92:95], a[132:135], a[48:51]
    buffer_load_dwordx4 v3, s[24:27], s44 offen lds
    s_add_u32 s44, s44, s49
    v_mfma_f32_16x16x32_bf16 a[44:47], a[92:95], a[136:139], a[44:47]
    ds_read_b128 a[208:211], v9 offset:38912
    v_mfma_f32_16x16x32_bf16 a[40:43], a[92:95], a[140:143], a[40:43]
    v_mfma_f32_16x16x32_bf16 a[36:39], a[92:95], a[144:147], a[36:39]
    ds_read_b128 a[212:215], v9 offset:39168
    v_mfma_f32_16x16x32_bf16 a[32:35], a[92:95], a[148:151], a[32:35]
    s_add_u32 m0, s55, 73728
    v_mfma_f32_16x16x32_bf16 a[28:31], a[92:95], a[152:155], a[28:31]
    ds_read_b128 a[216:219], v9 offset:40960
    v_mfma_f32_16x16x32_bf16 a[24:27], a[92:95], a[156:159], a[24:27]
    v_mfma_f32_16x16x32_bf16 a[20:23], a[96:99], a[128:131], a[20:23]
    ds_read_b128 a[220:223], v9 offset:41216
    v_mfma_f32_16x16x32_bf16 a[16:19], a[96:99], a[132:135], a[16:19]
    buffer_load_dwordx4 v4, s[28:31], s45 offen lds
    s_add_u32 s45, s45, s50
    v_mfma_f32_16x16x32_bf16 a[12:15], a[96:99], a[136:139], a[12:15]
    ds_read_b128 a[224:227], v9 offset:43008
    v_mfma_f32_16x16x32_bf16 a[8:11], a[96:99], a[140:143], a[8:11]
    v_mfma_f32_16x16x32_bf16 a[4:7], a[96:99], a[144:147], a[4:7]
    ds_read_b128 a[228:231], v9 offset:43264
    v_mfma_f32_16x16x32_bf16 a[0:3], a[96:99], a[148:151], a[0:3]
    s_add_u32 m0, s56, 73728
    v_mfma_f32_16x16x32_bf16 v[252:255], a[96:99], a[152:155], v[252:255]
    ds_read_b64_tr_b16 a[164:165], v13 offset:36864
    v_mfma_f32_16x16x32_bf16 v[248:251], a[96:99], a[156:159], v[248:251]
    v_mfma_f32_16x16x32_bf16 v[244:247], a[100:103], a[128:131], v[244:247]
    ds_read_b64_tr_b16 a[166:167], v13 offset:37888
    v_mfma_f32_16x16x32_bf16 v[240:243], a[100:103], a[132:135], v[240:243]
    buffer_load_dwordx4 v5, s[32:35], s46 offen lds
    s_add_u32 s46, s46, s51
    v_mfma_f32_16x16x32_bf16 v[236:239], a[100:103], a[136:139], v[236:239]
    ds_read_b64_tr_b16 a[168:169], v11 offset:38912
    v_mfma_f32_16x16x32_bf16 v[232:235], a[100:103], a[140:143], v[232:235]
    v_mfma_f32_16x16x32_bf16 v[228:231], a[100:103], a[144:147], v[228:231]
    ds_read_b64_tr_b16 a[170:171], v11 offset:39936
    v_mfma_f32_16x16x32_bf16 v[224:227], a[100:103], a[148:151], v[224:227]
    s_add_u32 m0, s57, 73728
    v_mfma_f32_16x16x32_bf16 v[220:223], a[100:103], a[152:155], v[220:223]
    ds_read_b64_tr_b16 a[172:173], v13 offset:38912
    v_mfma_f32_16x16x32_bf16 v[216:219], a[100:103], a[156:159], v[216:219]
    v_mfma_f32_16x16x32_bf16 v[212:215], a[104:107], a[128:131], v[212:215]
    ds_read_b64_tr_b16 a[174:175], v13 offset:39936
    v_mfma_f32_16x16x32_bf16 v[208:211], a[104:107], a[132:135], v[208:211]
    buffer_load_dwordx4 v6, s[36:39], s47 offen lds
    s_add_u32 s47, s47, s52
    v_mfma_f32_16x16x32_bf16 v[204:207], a[104:107], a[136:139], v[204:207]
    ds_read_b64_tr_b16 a[176:177], v11 offset:40960
    v_mfma_f32_16x16x32_bf16 v[200:203], a[104:107], a[140:143], v[200:203]
    v_mfma_f32_16x16x32_bf16 v[196:199], a[104:107], a[144:147], v[196:199]
    ds_read_b64_tr_b16 a[178:179], v11 offset:41984
    v_mfma_f32_16x16x32_bf16 v[192:195], a[104:107], a[148:151], v[192:195]
    s_add_u32 m0, s58, 73728
    v_mfma_f32_16x16x32_bf16 v[188:191], a[104:107], a[152:155], v[188:191]
    ds_read_b64_tr_b16 a[180:181], v13 offset:40960
    v_mfma_f32_16x16x32_bf16 v[184:187], a[104:107], a[156:159], v[184:187]
    v_mfma_f32_16x16x32_bf16 v[180:183], a[108:111], a[128:131], v[180:183]
    ds_read_b64_tr_b16 a[182:183], v13 offset:41984
    v_mfma_f32_16x16x32_bf16 v[176:179], a[108:111], a[132:135], v[176:179]
    buffer_load_dwordx4 v7, s[40:43], s48 offen lds
    s_add_u32 s48, s48, s53
    v_mfma_f32_16x16x32_bf16 v[172:175], a[108:111], a[136:139], v[172:175]
    ds_read_b64_tr_b16 a[184:185], v11 offset:43008
    v_mfma_f32_16x16x32_bf16 v[168:171], a[108:111], a[140:143], v[168:171]
    v_mfma_f32_16x16x32_bf16 v[164:167], a[108:111], a[144:147], v[164:167]
    ds_read_b64_tr_b16 a[186:187], v11 offset:44032
    v_mfma_f32_16x16x32_bf16 v[160:163], a[108:111], a[148:151], v[160:163]
    s_add_u32 m0, s60, 73728
    v_mfma_f32_16x16x32_bf16 v[156:159], a[108:111], a[152:155], v[156:159]
    ds_read_b64_tr_b16 a[188:189], v13 offset:43008
    v_mfma_f32_16x16x32_bf16 v[152:155], a[108:111], a[156:159], v[152:155]
    v_mfma_f32_16x16x32_bf16 v[148:151], a[112:115], a[128:131], v[148:151]
    ds_read_b64_tr_b16 a[190:191], v13 offset:44032
    v_mfma_f32_16x16x32_bf16 v[144:147], a[112:115], a[132:135], v[144:147]
    buffer_load_dwordx4 v1, s[20:23], s59 offen sc1 lds
    v_mfma_f32_16x16x32_bf16 v[140:143], a[112:115], a[136:139], v[140:143]
    ds_read_b64_tr_b16 a[192:193], v11 offset:45056
    v_mfma_f32_16x16x32_bf16 v[136:139], a[112:115], a[140:143], v[136:139]
    v_mfma_f32_16x16x32_bf16 v[132:135], a[112:115], a[144:147], v[132:135]
    ds_read_b64_tr_b16 a[194:195], v11 offset:46080
    v_mfma_f32_16x16x32_bf16 v[128:131], a[112:115], a[148:151], v[128:131]
    buffer_load_dwordx4 v1, s[20:23], s59 offen offset:1024 sc1 lds
    v_mfma_f32_16x16x32_bf16 v[124:127], a[112:115], a[152:155], v[124:127]
    ds_read_b64_tr_b16 a[196:197], v13 offset:45056
    v_mfma_f32_16x16x32_bf16 v[120:123], a[112:115], a[156:159], v[120:123]
    v_mfma_f32_16x16x32_bf16 v[116:119], a[116:119], a[128:131], v[116:119]
    ds_read_b64_tr_b16 a[198:199], v13 offset:46080
    v_mfma_f32_16x16x32_bf16 v[112:115], a[116:119], a[132:135], v[112:115]
    s_add_u32 m0, s60, 75776
    v_mfma_f32_16x16x32_bf16 v[108:111], a[116:119], a[136:139], v[108:111]
    v_mfma_f32_16x16x32_bf16 v[104:107], a[116:119], a[140:143], v[104:107]
    v_mfma_f32_16x16x32_bf16 v[100:103], a[116:119], a[144:147], v[100:103]
    v_mfma_f32_16x16x32_bf16 v[96:99], a[116:119], a[148:151], v[96:99]
    buffer_load_dwordx4 v2, s[20:23], s59 offen sc1 lds
    v_mfma_f32_16x16x32_bf16 v[92:95], a[116:119], a[152:155], v[92:95]
    v_mfma_f32_16x16x32_bf16 v[88:91], a[116:119], a[156:159], v[88:91]
    v_mfma_f32_16x16x32_bf16 v[84:87], a[120:123], a[128:131], v[84:87]
    v_mfma_f32_16x16x32_bf16 v[80:83], a[120:123], a[132:135], v[80:83]
    buffer_load_dwordx4 v2, s[20:23], s59 offen offset:1024 sc1 lds
    s_add_u32 s59, s59, 2048
    v_mfma_f32_16x16x32_bf16 v[76:79], a[120:123], a[136:139], v[76:79]
    v_mfma_f32_16x16x32_bf16 v[72:75], a[120:123], a[140:143], v[72:75]
    v_mfma_f32_16x16x32_bf16 v[68:71], a[120:123], a[144:147], v[68:71]
    v_mfma_f32_16x16x32_bf16 v[64:67], a[120:123], a[148:151], v[64:67]
    v_mfma_f32_16x16x32_bf16 v[60:63], a[120:123], a[152:155], v[60:63]
    v_mfma_f32_16x16x32_bf16 v[56:59], a[120:123], a[156:159], v[56:59]
    v_mfma_f32_16x16x32_bf16 v[52:55], a[124:127], a[128:131], v[52:55]
    v_mfma_f32_16x16x32_bf16 v[48:51], a[124:127], a[132:135], v[48:51]
    v_mfma_f32_16x16x32_bf16 v[44:47], a[124:127], a[136:139], v[44:47]
    v_mfma_f32_16x16x32_bf16 v[40:43], a[124:127], a[140:143], v[40:43]
    v_mfma_f32_16x16x32_bf16 v[36:39], a[124:127], a[144:147], v[36:39]
    v_mfma_f32_16x16x32_bf16 v[32:35], a[124:127], a[148:151], v[32:35]
    v_mfma_f32_16x16x32_bf16 v[28:31], a[124:127], a[152:155], v[28:31]
    v_mfma_f32_16x16x32_bf16 v[24:27], a[124:127], a[156:159], v[24:27]
    s_waitcnt lgkmcnt(0)
    v_mfma_f32_16x16x32_bf16 a[84:87], a[160:163], a[200:203], a[84:87]
    v_mfma_f32_16x16x32_bf16 a[80:83], a[160:163], a[204:207], a[80:83]
    s_waitcnt vmcnt(18)
    s_barrier
    v_mfma_f32_16x16x32_bf16 a[76:79], a[160:163], a[208:211], a[76:79]
    ds_read_b64_tr_b16 a[88:89], v10 offset:0
    v_mfma_f32_16x16x32_bf16 a[72:75], a[160:163], a[212:215], a[72:75]
    v_mfma_f32_16x16x32_bf16 a[68:71], a[160:163], a[216:219], a[68:71]
    ds_read_b64_tr_b16 a[90:91], v10 offset:1024
    v_mfma_f32_16x16x32_bf16 a[64:67], a[160:163], a[220:223], a[64:67]
    s_add_u32 m0, s54, 110592
    v_mfma_f32_16x16x32_bf16 a[60:63], a[160:163], a[224:227], a[60:63]
    ds_read_b128 a[128:131], v8 offset:0
    v_mfma_f32_16x16x32_bf16 a[56:59], a[160:163], a[228:231], a[56:59]
    v_mfma_f32_16x16x32_bf16 a[52:55], a[164:167], a[200:203], a[52:55]
    ds_read_b128 a[132:135], v8 offset:256
    v_mfma_f32_16x16x32_bf16 a[48:51], a[164:167], a[204:207], a[48:51]
    buffer_load_dwordx4 v3, s[24:27], s44 offen lds
    s_add_u32 s44, s44, s49
    v_mfma_f32_16x16x32_bf16 a[44:47], a[164:167], a[208:211], a[44:47]
    ds_read_b128 a[136:139], v8 offset:2048
    v_mfma_f32_16x16x32_bf16 a[40:43], a[164:167], a[212:215], a[40:43]
    v_mfma_f32_16x16x32_bf16 a[36:39], a[164:167], a[216:219], a[36:39]
    ds_read_b128 a[140:143], v8 offset:2304
    v_mfma_f32_16x16x32_bf16 a[32:35], a[164:167], a[220:223], a[32:35]
    s_add_u32 m0, s55, 110592
    v_mfma_f32_16x16x32_bf16 a[28:31], a[164:167], a[224:227], a[28:31]
    ds_read_b128 a[144:147], v8 offset:4096
    v_mfma_f32_16x16x32_bf16 a[24:27], a[164:167], a[228:231], a[24:27]
    v_mfma_f32_16x16x32_bf16 a[20:23], a[168:171], a[200:203], a[20:23]
    ds_read_b128 a[148:151], v8 offset:4352
    v_mfma_f32_16x16x32_bf16 a[16:19], a[168:171], a[204:207], a[16:19]
    buffer_load_dwordx4 v4, s[28:31], s45 offen lds
    s_add_u32 s45, s45, s50
    v_mfma_f32_16x16x32_bf16 a[12:15], a[168:171], a[208:211], a[12:15]
    ds_read_b128 a[152:155], v8 offset:6144
    v_mfma_f32_16x16x32_bf16 a[8:11], a[168:171], a[212:215], a[8:11]
    v_mfma_f32_16x16x32_bf16 a[4:7], a[168:171], a[216:219], a[4:7]
    ds_read_b128 a[156:159], v8 offset:6400
    v_mfma_f32_16x16x32_bf16 a[0:3], a[168:171], a[220:223], a[0:3]
    s_add_u32 m0, s56, 110592
    v_mfma_f32_16x16x32_bf16 v[252:255], a[168:171], a[224:227], v[252:255]
    ds_read_b64_tr_b16 a[92:93], v12 offset:0
    v_mfma_f32_16x16x32_bf16 v[248:251], a[168:171], a[228:231], v[248:251]
    v_mfma_f32_16x16x32_bf16 v[244:247], a[172:175], a[200:203], v[244:247]
    ds_read_b64_tr_b16 a[94:95], v12 offset:1024
    v_mfma_f32_16x16x32_bf16 v[240:243], a[172:175], a[204:207], v[240:243]
    buffer_load_dwordx4 v5, s[32:35], s46 offen lds
    s_add_u32 s46, s46, s51
    v_mfma_f32_16x16x32_bf16 v[236:239], a[172:175], a[208:211], v[236:239]
    ds_read_b64_tr_b16 a[96:97], v10 offset:2048
    v_mfma_f32_16x16x32_bf16 v[232:235], a[172:175], a[212:215], v[232:235]
    v_mfma_f32_16x16x32_bf16 v[228:231], a[172:175], a[216:219], v[228:231]
    ds_read_b64_tr_b16 a[98:99], v10 offset:3072
    v_mfma_f32_16x16x32_bf16 v[224:227], a[172:175], a[220:223], v[224:227]
    s_add_u32 m0, s57, 110592
    v_mfma_f32_16x16x32_bf16 v[220:223], a[172:175], a[224:227], v[220:223]
    ds_read_b64_tr_b16 a[100:101], v12 offset:2048
    v_mfma_f32_16x16x32_bf16 v[216:219], a[172:175], a[228:231], v[216:219]
    v_mfma_f32_16x16x32_bf16 v[212:215], a[176:179], a[200:203], v[212:215]
    ds_read_b64_tr_b16 a[102:103], v12 offset:3072
    v_mfma_f32_16x16x32_bf16 v[208:211], a[176:179], a[204:207], v[208:211]
    buffer_load_dwordx4 v6, s[36:39], s47 offen lds
    s_add_u32 s47, s47, s52
    v_mfma_f32_16x16x32_bf16 v[204:207], a[176:179], a[208:211], v[204:207]
    ds_read_b64_tr_b16 a[104:105], v10 offset:4096
    v_mfma_f32_16x16x32_bf16 v[200:203], a[176:179], a[212:215], v[200:203]
    v_mfma_f32_16x16x32_bf16 v[196:199], a[176:179], a[216:219], v[196:199]
    ds_read_b64_tr_b16 a[106:107], v10 offset:5120
    v_mfma_f32_16x16x32_bf16 v[192:195], a[176:179], a[220:223], v[192:195]
    s_add_u32 m0, s58, 110592
    v_mfma_f32_16x16x32_bf16 v[188:191], a[176:179], a[224:227], v[188:191]
    ds_read_b64_tr_b16 a[108:109], v12 offset:4096
    v_mfma_f32_16x16x32_bf16 v[184:187], a[176:179], a[228:231], v[184:187]
    v_mfma_f32_16x16x32_bf16 v[180:183], a[180:183], a[200:203], v[180:183]
    ds_read_b64_tr_b16 a[110:111], v12 offset:5120
    v_mfma_f32_16x16x32_bf16 v[176:179], a[180:183], a[204:207], v[176:179]
    buffer_load_dwordx4 v7, s[40:43], s48 offen lds
    s_add_u32 s48, s48, s53
    v_mfma_f32_16x16x32_bf16 v[172:175], a[180:183], a[208:211], v[172:175]
    ds_read_b64_tr_b16 a[112:113], v10 offset:6144
    v_mfma_f32_16x16x32_bf16 v[168:171], a[180:183], a[212:215], v[168:171]
    v_mfma_f32_16x16x32_bf16 v[164:167], a[180:183], a[216:219], v[164:167]
    ds_read_b64_tr_b16 a[114:115], v10 offset:7168
    v_mfma_f32_16x16x32_bf16 v[160:163], a[180:183], a[220:223], v[160:163]
    s_add_u32 m0, s60, 110592
    v_mfma_f32_16x16x32_bf16 v[156:159], a[180:183], a[224:227], v[156:159]
    ds_read_b64_tr_b16 a[116:117], v12 offset:6144
    v_mfma_f32_16x16x32_bf16 v[152:155], a[180:183], a[228:231], v[152:155]
    v_mfma_f32_16x16x32_bf16 v[148:151], a[184:187], a[200:203], v[148:151]
    ds_read_b64_tr_b16 a[118:119], v12 offset:7168
    v_mfma_f32_16x16x32_bf16 v[144:147], a[184:187], a[204:207], v[144:147]
    buffer_load_dwordx4 v1, s[20:23], s59 offen sc1 lds
    v_mfma_f32_16x16x32_bf16 v[140:143], a[184:187], a[208:211], v[140:143]
    ds_read_b64_tr_b16 a[120:121], v10 offset:8192
    v_mfma_f32_16x16x32_bf16 v[136:139], a[184:187], a[212:215], v[136:139]
    v_mfma_f32_16x16x32_bf16 v[132:135], a[184:187], a[216:219], v[132:135]
    ds_read_b64_tr_b16 a[122:123], v10 offset:9216
    v_mfma_f32_16x16x32_bf16 v[128:131], a[184:187], a[220:223], v[128:131]
    buffer_load_dwordx4 v1, s[20:23], s59 offen offset:1024 sc1 lds
    v_mfma_f32_16x16x32_bf16 v[124:127], a[184:187], a[224:227], v[124:127]
    ds_read_b64_tr_b16 a[124:125], v12 offset:8192
    v_mfma_f32_16x16x32_bf16 v[120:123], a[184:187], a[228:231], v[120:123]
    v_mfma_f32_16x16x32_bf16 v[116:119], a[188:191], a[200:203], v[116:119]
    ds_read_b64_tr_b16 a[126:127], v12 offset:9216
    v_mfma_f32_16x16x32_bf16 v[112:115], a[188:191], a[204:207], v[112:115]
    s_add_u32 m0, s60, 112640
    v_mfma_f32_16x16x32_bf16 v[108:111], a[188:191], a[208:211], v[108:111]
    v_mfma_f32_16x16x32_bf16 v[104:107], a[188:191], a[212:215], v[104:107]
    v_mfma_f32_16x16x32_bf16 v[100:103], a[188:191], a[216:219], v[100:103]
    v_mfma_f32_16x16x32_bf16 v[96:99], a[188:191], a[220:223], v[96:99]
    buffer_load_dwordx4 v2, s[20:23], s59 offen sc1 lds
    v_mfma_f32_16x16x32_bf16 v[92:95], a[188:191], a[224:227], v[92:95]
    v_mfma_f32_16x16x32_bf16 v[88:91], a[188:191], a[228:231], v[88:91]
    v_mfma_f32_16x16x32_bf16 v[84:87], a[192:195], a[200:203], v[84:87]
    v_mfma_f32_16x16x32_bf16 v[80:83], a[192:195], a[204:207], v[80:83]
    buffer_load_dwordx4 v2, s[20:23], s59 offen offset:1024 sc1 lds
    s_add_u32 s59, s59, 2048
    v_mfma_f32_16x16x32_bf16 v[76:79], a[192:195], a[208:211], v[76:79]
    v_mfma_f32_16x16x32_bf16 v[72:75], a[192:195], a[212:215], v[72:75]
    v_mfma_f32_16x16x32_bf16 v[68:71], a[192:195], a[216:219], v[68:71]
    v_mfma_f32_16x16x32_bf16 v[64:67], a[192:195], a[220:223], v[64:67]
    v_mfma_f32_16x16x32_bf16 v[60:63], a[192:195], a[224:227], v[60:63]
    v_mfma_f32_16x16x32_bf16 v[56:59], a[192:195], a[228:231], v[56:59]
    v_mfma_f32_16x16x32_bf16 v[52:55], a[196:199], a[200:203], v[52:55]
    v_mfma_f32_16x16x32_bf16 v[48:51], a[196:199], a[204:207], v[48:51]
    v_mfma_f32_16x16x32_bf16 v[44:47], a[196:199], a[208:211], v[44:47]
    v_mfma_f32_16x16x32_bf16 v[40:43], a[196:199], a[212:215], v[40:43]
    v_mfma_f32_16x16x32_bf16 v[36:39], a[196:199], a[216:219], v[36:39]
    v_mfma_f32_16x16x32_bf16 v[32:35], a[196:199], a[220:223], v[32:35]
    v_mfma_f32_16x16x32_bf16 v[28:31], a[196:199], a[224:227], v[28:31]
    v_mfma_f32_16x16x32_bf16 v[24:27], a[196:199], a[228:231], v[24:27]
    s_sub_u32 s61, s61, 1
    s_cmp_eq_u32 s61, 2
    s_cbranch_scc1 L_g1_fx1
    s_cmp_lg_u32 s61, 0
    s_cbranch_scc1 L_g1_loopn1
    s_add_u32 s24, s10, 0x3200000
    s_addc_u32 s25, s11, 0
    s_mov_b32 s26, 0x8000
    s_mov_b32 s27, 0x00020000
    s_getreg_b32 s17, hwreg(HW_REG_XCC_ID, 0, 4)
    v_accvgpr_read_b32 v2, a236
    v_accvgpr_read_b32 v3, a237
    s_add_u32 s17, s17, 1
    v_cmp_ne_u32 s[32:33], s17, v2
    v_cmp_gt_u32 s[36:37], 32, v3
    v_lshlrev_b32 v1, 3, v0
    s_or_b32 s93, s32, s36
    s_or_b32 s93, s93, s37
    v_lshlrev_b32 v1, 3, v0
    s_lshl_b32 s28, s3, 9
    buffer_load_dwordx2 a[238:239], v1, s[24:27], s28 offen sc1
    s_getpc_b64 s[28:29]
L_pc_g11:
    s_add_u32 s28, s28, L_code_a - L_pc_g11
    s_addc_u32 s29, s29, 0
    s_mov_b32 s30, L_g2_begin - L_code_a
    s_mov_b32 s31, 0x00020000
    s_lshr_b32 s19, s2, 3
    s_lshl_b32 s19, s19, 2
    s_add_u32 s19, s19, s14
    s_lshl_b32 s19, s19, 10
    v_lshlrev_b32 v6, 4, v0
    buffer_load_dwordx4 a[232:235], v6, s[28:31], s19 offen
    s_waitcnt lgkmcnt(0)
    v_mfma_f32_16x16x32_bf16 a[84:87], a[88:91], a[128:131], a[84:87]
    v_mfma_f32_16x16x32_bf16 a[80:83], a[88:91], a[132:135], a[80:83]
    s_waitcnt vmcnt(20)
    s_barrier
    v_mfma_f32_16x16x32_bf16 a[76:79], a[88:91], a[136:139], a[76:79]
    ds_read_b64_tr_b16 a[160:161], v10 offset:36864
    v_mfma_f32_16x16x32_bf16 a[72:75], a[88:91], a[140:143], a[72:75]
    s_lshl_b32 s28, s3, 9
    s_lshr_b32 s17, s2, 3
    s_lshl_b32 s17, s17, 2
    v_mfma_f32_16x16x32_bf16 a[68:71], a[88:91], a[144:147], a[68:71]
    ds_read_b64_tr_b16 a[162:163], v10 offset:37888
    v_mfma_f32_16x16x32_bf16 a[64:67], a[88:91], a[148:151], a[64:67]
    s_add_u32 s17, s17, s14
    s_lshl_b32 s17, s17, 2
    s_add_u32 s29, s28, s17
    v_mfma_f32_16x16x32_bf16 a[60:63], a[88:91], a[152:155], a[60:63]
    ds_read_b128 a[200:203], v8 offset:36864
    v_mfma_f32_16x16x32_bf16 a[56:59], a[88:91], a[156:159], a[56:59]
    s_lshl_b32 s30, s13, 1
    s_add_u32 s30, s30, s15
    s_lshl_b32 s30, s30, 6
    v_mfma_f32_16x16x32_bf16 a[52:55], a[92:95], a[128:131], a[52:55]
    ds_read_b128 a[204:207], v8 offset:37120
    v_mfma_f32_16x16x32_bf16 a[48:51], a[92:95], a[132:135], a[48:51]
    s_lshl_b32 s17, s3, 3
    s_lshl_b32 s19, s12, 1
    s_add_u32 s17, s17, s19
    v_mfma_f32_16x16x32_bf16 a[44:47], a[92:95], a[136:139], a[44:47]
    ds_read_b128 a[208:211], v8 offset:38912
    v_mfma_f32_16x16x32_bf16 a[40:43], a[92:95], a[140:143], a[40:43]
    s_add_u32 s17, s17, s16
    s_add_u32 s30, s30, s17
    s_lshl_b32 s30, s30, 2
    v_mfma_f32_16x16x32_bf16 a[36:39], a[92:95], a[144:147], a[36:39]
    ds_read_b128 a[212:215], v8 offset:39168
    v_mfma_f32_16x16x32_bf16 a[32:35], a[92:95], a[148:151], a[32:35]
    s_add_u32 s31, s30, 8192
    s_add_u32 s30, s30, 4096
    v_mfma_f32_16x16x32_bf16 a[28:31], a[92:95], a[152:155], a[28:31]
    ds_read_b128 a[216:219], v8 offset:40960
    v_mfma_f32_16x16x32_bf16 a[24:27], a[92:95], a[156:159], a[24:27]
    s_lshr_b32 s17, s2, 4
    s_lshl_b32 s17, s17, 3
    s_add_u32 s17, s17, s3
    v_mfma_f32_16x16x32_bf16 a[20:23], a[96:99], a[128:131], a[20:23]
    ds_read_b128 a[220:223], v8 offset:41216
    v_mfma_f32_16x16x32_bf16 a[16:19], a[96:99], a[132:135], a[16:19]
    s_lshl_b32 s28, s17, 7
    s_add_u32 s28, s28, 12288
    s_bfe_u32 s17, s2, 0x10003
    v_mfma_f32_16x16x32_bf16 a[12:15], a[96:99], a[136:139], a[12:15]
    ds_read_b128 a[224:227], v8 offset:43008
    v_mfma_f32_16x16x32_bf16 a[8:11], a[96:99], a[140:143], a[8:11]
    s_lshl_b32 s17, s17, 2
    s_add_u32 s17, s17, s14
    s_lshl_b32 s17, s17, 2
    v_mfma_f32_16x16x32_bf16 a[4:7], a[96:99], a[144:147], a[4:7]
    ds_read_b128 a[228:231], v8 offset:43264
    v_mfma_f32_16x16x32_bf16 a[0:3], a[96:99], a[148:151], a[0:3]
    s_add_u32 s28, s28, s17
    s_mov_b32 s91, s31
    s_mov_b32 s92, s28
    v_mfma_f32_16x16x32_bf16 v[252:255], a[96:99], a[152:155], v[252:255]
    ds_read_b64_tr_b16 a[164:165], v12 offset:36864
    v_mfma_f32_16x16x32_bf16 v[248:251], a[96:99], a[156:159], v[248:251]
    s_lshl_b32 s28, s3, 9
    s_lshl_b32 s74, s13, 3
    s_lshl_b32 s17, s15, 2
    v_mfma_f32_16x16x32_bf16 v[244:247], a[100:103], a[128:131], v[244:247]
    ds_read_b64_tr_b16 a[166:167], v12 offset:37888
    v_mfma_f32_16x16x32_bf16 v[240:243], a[100:103], a[132:135], v[240:243]
    s_add_u32 s74, s74, s17
    s_lshr_b32 s75, s62, 5
    s_add_u32 s75, s75, 32
    v_mfma_f32_16x16x32_bf16 v[236:239], a[100:103], a[136:139], v[236:239]
    ds_read_b64_tr_b16 a[168:169], v10 offset:38912
    v_mfma_f32_16x16x32_bf16 v[232:235], a[100:103], a[140:143], v[232:235]
    s_lshl_b32 s75, s75, 11
    s_mul_i32 s90, s74, 294912
    s_add_u32 s90, s90, s75
    v_mfma_f32_16x16x32_bf16 v[228:231], a[100:103], a[144:147], v[228:231]
    ds_read_b64_tr_b16 a[170:171], v10 offset:39936
    v_mfma_f32_16x16x32_bf16 v[224:227], a[100:103], a[148:151], v[224:227]
    s_mov_b32 s72, 0xbfb8aa3b
    s_mov_b32 s73, s72
    s_cmp_lt_u32 s63, 32
    v_mfma_f32_16x16x32_bf16 v[220:223], a[100:103], a[152:155], v[220:223]
    ds_read_b64_tr_b16 a[172:173], v12 offset:38912
    v_mfma_f32_16x16x32_bf16 v[216:219], a[100:103], a[156:159], v[216:219]
    s_mov_b32 s86, 1.0
    s_cselect_b32 s84, 0x3e8293ee, s86
    s_mov_b32 s85, s84
    v_mfma_f32_16x16x32_bf16 v[212:215], a[104:107], a[128:131], v[212:215]
    ds_read_b64_tr_b16 a[174:175], v12 offset:39936
    v_mfma_f32_16x16x32_bf16 v[208:211], a[104:107], a[132:135], v[208:211]
    s_mov_b32 s87, 1.0
    s_lshl_b32 s76, s63, 6
    s_add_u32 s76, s76, s74
    v_mfma_f32_16x16x32_bf16 v[204:207], a[104:107], a[136:139], v[204:207]
    ds_read_b64_tr_b16 a[176:177], v10 offset:40960
    v_mfma_f32_16x16x32_bf16 v[200:203], a[104:107], a[140:143], v[200:203]
    s_lshl_b32 s76, s76, 11
    s_lshl_b32 s19, s3, 2
    s_add_u32 s12, s12, s19
    v_mfma_f32_16x16x32_bf16 v[196:199], a[104:107], a[144:147], v[196:199]
    ds_read_b64_tr_b16 a[178:179], v10 offset:41984
    v_mfma_f32_16x16x32_bf16 v[192:195], a[104:107], a[148:151], v[192:195]
    s_lshl_b32 s13, s13, 3
    s_lshl_b32 s15, s14, 1
    s_add_u32 s13, s13, s15
    v_mfma_f32_16x16x32_bf16 v[188:191], a[104:107], a[152:155], v[188:191]
    ds_read_b64_tr_b16 a[180:181], v12 offset:40960
    v_mfma_f32_16x16x32_bf16 v[184:187], a[104:107], a[156:159], v[184:187]
    v_lshlrev_b32 v1, 4, v0
    s_add_u32 s20, s10, 0x400000
    s_addc_u32 s21, s11, 0
    v_mfma_f32_16x16x32_bf16 v[180:183], a[108:111], a[128:131], v[180:183]
    ds_read_b64_tr_b16 a[182:183], v12 offset:41984
    v_mfma_f32_16x16x32_bf16 v[176:179], a[108:111], a[132:135], v[176:179]
    s_mov_b32 s22, 0xc00000
    s_mov_b32 s23, 0x00020000
    s_add_u32 s19, s12, 32
    v_mfma_f32_16x16x32_bf16 v[172:175], a[108:111], a[136:139], v[172:175]
    ds_read_b64_tr_b16 a[184:185], v10 offset:43008
    v_mfma_f32_16x16x32_bf16 v[168:171], a[108:111], a[140:143], v[168:171]
    s_lshl_b32 s19, s19, 17
    s_lshl_b32 s18, s14, 11
    s_add_u32 s19, s19, s18
    v_mfma_f32_16x16x32_bf16 v[164:167], a[108:111], a[144:147], v[164:167]
    ds_read_b64_tr_b16 a[186:187], v10 offset:44032
    v_mfma_f32_16x16x32_bf16 v[160:163], a[108:111], a[148:151], v[160:163]
    v_add_u32 v2, s19, v1
    s_add_u32 s19, s19, 0x400000
    v_lshrrev_b32 v7, 5, v0
    v_mfma_f32_16x16x32_bf16 v[156:159], a[108:111], a[152:155], v[156:159]
    ds_read_b64_tr_b16 a[188:189], v12 offset:43008
    v_mfma_f32_16x16x32_bf16 v[152:155], a[108:111], a[156:159], v[152:155]
    v_and_b32 v23, 31, v0
    v_lshlrev_b32 v3, 2, v7
    v_xor_b32 v3, v23, v3
    v_mfma_f32_16x16x32_bf16 v[148:151], a[112:115], a[128:131], v[148:151]
    ds_read_b64_tr_b16 a[190:191], v12 offset:44032
    v_mfma_f32_16x16x32_bf16 v[144:147], a[112:115], a[132:135], v[144:147]
    v_lshlrev_b32 v3, 4, v3
    v_lshlrev_b32 v7, 9, v7
    v_xor_b32 v6, 0x80, v3
    v_mfma_f32_16x16x32_bf16 v[140:143], a[112:115], a[136:139], v[140:143]
    ds_read_b64_tr_b16 a[192:193], v10 offset:45056
    v_mfma_f32_16x16x32_bf16 v[136:139], a[112:115], a[140:143], v[136:139]
    v_add3_u32 v3, v3, v7, s19
    v_add3_u32 v6, v6, v7, s19
    v_lshrrev_b32 v7, 5, v0
    v_mfma_f32_16x16x32_bf16 v[132:135], a[112:115], a[144:147], v[132:135]
    ds_read_b64_tr_b16 a[194:195], v10 offset:46080
    v_mfma_f32_16x16x32_bf16 v[128:131], a[112:115], a[148:151], v[128:131]
    v_bfe_u32 v23, v0, 2, 2
    v_lshl_add_u32 v23, v7, 2, v23
    v_and_b32 v7, 3, v0
    v_mfma_f32_16x16x32_bf16 v[124:127], a[112:115], a[152:155], v[124:127]
    ds_read_b64_tr_b16 a[196:197], v12 offset:45056
    v_mfma_f32_16x16x32_bf16 v[120:123], a[112:115], a[156:159], v[120:123]
    v_lshlrev_b32 v4, 2, v7
    v_xor_b32 v4, v23, v4
    v_bfe_u32 v23, v0, 4, 1
    v_mfma_f32_16x16x32_bf16 v[116:119], a[116:119], a[128:131], v[116:119]
    ds_read_b64_tr_b16 a[198:199], v12 offset:46080
    v_mfma_f32_16x16x32_bf16 v[112:115], a[116:119], a[132:135], v[112:115]
    v_lshlrev_b32 v23, 3, v23
    v_lshl_add_u32 v23, v7, 9, v23
    v_add_u32 v23, 98304, v23
    v_mfma_f32_16x16x32_bf16 v[108:111], a[116:119], a[136:139], v[108:111]
    v_mfma_f32_16x16x32_bf16 v[104:107], a[116:119], a[140:143], v[104:107]
    v_xor_b32 v5, 8, v4
    v_lshl_add_u32 v4, v4, 4, v23
    v_lshl_add_u32 v5, v5, 4, v23
    v_mfma_f32_16x16x32_bf16 v[100:103], a[116:119], a[144:147], v[100:103]
    v_mfma_f32_16x16x32_bf16 v[96:99], a[116:119], a[148:151], v[96:99]
    v_add_u32 v23, 98304, v1
    s_mov_b32 s31, 0
    s_lshl_b32 s19, s2, 2
    v_mfma_f32_16x16x32_bf16 v[92:95], a[116:119], a[152:155], v[92:95]
    v_mfma_f32_16x16x32_bf16 v[88:91], a[116:119], a[156:159], v[88:91]
    s_add_u32 s19, s19, s14
    s_lshl_b32 s19, s19, 10
    v_add_u32 v7, s19, v1
    v_mfma_f32_16x16x32_bf16 v[84:87], a[120:123], a[128:131], v[84:87]
    v_mfma_f32_16x16x32_bf16 v[80:83], a[120:123], a[132:135], v[80:83]
    s_lshl_b32 s46, s12, 6
    s_add_u32 s46, s46, s13
    s_lshl_b32 s46, s46, 11
    v_mfma_f32_16x16x32_bf16 v[76:79], a[120:123], a[136:139], v[76:79]
    v_mfma_f32_16x16x32_bf16 v[72:75], a[120:123], a[140:143], v[72:75]
    s_mov_b32 s38, -1
    s_mov_b32 s39, 0
    s_cmp_eq_u32 s93, 0
    v_mfma_f32_16x16x32_bf16 v[68:71], a[120:123], a[144:147], v[68:71]
    v_mfma_f32_16x16x32_bf16 v[64:67], a[120:123], a[148:151], v[64:67]
    s_cselect_b32 s22, s22, 0
    v_mfma_f32_16x16x32_bf16 v[60:63], a[120:123], a[152:155], v[60:63]
    v_mfma_f32_16x16x32_bf16 v[56:59], a[120:123], a[156:159], v[56:59]
    v_mfma_f32_16x16x32_bf16 v[52:55], a[124:127], a[128:131], v[52:55]
    v_mfma_f32_16x16x32_bf16 v[48:51], a[124:127], a[132:135], v[48:51]
    v_mfma_f32_16x16x32_bf16 v[44:47], a[124:127], a[136:139], v[44:47]
    v_mfma_f32_16x16x32_bf16 v[40:43], a[124:127], a[140:143], v[40:43]
    v_mfma_f32_16x16x32_bf16 v[36:39], a[124:127], a[144:147], v[36:39]
    v_mfma_f32_16x16x32_bf16 v[32:35], a[124:127], a[148:151], v[32:35]
    v_mfma_f32_16x16x32_bf16 v[28:31], a[124:127], a[152:155], v[28:31]
    v_mfma_f32_16x16x32_bf16 v[24:27], a[124:127], a[156:159], v[24:27]
    s_waitcnt lgkmcnt(0)
    v_mfma_f32_16x16x32_bf16 a[84:87], a[160:163], a[200:203], a[84:87]
    v_mfma_f32_16x16x32_bf16 a[80:83], a[160:163], a[204:207], a[80:83]
    s_waitcnt vmcnt(11)
    s_barrier
    v_mfma_f32_16x16x32_bf16 a[76:79], a[160:163], a[208:211], a[76:79]
    ds_read_b64_tr_b16 a[88:89], v11 offset:0
    v_mfma_f32_16x16x32_bf16 a[72:75], a[160:163], a[212:215], a[72:75]
    s_mov_b32 s19, 0
    v_mfma_f32_16x16x32_bf16 a[68:71], a[160:163], a[216:219], a[68:71]
    ds_read_b64_tr_b16 a[90:91], v11 offset:1024
    v_mfma_f32_16x16x32_bf16 a[64:67], a[160:163], a[220:223], a[64:67]
    s_nop 0
    v_mfma_f32_16x16x32_bf16 a[60:63], a[160:163], a[224:227], a[60:63]
    ds_read_b128 a[128:131], v9 offset:0
    v_mfma_f32_16x16x32_bf16 a[56:59], a[160:163], a[228:231], a[56:59]
    buffer_load_dwordx4 a[232:235], v2, s[20:23], s19 offen offset:0 sc1
    v_mfma_f32_16x16x32_bf16 a[52:55], a[164:167], a[200:203], a[52:55]
    ds_read_b128 a[132:135], v9 offset:256
    v_mfma_f32_16x16x32_bf16 a[48:51], a[164:167], a[204:207], a[48:51]
    s_nop 0
    v_mfma_f32_16x16x32_bf16 a[44:47], a[164:167], a[208:211], a[44:47]
    ds_read_b128 a[136:139], v9 offset:2048
    v_mfma_f32_16x16x32_bf16 a[40:43], a[164:167], a[212:215], a[40:43]
    buffer_load_dwordx4 a[232:235], v2, s[20:23], s19 offen offset:1024 sc1
    v_mfma_f32_16x16x32_bf16 a[36:39], a[164:167], a[216:219], a[36:39]
    ds_read_b128 a[140:143], v9 offset:2304
    v_mfma_f32_16x16x32_bf16 a[32:35], a[164:167], a[220:223], a[32:35]
    s_nop 0
    v_mfma_f32_16x16x32_bf16 a[28:31], a[164:167], a[224:227], a[28:31]
    ds_read_b128 a[144:147], v9 offset:4096
    v_mfma_f32_16x16x32_bf16 a[24:27], a[164:167], a[228:231], a[24:27]
    buffer_load_dwordx4 a[232:235], v3, s[20:23], s19 offen offset:0 sc1
    v_mfma_f32_16x16x32_bf16 a[20:23], a[168:171], a[200:203], a[20:23]
    ds_read_b128 a[148:151], v9 offset:4352
    v_mfma_f32_16x16x32_bf16 a[16:19], a[168:171], a[204:207], a[16:19]
    s_nop 0
    v_mfma_f32_16x16x32_bf16 a[12:15], a[168:171], a[208:211], a[12:15]
    ds_read_b128 a[152:155], v9 offset:6144
    v_mfma_f32_16x16x32_bf16 a[8:11], a[168:171], a[212:215], a[8:11]
    buffer_load_dwordx4 a[232:235], v6, s[20:23], s19 offen offset:1024 sc1
    v_mfma_f32_16x16x32_bf16 a[4:7], a[168:171], a[216:219], a[4:7]
    ds_read_b128 a[156:159], v9 offset:6400
    v_mfma_f32_16x16x32_bf16 a[0:3], a[168:171], a[220:223], a[0:3]
    s_nop 0
    v_mfma_f32_16x16x32_bf16 v[252:255], a[168:171], a[224:227], v[252:255]
    ds_read_b64_tr_b16 a[92:93], v13 offset:0
    v_mfma_f32_16x16x32_bf16 v[248:251], a[168:171], a[228:231], v[248:251]
    s_mov_b32 s19, 8192
    v_mfma_f32_16x16x32_bf16 v[244:247], a[172:175], a[200:203], v[244:247]
    ds_read_b64_tr_b16 a[94:95], v13 offset:1024
    v_mfma_f32_16x16x32_bf16 v[240:243], a[172:175], a[204:207], v[240:243]
    s_nop 0
    v_mfma_f32_16x16x32_bf16 v[236:239], a[172:175], a[208:211], v[236:239]
    ds_read_b64_tr_b16 a[96:97], v11 offset:2048
    v_mfma_f32_16x16x32_bf16 v[232:235], a[172:175], a[212:215], v[232:235]
    buffer_load_dwordx4 a[232:235], v2, s[20:23], s19 offen offset:0 sc1
    v_mfma_f32_16x16x32_bf16 v[228:231], a[172:175], a[216:219], v[228:231]
    ds_read_b64_tr_b16 a[98:99], v11 offset:3072
    v_mfma_f32_16x16x32_bf16 v[224:227], a[172:175], a[220:223], v[224:227]
    s_nop 0
    v_mfma_f32_16x16x32_bf16 v[220:223], a[172:175], a[224:227], v[220:223]
    ds_read_b64_tr_b16 a[100:101], v13 offset:2048
    v_mfma_f32_16x16x32_bf16 v[216:219], a[172:175], a[228:231], v[216:219]
    buffer_load_dwordx4 a[232:235], v2, s[20:23], s19 offen offset:1024 sc1
    v_mfma_f32_16x16x32_bf16 v[212:215], a[176:179], a[200:203], v[212:215]
    ds_read_b64_tr_b16 a[102:103], v13 offset:3072
    v_mfma_f32_16x16x32_bf16 v[208:211], a[176:179], a[204:207], v[208:211]
    s_nop 0
    v_mfma_f32_16x16x32_bf16 v[204:207], a[176:179], a[208:211], v[204:207]
    ds_read_b64_tr_b16 a[104:105], v11 offset:4096
    v_mfma_f32_16x16x32_bf16 v[200:203], a[176:179], a[212:215], v[200:203]
    buffer_load_dwordx4 a[232:235], v3, s[20:23], s19 offen offset:0 sc1
    v_mfma_f32_16x16x32_bf16 v[196:199], a[176:179], a[216:219], v[196:199]
    ds_read_b64_tr_b16 a[106:107], v11 offset:5120
    v_mfma_f32_16x16x32_bf16 v[192:195], a[176:179], a[220:223], v[192:195]
    s_nop 0
    v_mfma_f32_16x16x32_bf16 v[188:191], a[176:179], a[224:227], v[188:191]
    ds_read_b64_tr_b16 a[108:109], v13 offset:4096
    v_mfma_f32_16x16x32_bf16 v[184:187], a[176:179], a[228:231], v[184:187]
    buffer_load_dwordx4 a[232:235], v6, s[20:23], s19 offen offset:1024 sc1
    v_mfma_f32_16x16x32_bf16 v[180:183], a[180:183], a[200:203], v[180:183]
    ds_read_b64_tr_b16 a[110:111], v13 offset:5120
    v_mfma_f32_16x16x32_bf16 v[176:179], a[180:183], a[204:207], v[176:179]
    s_nop 0
    v_mfma_f32_16x16x32_bf16 v[172:175], a[180:183], a[208:211], v[172:175]
    ds_read_b64_tr_b16 a[112:113], v11 offset:6144
    v_mfma_f32_16x16x32_bf16 v[168:171], a[180:183], a[212:215], v[168:171]
    s_mov_b32 s19, 16384
    v_mfma_f32_16x16x32_bf16 v[164:167], a[180:183], a[216:219], v[164:167]
    ds_read_b64_tr_b16 a[114:115], v11 offset:7168
    v_mfma_f32_16x16x32_bf16 v[160:163], a[180:183], a[220:223], v[160:163]
    s_nop 0
    v_mfma_f32_16x16x32_bf16 v[156:159], a[180:183], a[224:227], v[156:159]
    ds_read_b64_tr_b16 a[116:117], v13 offset:6144
    v_mfma_f32_16x16x32_bf16 v[152:155], a[180:183], a[228:231], v[152:155]
    buffer_load_dwordx4 a[232:235], v2, s[20:23], s19 offen offset:0 sc1
    v_mfma_f32_16x16x32_bf16 v[148:151], a[184:187], a[200:203], v[148:151]
    ds_read_b64_tr_b16 a[118:119], v13 offset:7168
    v_mfma_f32_16x16x32_bf16 v[144:147], a[184:187], a[204:207], v[144:147]
    s_nop 0
    v_mfma_f32_16x16x32_bf16 v[140:143], a[184:187], a[208:211], v[140:143]
    ds_read_b64_tr_b16 a[120:121], v11 offset:8192
    v_mfma_f32_16x16x32_bf16 v[136:139], a[184:187], a[212:215], v[136:139]
    buffer_load_dwordx4 a[232:235], v2, s[20:23], s19 offen offset:1024 sc1
    v_mfma_f32_16x16x32_bf16 v[132:135], a[184:187], a[216:219], v[132:135]
    ds_read_b64_tr_b16 a[122:123], v11 offset:9216
    v_mfma_f32_16x16x32_bf16 v[128:131], a[184:187], a[220:223], v[128:131]
    s_nop 0
    v_mfma_f32_16x16x32_bf16 v[124:127], a[184:187], a[224:227], v[124:127]
    ds_read_b64_tr_b16 a[124:125], v13 offset:8192
    v_mfma_f32_16x16x32_bf16 v[120:123], a[184:187], a[228:231], v[120:123]
    buffer_load_dwordx4 a[232:235], v3, s[20:23], s19 offen offset:0 sc1
    v_mfma_f32_16x16x32_bf16 v[116:119], a[188:191], a[200:203], v[116:119]
    ds_read_b64_tr_b16 a[126:127], v13 offset:9216
    v_mfma_f32_16x16x32_bf16 v[112:115], a[188:191], a[204:207], v[112:115]
    s_nop 0
    v_mfma_f32_16x16x32_bf16 v[108:111], a[188:191], a[208:211], v[108:111]
    v_mfma_f32_16x16x32_bf16 v[104:107], a[188:191], a[212:215], v[104:107]
    buffer_load_dwordx4 a[232:235], v6, s[20:23], s19 offen offset:1024 sc1
    v_mfma_f32_16x16x32_bf16 v[100:103], a[188:191], a[216:219], v[100:103]
    v_mfma_f32_16x16x32_bf16 v[96:99], a[188:191], a[220:223], v[96:99]
    s_nop 0
    v_mfma_f32_16x16x32_bf16 v[92:95], a[188:191], a[224:227], v[92:95]
    v_mfma_f32_16x16x32_bf16 v[88:91], a[188:191], a[228:231], v[88:91]
    buffer_load_dwordx4 a[232:235], v1, s[20:23], s46 offen offset:0 sc1
    v_mfma_f32_16x16x32_bf16 v[84:87], a[192:195], a[200:203], v[84:87]
    v_mfma_f32_16x16x32_bf16 v[80:83], a[192:195], a[204:207], v[80:83]
    s_nop 0
    v_mfma_f32_16x16x32_bf16 v[76:79], a[192:195], a[208:211], v[76:79]
    v_mfma_f32_16x16x32_bf16 v[72:75], a[192:195], a[212:215], v[72:75]
    buffer_load_dwordx4 a[232:235], v1, s[20:23], s46 offen offset:1024 sc1
    v_mfma_f32_16x16x32_bf16 v[68:71], a[192:195], a[216:219], v[68:71]
    v_mfma_f32_16x16x32_bf16 v[64:67], a[192:195], a[220:223], v[64:67]
    s_nop 0
    v_mfma_f32_16x16x32_bf16 v[60:63], a[192:195], a[224:227], v[60:63]
    v_mfma_f32_16x16x32_bf16 v[56:59], a[192:195], a[228:231], v[56:59]
    buffer_load_dwordx4 a[232:235], v1, s[20:23], s46 offen offset:2048 sc1
    v_mfma_f32_16x16x32_bf16 v[52:55], a[196:199], a[200:203], v[52:55]
    v_mfma_f32_16x16x32_bf16 v[48:51], a[196:199], a[204:207], v[48:51]
    s_nop 0
    v_mfma_f32_16x16x32_bf16 v[44:47], a[196:199], a[208:211], v[44:47]
    v_mfma_f32_16x16x32_bf16 v[40:43], a[196:199], a[212:215], v[40:43]
    buffer_load_dwordx4 a[232:235], v1, s[20:23], s46 offen offset:3072 sc1
    v_mfma_f32_16x16x32_bf16 v[36:39], a[196:199], a[216:219], v[36:39]
    v_mfma_f32_16x16x32_bf16 v[32:35], a[196:199], a[220:223], v[32:35]
    s_nop 0
    v_mfma_f32_16x16x32_bf16 v[28:31], a[196:199], a[224:227], v[28:31]
    v_mfma_f32_16x16x32_bf16 v[24:27], a[196:199], a[228:231], v[24:27]
    s_waitcnt lgkmcnt(0)
    v_mfma_f32_16x16x32_bf16 a[84:87], a[88:91], a[128:131], a[84:87]
    v_mfma_f32_16x16x32_bf16 a[80:83], a[88:91], a[132:135], a[80:83]
    s_waitcnt vmcnt(18)
    s_barrier
    v_mfma_f32_16x16x32_bf16 a[76:79], a[88:91], a[136:139], a[76:79]
    ds_read_b64_tr_b16 a[160:161], v11 offset:36864
    v_mfma_f32_16x16x32_bf16 a[72:75], a[88:91], a[140:143], a[72:75]
    s_nop 0
    v_mfma_f32_16x16x32_bf16 a[68:71], a[88:91], a[144:147], a[68:71]
    ds_read_b64_tr_b16 a[162:163], v11 offset:37888
    v_mfma_f32_16x16x32_bf16 a[64:67], a[88:91], a[148:151], a[64:67]
    v_mfma_f32_16x16x32_bf16 a[60:63], a[88:91], a[152:155], a[60:63]
    ds_read_b128 a[200:203], v9 offset:36864
    v_mfma_f32_16x16x32_bf16 a[56:59], a[88:91], a[156:159], a[56:59]
    v_mfma_f32_16x16x32_bf16 a[52:55], a[92:95], a[128:131], a[52:55]
    ds_read_b128 a[204:207], v9 offset:37120
    v_mfma_f32_16x16x32_bf16 a[48:51], a[92:95], a[132:135], a[48:51]
    v_mfma_f32_16x16x32_bf16 a[44:47], a[92:95], a[136:139], a[44:47]
    ds_read_b128 a[208:211], v9 offset:38912
    v_mfma_f32_16x16x32_bf16 a[40:43], a[92:95], a[140:143], a[40:43]
    v_mfma_f32_16x16x32_bf16 a[36:39], a[92:95], a[144:147], a[36:39]
    ds_read_b128 a[212:215], v9 offset:39168
    v_mfma_f32_16x16x32_bf16 a[32:35], a[92:95], a[148:151], a[32:35]
    v_mfma_f32_16x16x32_bf16 a[28:31], a[92:95], a[152:155], a[28:31]
    ds_read_b128 a[216:219], v9 offset:40960
    v_mfma_f32_16x16x32_bf16 a[24:27], a[92:95], a[156:159], a[24:27]
    v_mfma_f32_16x16x32_bf16 a[20:23], a[96:99], a[128:131], a[20:23]
    ds_read_b128 a[220:223], v9 offset:41216
    v_mfma_f32_16x16x32_bf16 a[16:19], a[96:99], a[132:135], a[16:19]
    v_mfma_f32_16x16x32_bf16 a[12:15], a[96:99], a[136:139], a[12:15]
    ds_read_b128 a[224:227], v9 offset:43008
    v_mfma_f32_16x16x32_bf16 a[8:11], a[96:99], a[140:143], a[8:11]
    v_mfma_f32_16x16x32_bf16 a[4:7], a[96:99], a[144:147], a[4:7]
    ds_read_b128 a[228:231], v9 offset:43264
    v_mfma_f32_16x16x32_bf16 a[0:3], a[96:99], a[148:151], a[0:3]
    v_mfma_f32_16x16x32_bf16 v[252:255], a[96:99], a[152:155], v[252:255]
    ds_read_b64_tr_b16 a[164:165], v13 offset:36864
    v_mfma_f32_16x16x32_bf16 v[248:251], a[96:99], a[156:159], v[248:251]
    v_mfma_f32_16x16x32_bf16 v[244:247], a[100:103], a[128:131], v[244:247]
    ds_read_b64_tr_b16 a[166:167], v13 offset:37888
    v_mfma_f32_16x16x32_bf16 v[240:243], a[100:103], a[132:135], v[240:243]
    v_mfma_f32_16x16x32_bf16 v[236:239], a[100:103], a[136:139], v[236:239]
    ds_read_b64_tr_b16 a[168:169], v11 offset:38912
    v_mfma_f32_16x16x32_bf16 v[232:235], a[100:103], a[140:143], v[232:235]
    v_mfma_f32_16x16x32_bf16 v[228:231], a[100:103], a[144:147], v[228:231]
    ds_read_b64_tr_b16 a[170:171], v11 offset:39936
    v_mfma_f32_16x16x32_bf16 v[224:227], a[100:103], a[148:151], v[224:227]
    v_mfma_f32_16x16x32_bf16 v[220:223], a[100:103], a[152:155], v[220:223]
    ds_read_b64_tr_b16 a[172:173], v13 offset:38912
    v_mfma_f32_16x16x32_bf16 v[216:219], a[100:103], a[156:159], v[216:219]
    v_mfma_f32_16x16x32_bf16 v[212:215], a[104:107], a[128:131], v[212:215]
    ds_read_b64_tr_b16 a[174:175], v13 offset:39936
    v_mfma_f32_16x16x32_bf16 v[208:211], a[104:107], a[132:135], v[208:211]
    v_mfma_f32_16x16x32_bf16 v[204:207], a[104:107], a[136:139], v[204:207]
    ds_read_b64_tr_b16 a[176:177], v11 offset:40960
    v_mfma_f32_16x16x32_bf16 v[200:203], a[104:107], a[140:143], v[200:203]
    v_mfma_f32_16x16x32_bf16 v[196:199], a[104:107], a[144:147], v[196:199]
    ds_read_b64_tr_b16 a[178:179], v11 offset:41984
    v_mfma_f32_16x16x32_bf16 v[192:195], a[104:107], a[148:151], v[192:195]
    v_mfma_f32_16x16x32_bf16 v[188:191], a[104:107], a[152:155], v[188:191]
    ds_read_b64_tr_b16 a[180:181], v13 offset:40960
    v_mfma_f32_16x16x32_bf16 v[184:187], a[104:107], a[156:159], v[184:187]
    v_mfma_f32_16x16x32_bf16 v[180:183], a[108:111], a[128:131], v[180:183]
    ds_read_b64_tr_b16 a[182:183], v13 offset:41984
    v_mfma_f32_16x16x32_bf16 v[176:179], a[108:111], a[132:135], v[176:179]
    v_mfma_f32_16x16x32_bf16 v[172:175], a[108:111], a[136:139], v[172:175]
    ds_read_b64_tr_b16 a[184:185], v11 offset:43008
    v_mfma_f32_16x16x32_bf16 v[168:171], a[108:111], a[140:143], v[168:171]
    v_mfma_f32_16x16x32_bf16 v[164:167], a[108:111], a[144:147], v[164:167]
    ds_read_b64_tr_b16 a[186:187], v11 offset:44032
    v_mfma_f32_16x16x32_bf16 v[160:163], a[108:111], a[148:151], v[160:163]
    v_mfma_f32_16x16x32_bf16 v[156:159], a[108:111], a[152:155], v[156:159]
    ds_read_b64_tr_b16 a[188:189], v13 offset:43008
    v_mfma_f32_16x16x32_bf16 v[152:155], a[108:111], a[156:159], v[152:155]
    v_mfma_f32_16x16x32_bf16 v[148:151], a[112:115], a[128:131], v[148:151]
    ds_read_b64_tr_b16 a[190:191], v13 offset:44032
    v_mfma_f32_16x16x32_bf16 v[144:147], a[112:115], a[132:135], v[144:147]
    v_mfma_f32_16x16x32_bf16 v[140:143], a[112:115], a[136:139], v[140:143]
    ds_read_b64_tr_b16 a[192:193], v11 offset:45056
    v_mfma_f32_16x16x32_bf16 v[136:139], a[112:115], a[140:143], v[136:139]
    v_mfma_f32_16x16x32_bf16 v[132:135], a[112:115], a[144:147], v[132:135]
    ds_read_b64_tr_b16 a[194:195], v11 offset:46080
    v_mfma_f32_16x16x32_bf16 v[128:131], a[112:115], a[148:151], v[128:131]
    v_mfma_f32_16x16x32_bf16 v[124:127], a[112:115], a[152:155], v[124:127]
    ds_read_b64_tr_b16 a[196:197], v13 offset:45056
    v_mfma_f32_16x16x32_bf16 v[120:123], a[112:115], a[156:159], v[120:123]
    v_mfma_f32_16x16x32_bf16 v[116:119], a[116:119], a[128:131], v[116:119]
    ds_read_b64_tr_b16 a[198:199], v13 offset:46080
    v_mfma_f32_16x16x32_bf16 v[112:115], a[116:119], a[132:135], v[112:115]
    v_mfma_f32_16x16x32_bf16 v[108:111], a[116:119], a[136:139], v[108:111]
    v_mfma_f32_16x16x32_bf16 v[104:107], a[116:119], a[140:143], v[104:107]
    v_mfma_f32_16x16x32_bf16 v[100:103], a[116:119], a[144:147], v[100:103]
    v_mfma_f32_16x16x32_bf16 v[96:99], a[116:119], a[148:151], v[96:99]
    v_mfma_f32_16x16x32_bf16 v[92:95], a[116:119], a[152:155], v[92:95]
    v_mfma_f32_16x16x32_bf16 v[88:91], a[116:119], a[156:159], v[88:91]
    v_mfma_f32_16x16x32_bf16 v[84:87], a[120:123], a[128:131], v[84:87]
    v_mfma_f32_16x16x32_bf16 v[80:83], a[120:123], a[132:135], v[80:83]
    v_mfma_f32_16x16x32_bf16 v[76:79], a[120:123], a[136:139], v[76:79]
    v_mfma_f32_16x16x32_bf16 v[72:75], a[120:123], a[140:143], v[72:75]
    v_mfma_f32_16x16x32_bf16 v[68:71], a[120:123], a[144:147], v[68:71]
    v_mfma_f32_16x16x32_bf16 v[64:67], a[120:123], a[148:151], v[64:67]
    v_mfma_f32_16x16x32_bf16 v[60:63], a[120:123], a[152:155], v[60:63]
    v_mfma_f32_16x16x32_bf16 v[56:59], a[120:123], a[156:159], v[56:59]
    v_mfma_f32_16x16x32_bf16 v[52:55], a[124:127], a[128:131], v[52:55]
    v_mfma_f32_16x16x32_bf16 v[48:51], a[124:127], a[132:135], v[48:51]
    v_mfma_f32_16x16x32_bf16 v[44:47], a[124:127], a[136:139], v[44:47]
    v_mfma_f32_16x16x32_bf16 v[40:43], a[124:127], a[140:143], v[40:43]
    v_mfma_f32_16x16x32_bf16 v[36:39], a[124:127], a[144:147], v[36:39]
    v_mfma_f32_16x16x32_bf16 v[32:35], a[124:127], a[148:151], v[32:35]
    v_mfma_f32_16x16x32_bf16 v[28:31], a[124:127], a[152:155], v[28:31]
    v_mfma_f32_16x16x32_bf16 v[24:27], a[124:127], a[156:159], v[24:27]
L_code_a:
    s_cmp_eq_u32 s77, 2
    s_cbranch_scc1 L_g1_w2
    s_waitcnt lgkmcnt(0)
    v_mfma_f32_16x16x32_bf16 v[84:87], a[192:195], a[200:203], v[84:87]
    s_load_dwordx2 s[4:5], s[0:1], 16
    s_load_dwordx2 s[6:7], s[0:1], 48
    s_load_dwordx2 s[8:9], s[0:1], 0
    s_load_dwordx2 s[34:35], s[0:1], 56
    v_mfma_f32_16x16x32_bf16 v[52:55], a[196:199], a[200:203], v[52:55]
    s_barrier
    s_lshl_b32 s75, s14, 14
    v_add_u32 v13, s75, v1
    v_mfma_f32_16x16x32_bf16 v[80:83], a[192:195], a[204:207], v[80:83]
    v_lshlrev_b32 v8, 3, v0
    v_mfma_f32_16x16x32_bf16 v[48:51], a[196:199], a[204:207], v[48:51]
    v_mfma_f32_16x16x32_bf16 v[76:79], a[192:195], a[208:211], v[76:79]
    v_mfma_f32_16x16x32_bf16 v[44:47], a[196:199], a[208:211], v[44:47]
    v_mfma_f32_16x16x32_bf16 v[72:75], a[192:195], a[212:215], v[72:75]
    v_pk_mul_f32 v[84:85], v[84:85], s[84:85]
    v_pk_mul_f32 v[86:87], v[86:87], s[84:85]
    v_mfma_f32_16x16x32_bf16 v[40:43], a[196:199], a[212:215], v[40:43]
    v_pk_mul_f32 v[52:53], v[52:53], s[84:85]
    v_pk_mul_f32 v[54:55], v[54:55], s[84:85]
    v_mfma_f32_16x16x32_bf16 v[68:71], a[192:195], a[216:219], v[68:71]
    v_cvt_pk_bf16_f32 v84, v84, v85
    v_cvt_pk_bf16_f32 v85, v86, v87
    v_mfma_f32_16x16x32_bf16 v[36:39], a[196:199], a[216:219], v[36:39]
    v_cvt_pk_bf16_f32 v86, v52, v53
    v_cvt_pk_bf16_f32 v87, v54, v55
    v_mfma_f32_16x16x32_bf16 v[64:67], a[192:195], a[220:223], v[64:67]
    buffer_store_dwordx4 v[84:87], v22, s[20:23], s76 offen offset:0
    v_pk_mul_f32 v[80:81], v[80:81], s[84:85]
    v_mfma_f32_16x16x32_bf16 v[32:35], a[196:199], a[220:223], v[32:35]
    v_pk_mul_f32 v[82:83], v[82:83], s[84:85]
    v_pk_mul_f32 v[48:49], v[48:49], s[84:85]
    v_mfma_f32_16x16x32_bf16 v[60:63], a[192:195], a[224:227], v[60:63]
    v_pk_mul_f32 v[50:51], v[50:51], s[84:85]
    v_cvt_pk_bf16_f32 v80, v80, v81
    v_mfma_f32_16x16x32_bf16 v[28:31], a[196:199], a[224:227], v[28:31]
    v_cvt_pk_bf16_f32 v81, v82, v83
    v_cvt_pk_bf16_f32 v82, v48, v49
    v_mfma_f32_16x16x32_bf16 v[56:59], a[192:195], a[228:231], v[56:59]
    v_cvt_pk_bf16_f32 v83, v50, v51
    buffer_store_dwordx4 v[80:83], v22, s[20:23], s76 offen offset:256
    v_mfma_f32_16x16x32_bf16 v[24:27], a[196:199], a[228:231], v[24:27]
    v_pk_mul_f32 v[76:77], v[76:77], s[84:85]
    v_pk_mul_f32 v[78:79], v[78:79], s[84:85]
    v_mfma_f32_16x16x32_bf16 v[212:215], a[176:179], a[200:203], v[212:215]
    v_pk_mul_f32 v[44:45], v[44:45], s[84:85]
    v_pk_mul_f32 v[46:47], v[46:47], s[84:85]
    v_mfma_f32_16x16x32_bf16 v[180:183], a[180:183], a[200:203], v[180:183]
    v_cvt_pk_bf16_f32 v76, v76, v77
    v_cvt_pk_bf16_f32 v77, v78, v79
    v_mfma_f32_16x16x32_bf16 v[148:151], a[184:187], a[200:203], v[148:151]
    v_cvt_pk_bf16_f32 v78, v44, v45
    v_cvt_pk_bf16_f32 v79, v46, v47
    v_mfma_f32_16x16x32_bf16 v[116:119], a[188:191], a[200:203], v[116:119]
    buffer_store_dwordx4 v[76:79], v22, s[20:23], s76 offen offset:2048
    v_pk_mul_f32 v[72:73], v[72:73], s[84:85]
    v_mfma_f32_16x16x32_bf16 v[208:211], a[176:179], a[204:207], v[208:211]
    v_pk_mul_f32 v[74:75], v[74:75], s[84:85]
    v_pk_mul_f32 v[40:41], v[40:41], s[84:85]
    v_mfma_f32_16x16x32_bf16 v[176:179], a[180:183], a[204:207], v[176:179]
    v_pk_mul_f32 v[42:43], v[42:43], s[84:85]
    v_cvt_pk_bf16_f32 v72, v72, v73
    v_mfma_f32_16x16x32_bf16 v[144:147], a[184:187], a[204:207], v[144:147]
    v_cvt_pk_bf16_f32 v73, v74, v75
    v_cvt_pk_bf16_f32 v74, v40, v41
    v_mfma_f32_16x16x32_bf16 v[112:115], a[188:191], a[204:207], v[112:115]
    v_cvt_pk_bf16_f32 v75, v42, v43
    buffer_store_dwordx4 v[72:75], v22, s[20:23], s76 offen offset:2304
    v_mfma_f32_16x16x32_bf16 v[204:207], a[176:179], a[208:211], v[204:207]
    v_pk_mul_f32 v[68:69], v[68:69], s[84:85]
    v_pk_mul_f32 v[70:71], v[70:71], s[84:85]
    v_mfma_f32_16x16x32_bf16 v[172:175], a[180:183], a[208:211], v[172:175]
    v_pk_mul_f32 v[36:37], v[36:37], s[84:85]
    v_pk_mul_f32 v[38:39], v[38:39], s[84:85]
    v_mfma_f32_16x16x32_bf16 v[140:143], a[184:187], a[208:211], v[140:143]
    v_cvt_pk_bf16_f32 v68, v68, v69
    v_cvt_pk_bf16_f32 v69, v70, v71
    v_mfma_f32_16x16x32_bf16 v[108:111], a[188:191], a[208:211], v[108:111]
    v_cvt_pk_bf16_f32 v70, v36, v37
    v_cvt_pk_bf16_f32 v71, v38, v39
    v_mfma_f32_16x16x32_bf16 v[200:203], a[176:179], a[212:215], v[200:203]
    s_add_u32 s76, s76, 4096
    buffer_store_dwordx4 v[68:71], v22, s[20:23], s76 offen offset:0
    v_mfma_f32_16x16x32_bf16 v[168:171], a[180:183], a[212:215], v[168:171]
    v_pk_mul_f32 v[64:65], v[64:65], s[84:85]
    v_pk_mul_f32 v[66:67], v[66:67], s[84:85]
    v_mfma_f32_16x16x32_bf16 v[136:139], a[184:187], a[212:215], v[136:139]
    v_pk_mul_f32 v[32:33], v[32:33], s[84:85]
    v_pk_mul_f32 v[34:35], v[34:35], s[84:85]
    v_mfma_f32_16x16x32_bf16 v[104:107], a[188:191], a[212:215], v[104:107]
    v_cvt_pk_bf16_f32 v64, v64, v65
    v_cvt_pk_bf16_f32 v65, v66, v67
    v_mfma_f32_16x16x32_bf16 v[196:199], a[176:179], a[216:219], v[196:199]
    v_cvt_pk_bf16_f32 v66, v32, v33
    v_cvt_pk_bf16_f32 v67, v34, v35
    v_mfma_f32_16x16x32_bf16 v[164:167], a[180:183], a[216:219], v[164:167]
    buffer_store_dwordx4 v[64:67], v22, s[20:23], s76 offen offset:256
    v_pk_mul_f32 v[60:61], v[60:61], s[84:85]
    v_mfma_f32_16x16x32_bf16 v[132:135], a[184:187], a[216:219], v[132:135]
    v_pk_mul_f32 v[62:63], v[62:63], s[84:85]
    v_pk_mul_f32 v[28:29], v[28:29], s[84:85]
    v_mfma_f32_16x16x32_bf16 v[100:103], a[188:191], a[216:219], v[100:103]
    v_pk_mul_f32 v[30:31], v[30:31], s[84:85]
    v_cvt_pk_bf16_f32 v60, v60, v61
    v_mfma_f32_16x16x32_bf16 v[192:195], a[176:179], a[220:223], v[192:195]
    v_cvt_pk_bf16_f32 v61, v62, v63
    v_cvt_pk_bf16_f32 v62, v28, v29
    v_mfma_f32_16x16x32_bf16 v[160:163], a[180:183], a[220:223], v[160:163]
    v_cvt_pk_bf16_f32 v63, v30, v31
    buffer_store_dwordx4 v[60:63], v22, s[20:23], s76 offen offset:2048
    v_mfma_f32_16x16x32_bf16 v[128:131], a[184:187], a[220:223], v[128:131]
    v_pk_mul_f32 v[56:57], v[56:57], s[84:85]
    v_pk_mul_f32 v[58:59], v[58:59], s[84:85]
    v_mfma_f32_16x16x32_bf16 v[96:99], a[188:191], a[220:223], v[96:99]
    v_pk_mul_f32 v[24:25], v[24:25], s[84:85]
    v_pk_mul_f32 v[26:27], v[26:27], s[84:85]
    v_mfma_f32_16x16x32_bf16 v[188:191], a[176:179], a[224:227], v[188:191]
    v_cvt_pk_bf16_f32 v56, v56, v57
    v_cvt_pk_bf16_f32 v57, v58, v59
    v_mfma_f32_16x16x32_bf16 v[156:159], a[180:183], a[224:227], v[156:159]
    v_cvt_pk_bf16_f32 v58, v24, v25
    v_cvt_pk_bf16_f32 v59, v26, v27
    v_mfma_f32_16x16x32_bf16 v[124:127], a[184:187], a[224:227], v[124:127]
    buffer_store_dwordx4 v[56:59], v22, s[20:23], s76 offen offset:2304
    s_add_u32 s76, s76, 126976
    v_mfma_f32_16x16x32_bf16 v[92:95], a[188:191], a[224:227], v[92:95]
    v_pk_mul_f32 v[212:213], v[212:213], s[72:73]
    v_pk_mul_f32 v[214:215], v[214:215], s[72:73]
    v_mfma_f32_16x16x32_bf16 v[184:187], a[176:179], a[228:231], v[184:187]
    v_pk_mul_f32 v[180:181], v[180:181], s[72:73]
    v_pk_mul_f32 v[182:183], v[182:183], s[72:73]
    v_mfma_f32_16x16x32_bf16 v[152:155], a[180:183], a[228:231], v[152:155]
    v_exp_f32 v212, v212
    v_mfma_f32_16x16x32_bf16 v[120:123], a[184:187], a[228:231], v[120:123]
    v_exp_f32 v213, v213
    v_mfma_f32_16x16x32_bf16 v[88:91], a[188:191], a[228:231], v[88:91]
    v_exp_f32 v214, v214
    v_mfma_f32_16x16x32_bf16 a[84:87], a[160:163], a[200:203], a[84:87]
    v_exp_f32 v215, v215
    v_mfma_f32_16x16x32_bf16 a[52:55], a[164:167], a[200:203], a[52:55]
    v_exp_f32 v180, v180
    v_mfma_f32_16x16x32_bf16 a[20:23], a[168:171], a[200:203], a[20:23]
    v_exp_f32 v181, v181
    v_mfma_f32_16x16x32_bf16 v[244:247], a[172:175], a[200:203], v[244:247]
    v_exp_f32 v182, v182
    v_mfma_f32_16x16x32_bf16 a[80:83], a[160:163], a[204:207], a[80:83]
    v_exp_f32 v183, v183
    v_mfma_f32_16x16x32_bf16 a[48:51], a[164:167], a[204:207], a[48:51]
    v_pk_add_f32 v[212:213], v[212:213], s[86:87]
    v_pk_add_f32 v[214:215], v[214:215], s[86:87]
    v_mfma_f32_16x16x32_bf16 a[16:19], a[168:171], a[204:207], a[16:19]
    v_pk_add_f32 v[180:181], v[180:181], s[86:87]
    v_pk_add_f32 v[182:183], v[182:183], s[86:87]
    v_mfma_f32_16x16x32_bf16 v[240:243], a[172:175], a[204:207], v[240:243]
    v_rcp_f32 v212, v212
    v_mfma_f32_16x16x32_bf16 a[76:79], a[160:163], a[208:211], a[76:79]
    v_rcp_f32 v213, v213
    v_mfma_f32_16x16x32_bf16 a[44:47], a[164:167], a[208:211], a[44:47]
    v_rcp_f32 v214, v214
    v_mfma_f32_16x16x32_bf16 a[12:15], a[168:171], a[208:211], a[12:15]
    v_rcp_f32 v215, v215
    v_mfma_f32_16x16x32_bf16 v[236:239], a[172:175], a[208:211], v[236:239]
    v_rcp_f32 v180, v180
    v_mfma_f32_16x16x32_bf16 a[72:75], a[160:163], a[212:215], a[72:75]
    v_rcp_f32 v181, v181
    v_mfma_f32_16x16x32_bf16 a[40:43], a[164:167], a[212:215], a[40:43]
    v_rcp_f32 v182, v182
    v_mfma_f32_16x16x32_bf16 a[8:11], a[168:171], a[212:215], a[8:11]
    v_rcp_f32 v183, v183
    v_mfma_f32_16x16x32_bf16 v[232:235], a[172:175], a[212:215], v[232:235]
    v_pk_mul_f32 v[212:213], v[212:213], v[148:149]
    v_pk_mul_f32 v[214:215], v[214:215], v[150:151]
    v_mfma_f32_16x16x32_bf16 a[68:71], a[160:163], a[216:219], a[68:71]
    v_pk_mul_f32 v[180:181], v[180:181], v[116:117]
    v_pk_mul_f32 v[182:183], v[182:183], v[118:119]
    v_mfma_f32_16x16x32_bf16 a[36:39], a[164:167], a[216:219], a[36:39]
    v_cvt_pk_bf16_f32 v148, v212, v213
    v_cvt_pk_bf16_f32 v149, v214, v215
    v_mfma_f32_16x16x32_bf16 a[4:7], a[168:171], a[216:219], a[4:7]
    v_cvt_pk_bf16_f32 v150, v180, v181
    v_cvt_pk_bf16_f32 v151, v182, v183
    v_mfma_f32_16x16x32_bf16 v[228:231], a[172:175], a[216:219], v[228:231]
    ds_write_b128 v13, v[148:151] offset:2048
    v_pk_mul_f32 v[208:209], v[208:209], s[72:73]
    v_mfma_f32_16x16x32_bf16 a[64:67], a[160:163], a[220:223], a[64:67]
    v_pk_mul_f32 v[210:211], v[210:211], s[72:73]
    v_pk_mul_f32 v[176:177], v[176:177], s[72:73]
    v_mfma_f32_16x16x32_bf16 a[32:35], a[164:167], a[220:223], a[32:35]
    v_pk_mul_f32 v[178:179], v[178:179], s[72:73]
    v_mfma_f32_16x16x32_bf16 a[0:3], a[168:171], a[220:223], a[0:3]
    v_exp_f32 v208, v208
    v_mfma_f32_16x16x32_bf16 v[224:227], a[172:175], a[220:223], v[224:227]
    v_exp_f32 v209, v209
    v_mfma_f32_16x16x32_bf16 a[60:63], a[160:163], a[224:227], a[60:63]
    v_exp_f32 v210, v210
    v_mfma_f32_16x16x32_bf16 a[28:31], a[164:167], a[224:227], a[28:31]
    v_exp_f32 v211, v211
    v_mfma_f32_16x16x32_bf16 v[252:255], a[168:171], a[224:227], v[252:255]
    v_exp_f32 v176, v176
    v_mfma_f32_16x16x32_bf16 v[220:223], a[172:175], a[224:227], v[220:223]
    v_exp_f32 v177, v177
    v_mfma_f32_16x16x32_bf16 a[56:59], a[160:163], a[228:231], a[56:59]
    v_exp_f32 v178, v178
    v_mfma_f32_16x16x32_bf16 a[24:27], a[164:167], a[228:231], a[24:27]
    v_exp_f32 v179, v179
    v_mfma_f32_16x16x32_bf16 v[248:251], a[168:171], a[228:231], v[248:251]
    v_pk_add_f32 v[208:209], v[208:209], s[86:87]
    v_pk_add_f32 v[210:211], v[210:211], s[86:87]
    v_mfma_f32_16x16x32_bf16 v[216:219], a[172:175], a[228:231], v[216:219]
    v_pk_add_f32 v[176:177], v[176:177], s[86:87]
    v_pk_add_f32 v[178:179], v[178:179], s[86:87]
    s_nop 7
    v_rcp_f32 v208, v208
    v_rcp_f32 v209, v209
    v_rcp_f32 v210, v210
    v_rcp_f32 v211, v211
    v_rcp_f32 v176, v176
    v_rcp_f32 v177, v177
    v_rcp_f32 v178, v178
    v_rcp_f32 v179, v179
    v_pk_mul_f32 v[208:209], v[208:209], v[144:145]
    v_pk_mul_f32 v[210:211], v[210:211], v[146:147]
    v_pk_mul_f32 v[176:177], v[176:177], v[112:113]
    v_pk_mul_f32 v[178:179], v[178:179], v[114:115]
    v_cvt_pk_bf16_f32 v144, v208, v209
    v_cvt_pk_bf16_f32 v145, v210, v211
    v_cvt_pk_bf16_f32 v146, v176, v177
    v_cvt_pk_bf16_f32 v147, v178, v179
    ds_write_b128 v13, v[144:147] offset:3072
    s_waitcnt vmcnt(0)
    v_mov_b32 v12, 1
    s_cmp_lg_u32 s93, 0
    s_cbranch_scc1 L_g1_rm1
    s_mov_b64 exec, 1
    buffer_store_dword v12, off, s[24:27], s29
    s_mov_b64 exec, -1
L_g1_rr1:
    v_pk_mul_f32 v[204:205], v[204:205], s[72:73]
    v_pk_mul_f32 v[206:207], v[206:207], s[72:73]
    v_pk_mul_f32 v[172:173], v[172:173], s[72:73]
    v_pk_mul_f32 v[174:175], v[174:175], s[72:73]
    v_exp_f32 v204, v204
    v_exp_f32 v205, v205
    v_exp_f32 v206, v206
    v_exp_f32 v207, v207
    v_exp_f32 v172, v172
    v_exp_f32 v173, v173
    v_exp_f32 v174, v174
    v_exp_f32 v175, v175
    v_pk_add_f32 v[204:205], v[204:205], s[86:87]
    v_pk_add_f32 v[206:207], v[206:207], s[86:87]
    v_pk_add_f32 v[172:173], v[172:173], s[86:87]
    v_pk_add_f32 v[174:175], v[174:175], s[86:87]
    v_rcp_f32 v204, v204
    v_rcp_f32 v205, v205
    v_rcp_f32 v206, v206
    v_rcp_f32 v207, v207
    v_rcp_f32 v172, v172
    v_rcp_f32 v173, v173
    v_rcp_f32 v174, v174
    v_rcp_f32 v175, v175
    v_pk_mul_f32 v[204:205], v[204:205], v[140:141]
    v_pk_mul_f32 v[206:207], v[206:207], v[142:143]
    v_pk_mul_f32 v[172:173], v[172:173], v[108:109]
    v_pk_mul_f32 v[174:175], v[174:175], v[110:111]
    v_cvt_pk_bf16_f32 v140, v204, v205
    v_cvt_pk_bf16_f32 v141, v206, v207
    v_cvt_pk_bf16_f32 v142, v172, v173
    v_cvt_pk_bf16_f32 v143, v174, v175
    ds_write_b128 v13, v[140:143] offset:6144
    v_pk_mul_f32 v[200:201], v[200:201], s[72:73]
    v_pk_mul_f32 v[202:203], v[202:203], s[72:73]
    v_pk_mul_f32 v[168:169], v[168:169], s[72:73]
    v_pk_mul_f32 v[170:171], v[170:171], s[72:73]
    v_exp_f32 v200, v200
    v_exp_f32 v201, v201
    v_exp_f32 v202, v202
    v_exp_f32 v203, v203
    v_exp_f32 v168, v168
    v_exp_f32 v169, v169
    v_exp_f32 v170, v170
    v_exp_f32 v171, v171
    v_pk_add_f32 v[200:201], v[200:201], s[86:87]
    v_pk_add_f32 v[202:203], v[202:203], s[86:87]
    v_pk_add_f32 v[168:169], v[168:169], s[86:87]
    v_pk_add_f32 v[170:171], v[170:171], s[86:87]
    v_rcp_f32 v200, v200
    v_rcp_f32 v201, v201
    v_rcp_f32 v202, v202
    v_rcp_f32 v203, v203
    v_rcp_f32 v168, v168
    v_rcp_f32 v169, v169
    v_rcp_f32 v170, v170
    v_rcp_f32 v171, v171
    v_pk_mul_f32 v[200:201], v[200:201], v[136:137]
    v_pk_mul_f32 v[202:203], v[202:203], v[138:139]
    v_pk_mul_f32 v[168:169], v[168:169], v[104:105]
    v_pk_mul_f32 v[170:171], v[170:171], v[106:107]
    v_cvt_pk_bf16_f32 v136, v200, v201
    v_cvt_pk_bf16_f32 v137, v202, v203
    v_cvt_pk_bf16_f32 v138, v168, v169
    v_cvt_pk_bf16_f32 v139, v170, v171
    ds_write_b128 v13, v[136:139] offset:7168
    v_pk_mul_f32 v[196:197], v[196:197], s[72:73]
    v_pk_mul_f32 v[198:199], v[198:199], s[72:73]
    v_pk_mul_f32 v[164:165], v[164:165], s[72:73]
    v_pk_mul_f32 v[166:167], v[166:167], s[72:73]
    v_exp_f32 v196, v196
    v_exp_f32 v197, v197
    v_exp_f32 v198, v198
    v_exp_f32 v199, v199
    v_exp_f32 v164, v164
    v_exp_f32 v165, v165
    v_exp_f32 v166, v166
    v_exp_f32 v167, v167
    v_pk_add_f32 v[196:197], v[196:197], s[86:87]
    v_pk_add_f32 v[198:199], v[198:199], s[86:87]
    v_pk_add_f32 v[164:165], v[164:165], s[86:87]
    v_pk_add_f32 v[166:167], v[166:167], s[86:87]
    v_rcp_f32 v196, v196
    v_rcp_f32 v197, v197
    v_rcp_f32 v198, v198
    v_rcp_f32 v199, v199
    v_rcp_f32 v164, v164
    v_rcp_f32 v165, v165
    v_rcp_f32 v166, v166
    v_rcp_f32 v167, v167
    v_pk_mul_f32 v[196:197], v[196:197], v[132:133]
    v_pk_mul_f32 v[198:199], v[198:199], v[134:135]
    v_pk_mul_f32 v[164:165], v[164:165], v[100:101]
    v_pk_mul_f32 v[166:167], v[166:167], v[102:103]
    v_cvt_pk_bf16_f32 v132, v196, v197
    v_cvt_pk_bf16_f32 v133, v198, v199
    v_cvt_pk_bf16_f32 v134, v164, v165
    v_cvt_pk_bf16_f32 v135, v166, v167
    ds_write_b128 v13, v[132:135] offset:10240
    v_pk_mul_f32 v[192:193], v[192:193], s[72:73]
    v_pk_mul_f32 v[194:195], v[194:195], s[72:73]
    v_pk_mul_f32 v[160:161], v[160:161], s[72:73]
    v_pk_mul_f32 v[162:163], v[162:163], s[72:73]
    v_exp_f32 v192, v192
    v_exp_f32 v193, v193
    v_exp_f32 v194, v194
    v_exp_f32 v195, v195
    v_exp_f32 v160, v160
    v_exp_f32 v161, v161
    v_exp_f32 v162, v162
    v_exp_f32 v163, v163
    v_pk_add_f32 v[192:193], v[192:193], s[86:87]
    v_pk_add_f32 v[194:195], v[194:195], s[86:87]
    v_pk_add_f32 v[160:161], v[160:161], s[86:87]
    v_pk_add_f32 v[162:163], v[162:163], s[86:87]
    v_rcp_f32 v192, v192
    v_rcp_f32 v193, v193
    v_rcp_f32 v194, v194
    v_rcp_f32 v195, v195
    v_rcp_f32 v160, v160
    v_rcp_f32 v161, v161
    v_rcp_f32 v162, v162
    v_rcp_f32 v163, v163
    v_pk_mul_f32 v[192:193], v[192:193], v[128:129]
    v_pk_mul_f32 v[194:195], v[194:195], v[130:131]
    v_pk_mul_f32 v[160:161], v[160:161], v[96:97]
    v_pk_mul_f32 v[162:163], v[162:163], v[98:99]
    v_cvt_pk_bf16_f32 v128, v192, v193
    v_cvt_pk_bf16_f32 v129, v194, v195
    v_cvt_pk_bf16_f32 v130, v160, v161
    v_cvt_pk_bf16_f32 v131, v162, v163
    ds_write_b128 v13, v[128:131] offset:11264
    v_pk_mul_f32 v[188:189], v[188:189], s[72:73]
    v_pk_mul_f32 v[190:191], v[190:191], s[72:73]
    v_pk_mul_f32 v[156:157], v[156:157], s[72:73]
    v_pk_mul_f32 v[158:159], v[158:159], s[72:73]
    v_exp_f32 v188, v188
    v_exp_f32 v189, v189
    v_exp_f32 v190, v190
    v_exp_f32 v191, v191
    v_exp_f32 v156, v156
    v_exp_f32 v157, v157
    v_exp_f32 v158, v158
    v_exp_f32 v159, v159
    v_pk_add_f32 v[188:189], v[188:189], s[86:87]
    v_pk_add_f32 v[190:191], v[190:191], s[86:87]
    v_pk_add_f32 v[156:157], v[156:157], s[86:87]
    v_pk_add_f32 v[158:159], v[158:159], s[86:87]
    v_rcp_f32 v188, v188
    v_rcp_f32 v189, v189
    v_rcp_f32 v190, v190
    v_rcp_f32 v191, v191
    v_rcp_f32 v156, v156
    v_rcp_f32 v157, v157
    v_rcp_f32 v158, v158
    v_rcp_f32 v159, v159
    v_pk_mul_f32 v[188:189], v[188:189], v[124:125]
    v_pk_mul_f32 v[190:191], v[190:191], v[126:127]
    v_pk_mul_f32 v[156:157], v[156:157], v[92:93]
    v_pk_mul_f32 v[158:159], v[158:159], v[94:95]
    v_cvt_pk_bf16_f32 v124, v188, v189
    v_cvt_pk_bf16_f32 v125, v190, v191
    v_cvt_pk_bf16_f32 v126, v156, v157
    v_cvt_pk_bf16_f32 v127, v158, v159
    ds_write_b128 v13, v[124:127] offset:14336
    v_pk_mul_f32 v[184:185], v[184:185], s[72:73]
    v_pk_mul_f32 v[186:187], v[186:187], s[72:73]
    v_pk_mul_f32 v[152:153], v[152:153], s[72:73]
    v_pk_mul_f32 v[154:155], v[154:155], s[72:73]
    v_exp_f32 v184, v184
    v_exp_f32 v185, v185
    v_exp_f32 v186, v186
    v_exp_f32 v187, v187
    v_exp_f32 v152, v152
    v_exp_f32 v153, v153
    v_exp_f32 v154, v154
    v_exp_f32 v155, v155
    v_pk_add_f32 v[184:185], v[184:185], s[86:87]
    v_pk_add_f32 v[186:187], v[186:187], s[86:87]
    v_pk_add_f32 v[152:153], v[152:153], s[86:87]
    v_pk_add_f32 v[154:155], v[154:155], s[86:87]
    v_rcp_f32 v184, v184
    v_rcp_f32 v185, v185
    v_rcp_f32 v186, v186
    v_rcp_f32 v187, v187
    v_rcp_f32 v152, v152
    v_rcp_f32 v153, v153
    v_rcp_f32 v154, v154
    v_rcp_f32 v155, v155
    v_pk_mul_f32 v[184:185], v[184:185], v[120:121]
    v_pk_mul_f32 v[186:187], v[186:187], v[122:123]
    v_pk_mul_f32 v[152:153], v[152:153], v[88:89]
    v_pk_mul_f32 v[154:155], v[154:155], v[90:91]
    v_cvt_pk_bf16_f32 v120, v184, v185
    v_cvt_pk_bf16_f32 v121, v186, v187
    v_cvt_pk_bf16_f32 v122, v152, v153
    v_cvt_pk_bf16_f32 v123, v154, v155
    ds_write_b128 v13, v[120:123] offset:15360
    v_accvgpr_read_b32 v52, a84
    v_accvgpr_read_b32 v53, a85
    v_accvgpr_read_b32 v54, a86
    v_accvgpr_read_b32 v55, a87
    v_accvgpr_read_b32 v48, a52
    v_accvgpr_read_b32 v49, a53
    v_accvgpr_read_b32 v50, a54
    v_accvgpr_read_b32 v51, a55
    v_accvgpr_read_b32 v44, a20
    v_accvgpr_read_b32 v45, a21
    v_accvgpr_read_b32 v46, a22
    v_accvgpr_read_b32 v47, a23
    v_pk_mul_f32 v[52:53], v[52:53], s[72:73]
    v_pk_mul_f32 v[54:55], v[54:55], s[72:73]
    v_pk_mul_f32 v[48:49], v[48:49], s[72:73]
    v_pk_mul_f32 v[50:51], v[50:51], s[72:73]
    v_exp_f32 v52, v52
    v_exp_f32 v53, v53
    v_exp_f32 v54, v54
    v_exp_f32 v55, v55
    v_exp_f32 v48, v48
    v_exp_f32 v49, v49
    v_exp_f32 v50, v50
    v_exp_f32 v51, v51
    v_pk_add_f32 v[52:53], v[52:53], s[86:87]
    v_pk_add_f32 v[54:55], v[54:55], s[86:87]
    v_pk_add_f32 v[48:49], v[48:49], s[86:87]
    v_pk_add_f32 v[50:51], v[50:51], s[86:87]
    v_rcp_f32 v52, v52
    v_rcp_f32 v53, v53
    v_rcp_f32 v54, v54
    v_rcp_f32 v55, v55
    v_rcp_f32 v48, v48
    v_rcp_f32 v49, v49
    v_rcp_f32 v50, v50
    v_rcp_f32 v51, v51
    v_pk_mul_f32 v[52:53], v[52:53], v[44:45]
    v_pk_mul_f32 v[54:55], v[54:55], v[46:47]
    v_pk_mul_f32 v[48:49], v[48:49], v[244:245]
    v_pk_mul_f32 v[50:51], v[50:51], v[246:247]
    v_cvt_pk_bf16_f32 v44, v52, v53
    v_cvt_pk_bf16_f32 v45, v54, v55
    v_cvt_pk_bf16_f32 v46, v48, v49
    v_cvt_pk_bf16_f32 v47, v50, v51
    ds_write_b128 v13, v[44:47] offset:0
    v_accvgpr_read_b32 v36, a80
    v_accvgpr_read_b32 v37, a81
    v_accvgpr_read_b32 v38, a82
    v_accvgpr_read_b32 v39, a83
    v_accvgpr_read_b32 v32, a48
    v_accvgpr_read_b32 v33, a49
    v_accvgpr_read_b32 v34, a50
    v_accvgpr_read_b32 v35, a51
    v_accvgpr_read_b32 v28, a16
    v_accvgpr_read_b32 v29, a17
    v_accvgpr_read_b32 v30, a18
    v_accvgpr_read_b32 v31, a19
    v_pk_mul_f32 v[36:37], v[36:37], s[72:73]
    v_pk_mul_f32 v[38:39], v[38:39], s[72:73]
    v_pk_mul_f32 v[32:33], v[32:33], s[72:73]
    v_pk_mul_f32 v[34:35], v[34:35], s[72:73]
    v_exp_f32 v36, v36
    v_exp_f32 v37, v37
    v_exp_f32 v38, v38
    v_exp_f32 v39, v39
    v_exp_f32 v32, v32
    v_exp_f32 v33, v33
    v_exp_f32 v34, v34
    v_exp_f32 v35, v35
    v_pk_add_f32 v[36:37], v[36:37], s[86:87]
    v_pk_add_f32 v[38:39], v[38:39], s[86:87]
    v_pk_add_f32 v[32:33], v[32:33], s[86:87]
    v_pk_add_f32 v[34:35], v[34:35], s[86:87]
    v_rcp_f32 v36, v36
    v_rcp_f32 v37, v37
    v_rcp_f32 v38, v38
    v_rcp_f32 v39, v39
    v_rcp_f32 v32, v32
    v_rcp_f32 v33, v33
    v_rcp_f32 v34, v34
    v_rcp_f32 v35, v35
    v_pk_mul_f32 v[36:37], v[36:37], v[28:29]
    v_pk_mul_f32 v[38:39], v[38:39], v[30:31]
    v_pk_mul_f32 v[32:33], v[32:33], v[240:241]
    v_pk_mul_f32 v[34:35], v[34:35], v[242:243]
    v_cvt_pk_bf16_f32 v28, v36, v37
    v_cvt_pk_bf16_f32 v29, v38, v39
    v_cvt_pk_bf16_f32 v30, v32, v33
    v_cvt_pk_bf16_f32 v31, v34, v35
    ds_write_b128 v13, v[28:31] offset:1024
    v_accvgpr_read_b32 v52, a76
    v_accvgpr_read_b32 v53, a77
    v_accvgpr_read_b32 v54, a78
    v_accvgpr_read_b32 v55, a79
    v_accvgpr_read_b32 v48, a44
    v_accvgpr_read_b32 v49, a45
    v_accvgpr_read_b32 v50, a46
    v_accvgpr_read_b32 v51, a47
    v_accvgpr_read_b32 v44, a12
    v_accvgpr_read_b32 v45, a13
    v_accvgpr_read_b32 v46, a14
    v_accvgpr_read_b32 v47, a15
    v_pk_mul_f32 v[52:53], v[52:53], s[72:73]
    v_pk_mul_f32 v[54:55], v[54:55], s[72:73]
    v_pk_mul_f32 v[48:49], v[48:49], s[72:73]
    v_pk_mul_f32 v[50:51], v[50:51], s[72:73]
    v_exp_f32 v52, v52
    v_exp_f32 v53, v53
    v_exp_f32 v54, v54
    v_exp_f32 v55, v55
    v_exp_f32 v48, v48
    v_exp_f32 v49, v49
    v_exp_f32 v50, v50
    v_exp_f32 v51, v51
    v_pk_add_f32 v[52:53], v[52:53], s[86:87]
    v_pk_add_f32 v[54:55], v[54:55], s[86:87]
    v_pk_add_f32 v[48:49], v[48:49], s[86:87]
    v_pk_add_f32 v[50:51], v[50:51], s[86:87]
    v_rcp_f32 v52, v52
    v_rcp_f32 v53, v53
    v_rcp_f32 v54, v54
    v_rcp_f32 v55, v55
    v_rcp_f32 v48, v48
    v_rcp_f32 v49, v49
    v_rcp_f32 v50, v50
    v_rcp_f32 v51, v51
    v_pk_mul_f32 v[52:53], v[52:53], v[44:45]
    v_pk_mul_f32 v[54:55], v[54:55], v[46:47]
    v_pk_mul_f32 v[48:49], v[48:49], v[236:237]
    v_pk_mul_f32 v[50:51], v[50:51], v[238:239]
    v_cvt_pk_bf16_f32 v44, v52, v53
    v_cvt_pk_bf16_f32 v45, v54, v55
    v_cvt_pk_bf16_f32 v46, v48, v49
    v_cvt_pk_bf16_f32 v47, v50, v51
    ds_write_b128 v13, v[44:47] offset:4096
    v_accvgpr_read_b32 v36, a72
    v_accvgpr_read_b32 v37, a73
    v_accvgpr_read_b32 v38, a74
    v_accvgpr_read_b32 v39, a75
    v_accvgpr_read_b32 v32, a40
    v_accvgpr_read_b32 v33, a41
    v_accvgpr_read_b32 v34, a42
    v_accvgpr_read_b32 v35, a43
    v_accvgpr_read_b32 v28, a8
    v_accvgpr_read_b32 v29, a9
    v_accvgpr_read_b32 v30, a10
    v_accvgpr_read_b32 v31, a11
    v_pk_mul_f32 v[36:37], v[36:37], s[72:73]
    v_pk_mul_f32 v[38:39], v[38:39], s[72:73]
    v_pk_mul_f32 v[32:33], v[32:33], s[72:73]
    v_pk_mul_f32 v[34:35], v[34:35], s[72:73]
    v_exp_f32 v36, v36
    v_exp_f32 v37, v37
    v_exp_f32 v38, v38
    v_exp_f32 v39, v39
    v_exp_f32 v32, v32
    v_exp_f32 v33, v33
    v_exp_f32 v34, v34
    v_exp_f32 v35, v35
    v_pk_add_f32 v[36:37], v[36:37], s[86:87]
    v_pk_add_f32 v[38:39], v[38:39], s[86:87]
    v_pk_add_f32 v[32:33], v[32:33], s[86:87]
    v_pk_add_f32 v[34:35], v[34:35], s[86:87]
    v_rcp_f32 v36, v36
    v_rcp_f32 v37, v37
    v_rcp_f32 v38, v38
    v_rcp_f32 v39, v39
    v_rcp_f32 v32, v32
    v_rcp_f32 v33, v33
    v_rcp_f32 v34, v34
    v_rcp_f32 v35, v35
    v_pk_mul_f32 v[36:37], v[36:37], v[28:29]
    v_pk_mul_f32 v[38:39], v[38:39], v[30:31]
    v_pk_mul_f32 v[32:33], v[32:33], v[232:233]
    v_pk_mul_f32 v[34:35], v[34:35], v[234:235]
    v_cvt_pk_bf16_f32 v28, v36, v37
    v_cvt_pk_bf16_f32 v29, v38, v39
    v_cvt_pk_bf16_f32 v30, v32, v33
    v_cvt_pk_bf16_f32 v31, v34, v35
    ds_write_b128 v13, v[28:31] offset:5120
    buffer_load_dwordx2 v[10:11], v8, s[24:27], s28 offen sc1
    v_accvgpr_read_b32 v52, a68
    v_accvgpr_read_b32 v53, a69
    v_accvgpr_read_b32 v54, a70
    v_accvgpr_read_b32 v55, a71
    v_accvgpr_read_b32 v48, a36
    v_accvgpr_read_b32 v49, a37
    v_accvgpr_read_b32 v50, a38
    v_accvgpr_read_b32 v51, a39
    v_accvgpr_read_b32 v44, a4
    v_accvgpr_read_b32 v45, a5
    v_accvgpr_read_b32 v46, a6
    v_accvgpr_read_b32 v47, a7
    v_pk_mul_f32 v[52:53], v[52:53], s[72:73]
    v_pk_mul_f32 v[54:55], v[54:55], s[72:73]
    v_pk_mul_f32 v[48:49], v[48:49], s[72:73]
    v_pk_mul_f32 v[50:51], v[50:51], s[72:73]
    v_exp_f32 v52, v52
    v_exp_f32 v53, v53
    v_exp_f32 v54, v54
    v_exp_f32 v55, v55
    v_exp_f32 v48, v48
    v_exp_f32 v49, v49
    v_exp_f32 v50, v50
    v_exp_f32 v51, v51
    v_pk_add_f32 v[52:53], v[52:53], s[86:87]
    v_pk_add_f32 v[54:55], v[54:55], s[86:87]
    v_pk_add_f32 v[48:49], v[48:49], s[86:87]
    v_pk_add_f32 v[50:51], v[50:51], s[86:87]
    v_rcp_f32 v52, v52
    v_rcp_f32 v53, v53
    v_rcp_f32 v54, v54
    v_rcp_f32 v55, v55
    v_rcp_f32 v48, v48
    v_rcp_f32 v49, v49
    v_rcp_f32 v50, v50
    v_rcp_f32 v51, v51
    v_pk_mul_f32 v[52:53], v[52:53], v[44:45]
    v_pk_mul_f32 v[54:55], v[54:55], v[46:47]
    v_pk_mul_f32 v[48:49], v[48:49], v[228:229]
    v_pk_mul_f32 v[50:51], v[50:51], v[230:231]
    v_cvt_pk_bf16_f32 v44, v52, v53
    v_cvt_pk_bf16_f32 v45, v54, v55
    v_cvt_pk_bf16_f32 v46, v48, v49
    v_cvt_pk_bf16_f32 v47, v50, v51
    ds_write_b128 v13, v[44:47] offset:8192
    v_accvgpr_read_b32 v36, a64
    v_accvgpr_read_b32 v37, a65
    v_accvgpr_read_b32 v38, a66
    v_accvgpr_read_b32 v39, a67
    v_accvgpr_read_b32 v32, a32
    v_accvgpr_read_b32 v33, a33
    v_accvgpr_read_b32 v34, a34
    v_accvgpr_read_b32 v35, a35
    v_accvgpr_read_b32 v28, a0
    v_accvgpr_read_b32 v29, a1
    v_accvgpr_read_b32 v30, a2
    v_accvgpr_read_b32 v31, a3
    v_pk_mul_f32 v[36:37], v[36:37], s[72:73]
    v_pk_mul_f32 v[38:39], v[38:39], s[72:73]
    v_pk_mul_f32 v[32:33], v[32:33], s[72:73]
    v_pk_mul_f32 v[34:35], v[34:35], s[72:73]
    v_exp_f32 v36, v36
    v_exp_f32 v37, v37
    v_exp_f32 v38, v38
    v_exp_f32 v39, v39
    v_exp_f32 v32, v32
    v_exp_f32 v33, v33
    v_exp_f32 v34, v34
    v_exp_f32 v35, v35
    v_pk_add_f32 v[36:37], v[36:37], s[86:87]
    v_pk_add_f32 v[38:39], v[38:39], s[86:87]
    v_pk_add_f32 v[32:33], v[32:33], s[86:87]
    v_pk_add_f32 v[34:35], v[34:35], s[86:87]
    v_rcp_f32 v36, v36
    v_rcp_f32 v37, v37
    v_rcp_f32 v38, v38
    v_rcp_f32 v39, v39
    v_rcp_f32 v32, v32
    v_rcp_f32 v33, v33
    v_rcp_f32 v34, v34
    v_rcp_f32 v35, v35
    v_pk_mul_f32 v[36:37], v[36:37], v[28:29]
    v_pk_mul_f32 v[38:39], v[38:39], v[30:31]
    v_pk_mul_f32 v[32:33], v[32:33], v[224:225]
    v_pk_mul_f32 v[34:35], v[34:35], v[226:227]
    v_cvt_pk_bf16_f32 v28, v36, v37
    v_cvt_pk_bf16_f32 v29, v38, v39
    v_cvt_pk_bf16_f32 v30, v32, v33
    v_cvt_pk_bf16_f32 v31, v34, v35
    ds_write_b128 v13, v[28:31] offset:9216
    s_waitcnt vmcnt(0)
    v_and_b32 v10, v10, v11
    v_cmp_ne_u32 vcc, 1, v10
    s_nop 1
    s_cmp_eq_u64 vcc, 0
    s_cselect_b32 s22, s22, 0
    s_cselect_b32 s89, 1, 0
    v_accvgpr_read_b32 v52, a60
    v_accvgpr_read_b32 v53, a61
    v_accvgpr_read_b32 v54, a62
    s_add_u32 m0, s18, 98304
    v_accvgpr_read_b32 v55, a63
    v_accvgpr_read_b32 v48, a28
    v_accvgpr_read_b32 v49, a29
    buffer_load_dwordx4 v2, s[20:23], s31 offen sc1 lds
    v_accvgpr_read_b32 v50, a30
    v_accvgpr_read_b32 v51, a31
    v_pk_mul_f32 v[52:53], v[52:53], s[72:73]
    buffer_load_dwordx4 v2, s[20:23], s31 offen offset:1024 sc1 lds
    v_pk_mul_f32 v[54:55], v[54:55], s[72:73]
    v_pk_mul_f32 v[48:49], v[48:49], s[72:73]
    v_pk_mul_f32 v[50:51], v[50:51], s[72:73]
    s_add_u32 m0, s18, 106496
    v_exp_f32 v52, v52
    v_exp_f32 v53, v53
    v_exp_f32 v54, v54
    buffer_load_dwordx4 v3, s[20:23], s31 offen sc1 lds
    v_exp_f32 v55, v55
    v_exp_f32 v48, v48
    v_exp_f32 v49, v49
    buffer_load_dwordx4 v6, s[20:23], s31 offen offset:1024 sc1 lds
    s_add_u32 s31, s31, 8192
    s_and_b32 s31, s31, 0x1ffff
    v_exp_f32 v50, v50
    v_exp_f32 v51, v51
    v_pk_add_f32 v[52:53], v[52:53], s[86:87]
    buffer_load_dwordx4 a[96:99], v1, s[20:23], s46 offen offset:0 sc1
    v_pk_add_f32 v[54:55], v[54:55], s[86:87]
    v_pk_add_f32 v[48:49], v[48:49], s[86:87]
    v_pk_add_f32 v[50:51], v[50:51], s[86:87]
    buffer_load_dwordx4 a[100:103], v1, s[20:23], s46 offen offset:1024 sc1
    v_rcp_f32 v52, v52
    v_rcp_f32 v53, v53
    v_rcp_f32 v54, v54
    buffer_load_dwordx4 a[104:107], v1, s[20:23], s46 offen offset:2048 sc1
    v_rcp_f32 v55, v55
    v_rcp_f32 v48, v48
    v_rcp_f32 v49, v49
    buffer_load_dwordx4 a[108:111], v1, s[20:23], s46 offen offset:3072 sc1
    v_rcp_f32 v50, v50
    v_rcp_f32 v51, v51
    v_pk_mul_f32 v[52:53], v[52:53], v[252:253]
    s_add_u32 m0, s18, 114688
    v_pk_mul_f32 v[54:55], v[54:55], v[254:255]
    v_pk_mul_f32 v[48:49], v[48:49], v[220:221]
    v_pk_mul_f32 v[50:51], v[50:51], v[222:223]
    buffer_load_dwordx4 v2, s[20:23], s31 offen sc1 lds
    v_cvt_pk_bf16_f32 v252, v52, v53
    v_cvt_pk_bf16_f32 v253, v54, v55
    v_cvt_pk_bf16_f32 v254, v48, v49
    buffer_load_dwordx4 v2, s[20:23], s31 offen offset:1024 sc1 lds
    v_cvt_pk_bf16_f32 v255, v50, v51
    ds_write_b128 v13, v[252:255] offset:12288
    v_accvgpr_read_b32 v36, a56
    s_add_u32 m0, s18, 122880
    v_accvgpr_read_b32 v37, a57
    v_accvgpr_read_b32 v38, a58
    v_accvgpr_read_b32 v39, a59
    buffer_load_dwordx4 v3, s[20:23], s31 offen sc1 lds
    v_accvgpr_read_b32 v32, a24
    v_accvgpr_read_b32 v33, a25
    v_accvgpr_read_b32 v34, a26
    buffer_load_dwordx4 v6, s[20:23], s31 offen offset:1024 sc1 lds
    s_add_u32 s31, s31, 8192
    s_and_b32 s31, s31, 0x1ffff
    v_accvgpr_read_b32 v35, a27
    v_pk_mul_f32 v[36:37], v[36:37], s[72:73]
    v_pk_mul_f32 v[38:39], v[38:39], s[72:73]
    s_add_u32 m0, s18, 131072
    v_pk_mul_f32 v[32:33], v[32:33], s[72:73]
    v_pk_mul_f32 v[34:35], v[34:35], s[72:73]
    v_exp_f32 v36, v36
    buffer_load_dwordx4 v2, s[20:23], s31 offen sc1 lds
    v_exp_f32 v37, v37
    v_exp_f32 v38, v38
    v_exp_f32 v39, v39
    buffer_load_dwordx4 v2, s[20:23], s31 offen offset:1024 sc1 lds
    v_exp_f32 v32, v32
    v_exp_f32 v33, v33
    v_exp_f32 v34, v34
    s_add_u32 m0, s18, 139264
    v_exp_f32 v35, v35
    v_pk_add_f32 v[36:37], v[36:37], s[86:87]
    v_pk_add_f32 v[38:39], v[38:39], s[86:87]
    buffer_load_dwordx4 v3, s[20:23], s31 offen sc1 lds
    v_pk_add_f32 v[32:33], v[32:33], s[86:87]
    v_pk_add_f32 v[34:35], v[34:35], s[86:87]
    v_rcp_f32 v36, v36
    buffer_load_dwordx4 v6, s[20:23], s31 offen offset:1024 sc1 lds
    s_add_u32 s31, s31, 8192
    s_and_b32 s31, s31, 0x1ffff
    v_rcp_f32 v37, v37
    v_rcp_f32 v38, v38
    v_rcp_f32 v39, v39
    v_rcp_f32 v32, v32
    v_rcp_f32 v33, v33
    v_rcp_f32 v34, v34
    v_rcp_f32 v35, v35
    v_pk_mul_f32 v[36:37], v[36:37], v[248:249]
    v_pk_mul_f32 v[38:39], v[38:39], v[250:251]
    v_pk_mul_f32 v[32:33], v[32:33], v[216:217]
    v_pk_mul_f32 v[34:35], v[34:35], v[218:219]
    v_cvt_pk_bf16_f32 v248, v36, v37
    v_cvt_pk_bf16_f32 v249, v38, v39
    v_cvt_pk_bf16_f32 v250, v32, v33
    v_cvt_pk_bf16_f32 v251, v34, v35
    ds_write_b128 v13, v[248:251] offset:13312
    v_mov_b32 v218, v13
    v_mov_b32 v216, v22
    v_mov_b32 v217, v22
    s_cmp_eq_u32 s89, 1
    s_cbranch_scc1 L_at_begin
    s_branch L_at_late
L_g1_w2:
    s_waitcnt lgkmcnt(0)
    v_mfma_f32_16x16x32_bf16 v[212:215], a[176:179], a[200:203], v[212:215]
    s_load_dwordx2 s[4:5], s[0:1], 16
    s_load_dwordx2 s[6:7], s[0:1], 48
    s_load_dwordx2 s[8:9], s[0:1], 0
    s_load_dwordx2 s[34:35], s[0:1], 56
    v_mfma_f32_16x16x32_bf16 v[180:183], a[180:183], a[200:203], v[180:183]
    s_barrier
    s_lshl_b32 s75, s14, 14
    v_add_u32 v13, s75, v1
    v_mfma_f32_16x16x32_bf16 v[208:211], a[176:179], a[204:207], v[208:211]
    v_lshlrev_b32 v8, 3, v0
    v_mfma_f32_16x16x32_bf16 v[176:179], a[180:183], a[204:207], v[176:179]
    v_mfma_f32_16x16x32_bf16 v[204:207], a[176:179], a[208:211], v[204:207]
    v_mfma_f32_16x16x32_bf16 v[172:175], a[180:183], a[208:211], v[172:175]
    v_mfma_f32_16x16x32_bf16 v[200:203], a[176:179], a[212:215], v[200:203]
    v_pk_mul_f32 v[212:213], v[212:213], s[84:85]
    v_pk_mul_f32 v[214:215], v[214:215], s[84:85]
    v_mfma_f32_16x16x32_bf16 v[168:171], a[180:183], a[212:215], v[168:171]
    v_pk_mul_f32 v[180:181], v[180:181], s[84:85]
    v_pk_mul_f32 v[182:183], v[182:183], s[84:85]
    v_mfma_f32_16x16x32_bf16 v[196:199], a[176:179], a[216:219], v[196:199]
    v_cvt_pk_bf16_f32 v212, v212, v213
    v_cvt_pk_bf16_f32 v213, v214, v215
    v_mfma_f32_16x16x32_bf16 v[164:167], a[180:183], a[216:219], v[164:167]
    v_cvt_pk_bf16_f32 v214, v180, v181
    v_cvt_pk_bf16_f32 v215, v182, v183
    v_mfma_f32_16x16x32_bf16 v[192:195], a[176:179], a[220:223], v[192:195]
    buffer_store_dwordx4 v[212:215], v22, s[20:23], s76 offen offset:0
    v_pk_mul_f32 v[208:209], v[208:209], s[84:85]
    v_mfma_f32_16x16x32_bf16 v[160:163], a[180:183], a[220:223], v[160:163]
    v_pk_mul_f32 v[210:211], v[210:211], s[84:85]
    v_pk_mul_f32 v[176:177], v[176:177], s[84:85]
    v_mfma_f32_16x16x32_bf16 v[188:191], a[176:179], a[224:227], v[188:191]
    v_pk_mul_f32 v[178:179], v[178:179], s[84:85]
    v_cvt_pk_bf16_f32 v208, v208, v209
    v_mfma_f32_16x16x32_bf16 v[156:159], a[180:183], a[224:227], v[156:159]
    v_cvt_pk_bf16_f32 v209, v210, v211
    v_cvt_pk_bf16_f32 v210, v176, v177
    v_mfma_f32_16x16x32_bf16 v[184:187], a[176:179], a[228:231], v[184:187]
    v_cvt_pk_bf16_f32 v211, v178, v179
    buffer_store_dwordx4 v[208:211], v22, s[20:23], s76 offen offset:256
    v_mfma_f32_16x16x32_bf16 v[152:155], a[180:183], a[228:231], v[152:155]
    v_pk_mul_f32 v[204:205], v[204:205], s[84:85]
    v_pk_mul_f32 v[206:207], v[206:207], s[84:85]
    v_mfma_f32_16x16x32_bf16 v[148:151], a[184:187], a[200:203], v[148:151]
    v_pk_mul_f32 v[172:173], v[172:173], s[84:85]
    v_pk_mul_f32 v[174:175], v[174:175], s[84:85]
    v_mfma_f32_16x16x32_bf16 v[116:119], a[188:191], a[200:203], v[116:119]
    v_cvt_pk_bf16_f32 v204, v204, v205
    v_cvt_pk_bf16_f32 v205, v206, v207
    v_mfma_f32_16x16x32_bf16 v[144:147], a[184:187], a[204:207], v[144:147]
    v_cvt_pk_bf16_f32 v206, v172, v173
    v_cvt_pk_bf16_f32 v207, v174, v175
    v_mfma_f32_16x16x32_bf16 v[112:115], a[188:191], a[204:207], v[112:115]
    buffer_store_dwordx4 v[204:207], v22, s[20:23], s76 offen offset:2048
    v_pk_mul_f32 v[200:201], v[200:201], s[84:85]
    v_mfma_f32_16x16x32_bf16 v[140:143], a[184:187], a[208:211], v[140:143]
    v_pk_mul_f32 v[202:203], v[202:203], s[84:85]
    v_pk_mul_f32 v[168:169], v[168:169], s[84:85]
    v_mfma_f32_16x16x32_bf16 v[108:111], a[188:191], a[208:211], v[108:111]
    v_pk_mul_f32 v[170:171], v[170:171], s[84:85]
    v_cvt_pk_bf16_f32 v200, v200, v201
    v_mfma_f32_16x16x32_bf16 v[136:139], a[184:187], a[212:215], v[136:139]
    v_cvt_pk_bf16_f32 v201, v202, v203
    v_cvt_pk_bf16_f32 v202, v168, v169
    v_mfma_f32_16x16x32_bf16 v[104:107], a[188:191], a[212:215], v[104:107]
    v_cvt_pk_bf16_f32 v203, v170, v171
    buffer_store_dwordx4 v[200:203], v22, s[20:23], s76 offen offset:2304
    v_mfma_f32_16x16x32_bf16 v[132:135], a[184:187], a[216:219], v[132:135]
    v_pk_mul_f32 v[196:197], v[196:197], s[84:85]
    v_pk_mul_f32 v[198:199], v[198:199], s[84:85]
    v_mfma_f32_16x16x32_bf16 v[100:103], a[188:191], a[216:219], v[100:103]
    v_pk_mul_f32 v[164:165], v[164:165], s[84:85]
    v_pk_mul_f32 v[166:167], v[166:167], s[84:85]
    v_mfma_f32_16x16x32_bf16 v[128:131], a[184:187], a[220:223], v[128:131]
    v_cvt_pk_bf16_f32 v196, v196, v197
    v_cvt_pk_bf16_f32 v197, v198, v199
    v_mfma_f32_16x16x32_bf16 v[96:99], a[188:191], a[220:223], v[96:99]
    v_cvt_pk_bf16_f32 v198, v164, v165
    v_cvt_pk_bf16_f32 v199, v166, v167
    v_mfma_f32_16x16x32_bf16 v[124:127], a[184:187], a[224:227], v[124:127]
    s_add_u32 s76, s76, 4096
    buffer_store_dwordx4 v[196:199], v22, s[20:23], s76 offen offset:0
    v_mfma_f32_16x16x32_bf16 v[92:95], a[188:191], a[224:227], v[92:95]
    v_pk_mul_f32 v[192:193], v[192:193], s[84:85]
    v_pk_mul_f32 v[194:195], v[194:195], s[84:85]
    v_mfma_f32_16x16x32_bf16 v[120:123], a[184:187], a[228:231], v[120:123]
    v_pk_mul_f32 v[160:161], v[160:161], s[84:85]
    v_pk_mul_f32 v[162:163], v[162:163], s[84:85]
    v_mfma_f32_16x16x32_bf16 v[88:91], a[188:191], a[228:231], v[88:91]
    v_cvt_pk_bf16_f32 v192, v192, v193
    v_cvt_pk_bf16_f32 v193, v194, v195
    v_mfma_f32_16x16x32_bf16 v[84:87], a[192:195], a[200:203], v[84:87]
    v_cvt_pk_bf16_f32 v194, v160, v161
    v_cvt_pk_bf16_f32 v195, v162, v163
    v_mfma_f32_16x16x32_bf16 v[52:55], a[196:199], a[200:203], v[52:55]
    buffer_store_dwordx4 v[192:195], v22, s[20:23], s76 offen offset:256
    v_pk_mul_f32 v[188:189], v[188:189], s[84:85]
    v_mfma_f32_16x16x32_bf16 v[80:83], a[192:195], a[204:207], v[80:83]
    v_pk_mul_f32 v[190:191], v[190:191], s[84:85]
    v_pk_mul_f32 v[156:157], v[156:157], s[84:85]
    v_mfma_f32_16x16x32_bf16 v[48:51], a[196:199], a[204:207], v[48:51]
    v_pk_mul_f32 v[158:159], v[158:159], s[84:85]
    v_cvt_pk_bf16_f32 v188, v188, v189
    v_mfma_f32_16x16x32_bf16 v[76:79], a[192:195], a[208:211], v[76:79]
    v_cvt_pk_bf16_f32 v189, v190, v191
    v_cvt_pk_bf16_f32 v190, v156, v157
    v_mfma_f32_16x16x32_bf16 v[44:47], a[196:199], a[208:211], v[44:47]
    v_cvt_pk_bf16_f32 v191, v158, v159
    buffer_store_dwordx4 v[188:191], v22, s[20:23], s76 offen offset:2048
    v_mfma_f32_16x16x32_bf16 v[72:75], a[192:195], a[212:215], v[72:75]
    v_pk_mul_f32 v[184:185], v[184:185], s[84:85]
    v_pk_mul_f32 v[186:187], v[186:187], s[84:85]
    v_mfma_f32_16x16x32_bf16 v[40:43], a[196:199], a[212:215], v[40:43]
    v_pk_mul_f32 v[152:153], v[152:153], s[84:85]
    v_pk_mul_f32 v[154:155], v[154:155], s[84:85]
    v_mfma_f32_16x16x32_bf16 v[68:71], a[192:195], a[216:219], v[68:71]
    v_cvt_pk_bf16_f32 v184, v184, v185
    v_cvt_pk_bf16_f32 v185, v186, v187
    v_mfma_f32_16x16x32_bf16 v[36:39], a[196:199], a[216:219], v[36:39]
    v_cvt_pk_bf16_f32 v186, v152, v153
    v_cvt_pk_bf16_f32 v187, v154, v155
    v_mfma_f32_16x16x32_bf16 v[64:67], a[192:195], a[220:223], v[64:67]
    buffer_store_dwordx4 v[184:187], v22, s[20:23], s76 offen offset:2304
    s_add_u32 s76, s76, 126976
    v_mfma_f32_16x16x32_bf16 v[32:35], a[196:199], a[220:223], v[32:35]
    v_pk_mul_f32 v[148:149], v[148:149], s[84:85]
    v_pk_mul_f32 v[150:151], v[150:151], s[84:85]
    v_mfma_f32_16x16x32_bf16 v[60:63], a[192:195], a[224:227], v[60:63]
    v_pk_mul_f32 v[116:117], v[116:117], s[84:85]
    v_pk_mul_f32 v[118:119], v[118:119], s[84:85]
    v_mfma_f32_16x16x32_bf16 v[28:31], a[196:199], a[224:227], v[28:31]
    v_cvt_pk_bf16_f32 v148, v148, v149
    v_cvt_pk_bf16_f32 v149, v150, v151
    v_mfma_f32_16x16x32_bf16 v[56:59], a[192:195], a[228:231], v[56:59]
    v_cvt_pk_bf16_f32 v150, v116, v117
    v_cvt_pk_bf16_f32 v151, v118, v119
    v_mfma_f32_16x16x32_bf16 v[24:27], a[196:199], a[228:231], v[24:27]
    buffer_store_dwordx4 v[148:151], v22, s[20:23], s76 offen offset:0
    v_pk_mul_f32 v[144:145], v[144:145], s[84:85]
    v_mfma_f32_16x16x32_bf16 a[84:87], a[160:163], a[200:203], a[84:87]
    v_pk_mul_f32 v[146:147], v[146:147], s[84:85]
    v_pk_mul_f32 v[112:113], v[112:113], s[84:85]
    v_mfma_f32_16x16x32_bf16 a[52:55], a[164:167], a[200:203], a[52:55]
    v_pk_mul_f32 v[114:115], v[114:115], s[84:85]
    v_cvt_pk_bf16_f32 v144, v144, v145
    v_mfma_f32_16x16x32_bf16 a[20:23], a[168:171], a[200:203], a[20:23]
    v_cvt_pk_bf16_f32 v145, v146, v147
    v_cvt_pk_bf16_f32 v146, v112, v113
    v_mfma_f32_16x16x32_bf16 v[244:247], a[172:175], a[200:203], v[244:247]
    v_cvt_pk_bf16_f32 v147, v114, v115
    buffer_store_dwordx4 v[144:147], v22, s[20:23], s76 offen offset:256
    v_mfma_f32_16x16x32_bf16 a[80:83], a[160:163], a[204:207], a[80:83]
    v_pk_mul_f32 v[140:141], v[140:141], s[84:85]
    v_pk_mul_f32 v[142:143], v[142:143], s[84:85]
    v_mfma_f32_16x16x32_bf16 a[48:51], a[164:167], a[204:207], a[48:51]
    v_pk_mul_f32 v[108:109], v[108:109], s[84:85]
    v_pk_mul_f32 v[110:111], v[110:111], s[84:85]
    v_mfma_f32_16x16x32_bf16 a[16:19], a[168:171], a[204:207], a[16:19]
    v_cvt_pk_bf16_f32 v140, v140, v141
    v_cvt_pk_bf16_f32 v141, v142, v143
    v_mfma_f32_16x16x32_bf16 v[240:243], a[172:175], a[204:207], v[240:243]
    v_cvt_pk_bf16_f32 v142, v108, v109
    v_cvt_pk_bf16_f32 v143, v110, v111
    v_mfma_f32_16x16x32_bf16 a[76:79], a[160:163], a[208:211], a[76:79]
    buffer_store_dwordx4 v[140:143], v22, s[20:23], s76 offen offset:2048
    v_pk_mul_f32 v[136:137], v[136:137], s[84:85]
    v_mfma_f32_16x16x32_bf16 a[44:47], a[164:167], a[208:211], a[44:47]
    v_pk_mul_f32 v[138:139], v[138:139], s[84:85]
    v_pk_mul_f32 v[104:105], v[104:105], s[84:85]
    v_mfma_f32_16x16x32_bf16 a[12:15], a[168:171], a[208:211], a[12:15]
    v_pk_mul_f32 v[106:107], v[106:107], s[84:85]
    v_cvt_pk_bf16_f32 v136, v136, v137
    v_mfma_f32_16x16x32_bf16 v[236:239], a[172:175], a[208:211], v[236:239]
    v_cvt_pk_bf16_f32 v137, v138, v139
    v_cvt_pk_bf16_f32 v138, v104, v105
    v_mfma_f32_16x16x32_bf16 a[72:75], a[160:163], a[212:215], a[72:75]
    v_cvt_pk_bf16_f32 v139, v106, v107
    buffer_store_dwordx4 v[136:139], v22, s[20:23], s76 offen offset:2304
    v_mfma_f32_16x16x32_bf16 a[40:43], a[164:167], a[212:215], a[40:43]
    v_pk_mul_f32 v[132:133], v[132:133], s[84:85]
    v_pk_mul_f32 v[134:135], v[134:135], s[84:85]
    v_mfma_f32_16x16x32_bf16 a[8:11], a[168:171], a[212:215], a[8:11]
    v_pk_mul_f32 v[100:101], v[100:101], s[84:85]
    v_pk_mul_f32 v[102:103], v[102:103], s[84:85]
    v_mfma_f32_16x16x32_bf16 v[232:235], a[172:175], a[212:215], v[232:235]
    v_cvt_pk_bf16_f32 v132, v132, v133
    v_cvt_pk_bf16_f32 v133, v134, v135
    v_mfma_f32_16x16x32_bf16 a[68:71], a[160:163], a[216:219], a[68:71]
    v_cvt_pk_bf16_f32 v134, v100, v101
    v_cvt_pk_bf16_f32 v135, v102, v103
    v_mfma_f32_16x16x32_bf16 a[36:39], a[164:167], a[216:219], a[36:39]
    s_add_u32 s76, s76, 4096
    buffer_store_dwordx4 v[132:135], v22, s[20:23], s76 offen offset:0
    v_mfma_f32_16x16x32_bf16 a[4:7], a[168:171], a[216:219], a[4:7]
    v_pk_mul_f32 v[128:129], v[128:129], s[84:85]
    v_pk_mul_f32 v[130:131], v[130:131], s[84:85]
    v_mfma_f32_16x16x32_bf16 v[228:231], a[172:175], a[216:219], v[228:231]
    v_pk_mul_f32 v[96:97], v[96:97], s[84:85]
    v_pk_mul_f32 v[98:99], v[98:99], s[84:85]
    v_mfma_f32_16x16x32_bf16 a[64:67], a[160:163], a[220:223], a[64:67]
    v_cvt_pk_bf16_f32 v128, v128, v129
    v_cvt_pk_bf16_f32 v129, v130, v131
    v_mfma_f32_16x16x32_bf16 a[32:35], a[164:167], a[220:223], a[32:35]
    v_cvt_pk_bf16_f32 v130, v96, v97
    v_cvt_pk_bf16_f32 v131, v98, v99
    v_mfma_f32_16x16x32_bf16 a[0:3], a[168:171], a[220:223], a[0:3]
    buffer_store_dwordx4 v[128:131], v22, s[20:23], s76 offen offset:256
    v_pk_mul_f32 v[124:125], v[124:125], s[84:85]
    v_mfma_f32_16x16x32_bf16 v[224:227], a[172:175], a[220:223], v[224:227]
    v_pk_mul_f32 v[126:127], v[126:127], s[84:85]
    v_pk_mul_f32 v[92:93], v[92:93], s[84:85]
    v_mfma_f32_16x16x32_bf16 a[60:63], a[160:163], a[224:227], a[60:63]
    v_pk_mul_f32 v[94:95], v[94:95], s[84:85]
    v_cvt_pk_bf16_f32 v124, v124, v125
    v_mfma_f32_16x16x32_bf16 a[28:31], a[164:167], a[224:227], a[28:31]
    v_cvt_pk_bf16_f32 v125, v126, v127
    v_cvt_pk_bf16_f32 v126, v92, v93
    v_mfma_f32_16x16x32_bf16 v[252:255], a[168:171], a[224:227], v[252:255]
    v_cvt_pk_bf16_f32 v127, v94, v95
    buffer_store_dwordx4 v[124:127], v22, s[20:23], s76 offen offset:2048
    v_mfma_f32_16x16x32_bf16 v[220:223], a[172:175], a[224:227], v[220:223]
    v_pk_mul_f32 v[120:121], v[120:121], s[84:85]
    v_pk_mul_f32 v[122:123], v[122:123], s[84:85]
    v_mfma_f32_16x16x32_bf16 a[56:59], a[160:163], a[228:231], a[56:59]
    v_pk_mul_f32 v[88:89], v[88:89], s[84:85]
    v_pk_mul_f32 v[90:91], v[90:91], s[84:85]
    v_mfma_f32_16x16x32_bf16 a[24:27], a[164:167], a[228:231], a[24:27]
    v_cvt_pk_bf16_f32 v120, v120, v121
    v_cvt_pk_bf16_f32 v121, v122, v123
    v_mfma_f32_16x16x32_bf16 v[248:251], a[168:171], a[228:231], v[248:251]
    v_cvt_pk_bf16_f32 v122, v88, v89
    v_cvt_pk_bf16_f32 v123, v90, v91
    v_mfma_f32_16x16x32_bf16 v[216:219], a[172:175], a[228:231], v[216:219]
    buffer_store_dwordx4 v[120:123], v22, s[20:23], s76 offen offset:2304
    s_add_u32 s76, s76, 126976
    s_nop 7
    v_pk_mul_f32 v[84:85], v[84:85], s[84:85]
    v_pk_mul_f32 v[86:87], v[86:87], s[84:85]
    v_pk_mul_f32 v[52:53], v[52:53], s[84:85]
    v_pk_mul_f32 v[54:55], v[54:55], s[84:85]
    v_cvt_pk_bf16_f32 v84, v84, v85
    v_cvt_pk_bf16_f32 v85, v86, v87
    v_cvt_pk_bf16_f32 v86, v52, v53
    v_cvt_pk_bf16_f32 v87, v54, v55
    buffer_store_dwordx4 v[84:87], v22, s[20:23], s76 offen offset:0
    v_pk_mul_f32 v[80:81], v[80:81], s[84:85]
    v_pk_mul_f32 v[82:83], v[82:83], s[84:85]
    v_pk_mul_f32 v[48:49], v[48:49], s[84:85]
    v_pk_mul_f32 v[50:51], v[50:51], s[84:85]
    v_cvt_pk_bf16_f32 v80, v80, v81
    v_cvt_pk_bf16_f32 v81, v82, v83
    v_cvt_pk_bf16_f32 v82, v48, v49
    v_cvt_pk_bf16_f32 v83, v50, v51
    buffer_store_dwordx4 v[80:83], v22, s[20:23], s76 offen offset:256
    v_pk_mul_f32 v[76:77], v[76:77], s[84:85]
    v_pk_mul_f32 v[78:79], v[78:79], s[84:85]
    v_pk_mul_f32 v[44:45], v[44:45], s[84:85]
    v_pk_mul_f32 v[46:47], v[46:47], s[84:85]
    v_cvt_pk_bf16_f32 v76, v76, v77
    v_cvt_pk_bf16_f32 v77, v78, v79
    v_cvt_pk_bf16_f32 v78, v44, v45
    v_cvt_pk_bf16_f32 v79, v46, v47
    buffer_store_dwordx4 v[76:79], v22, s[20:23], s76 offen offset:2048
    v_pk_mul_f32 v[72:73], v[72:73], s[84:85]
    v_pk_mul_f32 v[74:75], v[74:75], s[84:85]
    v_pk_mul_f32 v[40:41], v[40:41], s[84:85]
    v_pk_mul_f32 v[42:43], v[42:43], s[84:85]
    v_cvt_pk_bf16_f32 v72, v72, v73
    v_cvt_pk_bf16_f32 v73, v74, v75
    v_cvt_pk_bf16_f32 v74, v40, v41
    v_cvt_pk_bf16_f32 v75, v42, v43
    buffer_store_dwordx4 v[72:75], v22, s[20:23], s76 offen offset:2304
    v_pk_mul_f32 v[68:69], v[68:69], s[84:85]
    v_pk_mul_f32 v[70:71], v[70:71], s[84:85]
    v_pk_mul_f32 v[36:37], v[36:37], s[84:85]
    v_pk_mul_f32 v[38:39], v[38:39], s[84:85]
    v_cvt_pk_bf16_f32 v68, v68, v69
    v_cvt_pk_bf16_f32 v69, v70, v71
    v_cvt_pk_bf16_f32 v70, v36, v37
    v_cvt_pk_bf16_f32 v71, v38, v39
    s_add_u32 s76, s76, 4096
    buffer_store_dwordx4 v[68:71], v22, s[20:23], s76 offen offset:0
    v_pk_mul_f32 v[64:65], v[64:65], s[84:85]
    v_pk_mul_f32 v[66:67], v[66:67], s[84:85]
    v_pk_mul_f32 v[32:33], v[32:33], s[84:85]
    v_pk_mul_f32 v[34:35], v[34:35], s[84:85]
    v_cvt_pk_bf16_f32 v64, v64, v65
    v_cvt_pk_bf16_f32 v65, v66, v67
    v_cvt_pk_bf16_f32 v66, v32, v33
    v_cvt_pk_bf16_f32 v67, v34, v35
    buffer_store_dwordx4 v[64:67], v22, s[20:23], s76 offen offset:256
    v_pk_mul_f32 v[60:61], v[60:61], s[84:85]
    v_pk_mul_f32 v[62:63], v[62:63], s[84:85]
    v_pk_mul_f32 v[28:29], v[28:29], s[84:85]
    v_pk_mul_f32 v[30:31], v[30:31], s[84:85]
    v_cvt_pk_bf16_f32 v60, v60, v61
    v_cvt_pk_bf16_f32 v61, v62, v63
    v_cvt_pk_bf16_f32 v62, v28, v29
    v_cvt_pk_bf16_f32 v63, v30, v31
    buffer_store_dwordx4 v[60:63], v22, s[20:23], s76 offen offset:2048
    v_pk_mul_f32 v[56:57], v[56:57], s[84:85]
    v_pk_mul_f32 v[58:59], v[58:59], s[84:85]
    v_pk_mul_f32 v[24:25], v[24:25], s[84:85]
    v_pk_mul_f32 v[26:27], v[26:27], s[84:85]
    v_cvt_pk_bf16_f32 v56, v56, v57
    v_cvt_pk_bf16_f32 v57, v58, v59
    v_cvt_pk_bf16_f32 v58, v24, v25
    v_cvt_pk_bf16_f32 v59, v26, v27
    buffer_store_dwordx4 v[56:59], v22, s[20:23], s76 offen offset:2304
    s_add_u32 s76, s76, 126976
    v_accvgpr_read_b32 v52, a84
    v_accvgpr_read_b32 v53, a85
    v_accvgpr_read_b32 v54, a86
    v_accvgpr_read_b32 v55, a87
    v_accvgpr_read_b32 v48, a52
    v_accvgpr_read_b32 v49, a53
    v_accvgpr_read_b32 v50, a54
    v_accvgpr_read_b32 v51, a55
    v_accvgpr_read_b32 v44, a20
    v_accvgpr_read_b32 v45, a21
    v_accvgpr_read_b32 v46, a22
    v_accvgpr_read_b32 v47, a23
    v_pk_mul_f32 v[52:53], v[52:53], s[72:73]
    v_pk_mul_f32 v[54:55], v[54:55], s[72:73]
    v_pk_mul_f32 v[48:49], v[48:49], s[72:73]
    v_pk_mul_f32 v[50:51], v[50:51], s[72:73]
    v_exp_f32 v52, v52
    v_exp_f32 v53, v53
    v_exp_f32 v54, v54
    v_exp_f32 v55, v55
    v_exp_f32 v48, v48
    v_exp_f32 v49, v49
    v_exp_f32 v50, v50
    v_exp_f32 v51, v51
    v_pk_add_f32 v[52:53], v[52:53], s[86:87]
    v_pk_add_f32 v[54:55], v[54:55], s[86:87]
    v_pk_add_f32 v[48:49], v[48:49], s[86:87]
    v_pk_add_f32 v[50:51], v[50:51], s[86:87]
    v_rcp_f32 v52, v52
    v_rcp_f32 v53, v53
    v_rcp_f32 v54, v54
    v_rcp_f32 v55, v55
    v_rcp_f32 v48, v48
    v_rcp_f32 v49, v49
    v_rcp_f32 v50, v50
    v_rcp_f32 v51, v51
    v_pk_mul_f32 v[52:53], v[52:53], v[44:45]
    v_pk_mul_f32 v[54:55], v[54:55], v[46:47]
    v_pk_mul_f32 v[48:49], v[48:49], v[244:245]
    v_pk_mul_f32 v[50:51], v[50:51], v[246:247]
    v_cvt_pk_bf16_f32 v44, v52, v53
    v_cvt_pk_bf16_f32 v45, v54, v55
    v_cvt_pk_bf16_f32 v46, v48, v49
    v_cvt_pk_bf16_f32 v47, v50, v51
    ds_write_b128 v13, v[44:47] offset:0
    s_waitcnt vmcnt(0)
    v_mov_b32 v12, 1
    s_cmp_lg_u32 s93, 0
    s_cbranch_scc1 L_g1_rm2
    s_mov_b64 exec, 1
    buffer_store_dword v12, off, s[24:27], s29
    s_mov_b64 exec, -1
L_g1_rr2:
    v_accvgpr_read_b32 v36, a80
    v_accvgpr_read_b32 v37, a81
    v_accvgpr_read_b32 v38, a82
    v_accvgpr_read_b32 v39, a83
    v_accvgpr_read_b32 v32, a48
    v_accvgpr_read_b32 v33, a49
    v_accvgpr_read_b32 v34, a50
    v_accvgpr_read_b32 v35, a51
    v_accvgpr_read_b32 v28, a16
    v_accvgpr_read_b32 v29, a17
    v_accvgpr_read_b32 v30, a18
    v_accvgpr_read_b32 v31, a19
    v_pk_mul_f32 v[36:37], v[36:37], s[72:73]
    v_pk_mul_f32 v[38:39], v[38:39], s[72:73]
    v_pk_mul_f32 v[32:33], v[32:33], s[72:73]
    v_pk_mul_f32 v[34:35], v[34:35], s[72:73]
    v_exp_f32 v36, v36
    v_exp_f32 v37, v37
    v_exp_f32 v38, v38
    v_exp_f32 v39, v39
    v_exp_f32 v32, v32
    v_exp_f32 v33, v33
    v_exp_f32 v34, v34
    v_exp_f32 v35, v35
    v_pk_add_f32 v[36:37], v[36:37], s[86:87]
    v_pk_add_f32 v[38:39], v[38:39], s[86:87]
    v_pk_add_f32 v[32:33], v[32:33], s[86:87]
    v_pk_add_f32 v[34:35], v[34:35], s[86:87]
    v_rcp_f32 v36, v36
    v_rcp_f32 v37, v37
    v_rcp_f32 v38, v38
    v_rcp_f32 v39, v39
    v_rcp_f32 v32, v32
    v_rcp_f32 v33, v33
    v_rcp_f32 v34, v34
    v_rcp_f32 v35, v35
    v_pk_mul_f32 v[36:37], v[36:37], v[28:29]
    v_pk_mul_f32 v[38:39], v[38:39], v[30:31]
    v_pk_mul_f32 v[32:33], v[32:33], v[240:241]
    v_pk_mul_f32 v[34:35], v[34:35], v[242:243]
    v_cvt_pk_bf16_f32 v28, v36, v37
    v_cvt_pk_bf16_f32 v29, v38, v39
    v_cvt_pk_bf16_f32 v30, v32, v33
    v_cvt_pk_bf16_f32 v31, v34, v35
    ds_write_b128 v13, v[28:31] offset:1024
    v_accvgpr_read_b32 v52, a76
    v_accvgpr_read_b32 v53, a77
    v_accvgpr_read_b32 v54, a78
    v_accvgpr_read_b32 v55, a79
    v_accvgpr_read_b32 v48, a44
    v_accvgpr_read_b32 v49, a45
    v_accvgpr_read_b32 v50, a46
    v_accvgpr_read_b32 v51, a47
    v_accvgpr_read_b32 v44, a12
    v_accvgpr_read_b32 v45, a13
    v_accvgpr_read_b32 v46, a14
    v_accvgpr_read_b32 v47, a15
    v_pk_mul_f32 v[52:53], v[52:53], s[72:73]
    v_pk_mul_f32 v[54:55], v[54:55], s[72:73]
    v_pk_mul_f32 v[48:49], v[48:49], s[72:73]
    v_pk_mul_f32 v[50:51], v[50:51], s[72:73]
    v_exp_f32 v52, v52
    v_exp_f32 v53, v53
    v_exp_f32 v54, v54
    v_exp_f32 v55, v55
    v_exp_f32 v48, v48
    v_exp_f32 v49, v49
    v_exp_f32 v50, v50
    v_exp_f32 v51, v51
    v_pk_add_f32 v[52:53], v[52:53], s[86:87]
    v_pk_add_f32 v[54:55], v[54:55], s[86:87]
    v_pk_add_f32 v[48:49], v[48:49], s[86:87]
    v_pk_add_f32 v[50:51], v[50:51], s[86:87]
    v_rcp_f32 v52, v52
    v_rcp_f32 v53, v53
    v_rcp_f32 v54, v54
    v_rcp_f32 v55, v55
    v_rcp_f32 v48, v48
    v_rcp_f32 v49, v49
    v_rcp_f32 v50, v50
    v_rcp_f32 v51, v51
    v_pk_mul_f32 v[52:53], v[52:53], v[44:45]
    v_pk_mul_f32 v[54:55], v[54:55], v[46:47]
    v_pk_mul_f32 v[48:49], v[48:49], v[236:237]
    v_pk_mul_f32 v[50:51], v[50:51], v[238:239]
    v_cvt_pk_bf16_f32 v44, v52, v53
    v_cvt_pk_bf16_f32 v45, v54, v55
    v_cvt_pk_bf16_f32 v46, v48, v49
    v_cvt_pk_bf16_f32 v47, v50, v51
    ds_write_b128 v13, v[44:47] offset:4096
    v_accvgpr_read_b32 v36, a72
    v_accvgpr_read_b32 v37, a73
    v_accvgpr_read_b32 v38, a74
    v_accvgpr_read_b32 v39, a75
    v_accvgpr_read_b32 v32, a40
    v_accvgpr_read_b32 v33, a41
    v_accvgpr_read_b32 v34, a42
    v_accvgpr_read_b32 v35, a43
    v_accvgpr_read_b32 v28, a8
    v_accvgpr_read_b32 v29, a9
    v_accvgpr_read_b32 v30, a10
    v_accvgpr_read_b32 v31, a11
    v_pk_mul_f32 v[36:37], v[36:37], s[72:73]
    v_pk_mul_f32 v[38:39], v[38:39], s[72:73]
    v_pk_mul_f32 v[32:33], v[32:33], s[72:73]
    v_pk_mul_f32 v[34:35], v[34:35], s[72:73]
    v_exp_f32 v36, v36
    v_exp_f32 v37, v37
    v_exp_f32 v38, v38
    v_exp_f32 v39, v39
    v_exp_f32 v32, v32
    v_exp_f32 v33, v33
    v_exp_f32 v34, v34
    v_exp_f32 v35, v35
    v_pk_add_f32 v[36:37], v[36:37], s[86:87]
    v_pk_add_f32 v[38:39], v[38:39], s[86:87]
    v_pk_add_f32 v[32:33], v[32:33], s[86:87]
    v_pk_add_f32 v[34:35], v[34:35], s[86:87]
    v_rcp_f32 v36, v36
    v_rcp_f32 v37, v37
    v_rcp_f32 v38, v38
    v_rcp_f32 v39, v39
    v_rcp_f32 v32, v32
    v_rcp_f32 v33, v33
    v_rcp_f32 v34, v34
    v_rcp_f32 v35, v35
    v_pk_mul_f32 v[36:37], v[36:37], v[28:29]
    v_pk_mul_f32 v[38:39], v[38:39], v[30:31]
    v_pk_mul_f32 v[32:33], v[32:33], v[232:233]
    v_pk_mul_f32 v[34:35], v[34:35], v[234:235]
    v_cvt_pk_bf16_f32 v28, v36, v37
    v_cvt_pk_bf16_f32 v29, v38, v39
    v_cvt_pk_bf16_f32 v30, v32, v33
    v_cvt_pk_bf16_f32 v31, v34, v35
    ds_write_b128 v13, v[28:31] offset:5120
    v_accvgpr_read_b32 v52, a68
    v_accvgpr_read_b32 v53, a69
    v_accvgpr_read_b32 v54, a70
    v_accvgpr_read_b32 v55, a71
    v_accvgpr_read_b32 v48, a36
    v_accvgpr_read_b32 v49, a37
    v_accvgpr_read_b32 v50, a38
    v_accvgpr_read_b32 v51, a39
    v_accvgpr_read_b32 v44, a4
    v_accvgpr_read_b32 v45, a5
    v_accvgpr_read_b32 v46, a6
    v_accvgpr_read_b32 v47, a7
    v_pk_mul_f32 v[52:53], v[52:53], s[72:73]
    v_pk_mul_f32 v[54:55], v[54:55], s[72:73]
    v_pk_mul_f32 v[48:49], v[48:49], s[72:73]
    v_pk_mul_f32 v[50:51], v[50:51], s[72:73]
    v_exp_f32 v52, v52
    v_exp_f32 v53, v53
    v_exp_f32 v54, v54
    v_exp_f32 v55, v55
    v_exp_f32 v48, v48
    v_exp_f32 v49, v49
    v_exp_f32 v50, v50
    v_exp_f32 v51, v51
    v_pk_add_f32 v[52:53], v[52:53], s[86:87]
    v_pk_add_f32 v[54:55], v[54:55], s[86:87]
    v_pk_add_f32 v[48:49], v[48:49], s[86:87]
    v_pk_add_f32 v[50:51], v[50:51], s[86:87]
    v_rcp_f32 v52, v52
    v_rcp_f32 v53, v53
    v_rcp_f32 v54, v54
    v_rcp_f32 v55, v55
    v_rcp_f32 v48, v48
    v_rcp_f32 v49, v49
    v_rcp_f32 v50, v50
    v_rcp_f32 v51, v51
    v_pk_mul_f32 v[52:53], v[52:53], v[44:45]
    v_pk_mul_f32 v[54:55], v[54:55], v[46:47]
    v_pk_mul_f32 v[48:49], v[48:49], v[228:229]
    v_pk_mul_f32 v[50:51], v[50:51], v[230:231]
    v_cvt_pk_bf16_f32 v44, v52, v53
    v_cvt_pk_bf16_f32 v45, v54, v55
    v_cvt_pk_bf16_f32 v46, v48, v49
    v_cvt_pk_bf16_f32 v47, v50, v51
    ds_write_b128 v13, v[44:47] offset:8192
    v_accvgpr_read_b32 v36, a64
    v_accvgpr_read_b32 v37, a65
    v_accvgpr_read_b32 v38, a66
    v_accvgpr_read_b32 v39, a67
    v_accvgpr_read_b32 v32, a32
    v_accvgpr_read_b32 v33, a33
    v_accvgpr_read_b32 v34, a34
    v_accvgpr_read_b32 v35, a35
    v_accvgpr_read_b32 v28, a0
    v_accvgpr_read_b32 v29, a1
    v_accvgpr_read_b32 v30, a2
    v_accvgpr_read_b32 v31, a3
    v_pk_mul_f32 v[36:37], v[36:37], s[72:73]
    v_pk_mul_f32 v[38:39], v[38:39], s[72:73]
    v_pk_mul_f32 v[32:33], v[32:33], s[72:73]
    v_pk_mul_f32 v[34:35], v[34:35], s[72:73]
    v_exp_f32 v36, v36
    v_exp_f32 v37, v37
    v_exp_f32 v38, v38
    v_exp_f32 v39, v39
    v_exp_f32 v32, v32
    v_exp_f32 v33, v33
    v_exp_f32 v34, v34
    v_exp_f32 v35, v35
    v_pk_add_f32 v[36:37], v[36:37], s[86:87]
    v_pk_add_f32 v[38:39], v[38:39], s[86:87]
    v_pk_add_f32 v[32:33], v[32:33], s[86:87]
    v_pk_add_f32 v[34:35], v[34:35], s[86:87]
    v_rcp_f32 v36, v36
    v_rcp_f32 v37, v37
    v_rcp_f32 v38, v38
    v_rcp_f32 v39, v39
    v_rcp_f32 v32, v32
    v_rcp_f32 v33, v33
    v_rcp_f32 v34, v34
    v_rcp_f32 v35, v35
    v_pk_mul_f32 v[36:37], v[36:37], v[28:29]
    v_pk_mul_f32 v[38:39], v[38:39], v[30:31]
    v_pk_mul_f32 v[32:33], v[32:33], v[224:225]
    v_pk_mul_f32 v[34:35], v[34:35], v[226:227]
    v_cvt_pk_bf16_f32 v28, v36, v37
    v_cvt_pk_bf16_f32 v29, v38, v39
    v_cvt_pk_bf16_f32 v30, v32, v33
    v_cvt_pk_bf16_f32 v31, v34, v35
    ds_write_b128 v13, v[28:31] offset:9216
    v_accvgpr_read_b32 v52, a60
    v_accvgpr_read_b32 v53, a61
    v_accvgpr_read_b32 v54, a62
    v_accvgpr_read_b32 v55, a63
    v_accvgpr_read_b32 v48, a28
    v_accvgpr_read_b32 v49, a29
    v_accvgpr_read_b32 v50, a30
    v_accvgpr_read_b32 v51, a31
    v_pk_mul_f32 v[52:53], v[52:53], s[72:73]
    v_pk_mul_f32 v[54:55], v[54:55], s[72:73]
    v_pk_mul_f32 v[48:49], v[48:49], s[72:73]
    v_pk_mul_f32 v[50:51], v[50:51], s[72:73]
    v_exp_f32 v52, v52
    v_exp_f32 v53, v53
    v_exp_f32 v54, v54
    v_exp_f32 v55, v55
    v_exp_f32 v48, v48
    v_exp_f32 v49, v49
    v_exp_f32 v50, v50
    v_exp_f32 v51, v51
    v_pk_add_f32 v[52:53], v[52:53], s[86:87]
    v_pk_add_f32 v[54:55], v[54:55], s[86:87]
    v_pk_add_f32 v[48:49], v[48:49], s[86:87]
    v_pk_add_f32 v[50:51], v[50:51], s[86:87]
    v_rcp_f32 v52, v52
    v_rcp_f32 v53, v53
    v_rcp_f32 v54, v54
    v_rcp_f32 v55, v55
    v_rcp_f32 v48, v48
    v_rcp_f32 v49, v49
    v_rcp_f32 v50, v50
    v_rcp_f32 v51, v51
    v_pk_mul_f32 v[52:53], v[52:53], v[252:253]
    v_pk_mul_f32 v[54:55], v[54:55], v[254:255]
    v_pk_mul_f32 v[48:49], v[48:49], v[220:221]
    v_pk_mul_f32 v[50:51], v[50:51], v[222:223]
    v_cvt_pk_bf16_f32 v252, v52, v53
    v_cvt_pk_bf16_f32 v253, v54, v55
    v_cvt_pk_bf16_f32 v254, v48, v49
    v_cvt_pk_bf16_f32 v255, v50, v51
    ds_write_b128 v13, v[252:255] offset:12288
    buffer_load_dwordx2 v[10:11], v8, s[24:27], s28 offen sc1
    v_accvgpr_read_b32 v36, a56
    v_accvgpr_read_b32 v37, a57
    v_accvgpr_read_b32 v38, a58
    v_accvgpr_read_b32 v39, a59
    v_accvgpr_read_b32 v32, a24
    v_accvgpr_read_b32 v33, a25
    v_accvgpr_read_b32 v34, a26
    v_accvgpr_read_b32 v35, a27
    v_pk_mul_f32 v[36:37], v[36:37], s[72:73]
    v_pk_mul_f32 v[38:39], v[38:39], s[72:73]
    v_pk_mul_f32 v[32:33], v[32:33], s[72:73]
    v_pk_mul_f32 v[34:35], v[34:35], s[72:73]
    v_exp_f32 v36, v36
    v_exp_f32 v37, v37
    v_exp_f32 v38, v38
    v_exp_f32 v39, v39
    v_exp_f32 v32, v32
    v_exp_f32 v33, v33
    v_exp_f32 v34, v34
    v_exp_f32 v35, v35
    v_pk_add_f32 v[36:37], v[36:37], s[86:87]
    v_pk_add_f32 v[38:39], v[38:39], s[86:87]
    v_pk_add_f32 v[32:33], v[32:33], s[86:87]
    v_pk_add_f32 v[34:35], v[34:35], s[86:87]
    v_rcp_f32 v36, v36
    v_rcp_f32 v37, v37
    v_rcp_f32 v38, v38
    v_rcp_f32 v39, v39
    v_rcp_f32 v32, v32
    v_rcp_f32 v33, v33
    v_rcp_f32 v34, v34
    v_rcp_f32 v35, v35
    v_pk_mul_f32 v[36:37], v[36:37], v[248:249]
    v_pk_mul_f32 v[38:39], v[38:39], v[250:251]
    v_pk_mul_f32 v[32:33], v[32:33], v[216:217]
    v_pk_mul_f32 v[34:35], v[34:35], v[218:219]
    v_cvt_pk_bf16_f32 v248, v36, v37
    v_cvt_pk_bf16_f32 v249, v38, v39
    v_cvt_pk_bf16_f32 v250, v32, v33
    v_cvt_pk_bf16_f32 v251, v34, v35
    ds_write_b128 v13, v[248:251] offset:13312
    s_waitcnt vmcnt(0)
    v_and_b32 v10, v10, v11
    v_cmp_ne_u32 vcc, 1, v10
    s_nop 1
    s_cmp_eq_u64 vcc, 0
    s_cselect_b32 s22, s22, 0
    s_cselect_b32 s89, 1, 0
    s_nop 0
    s_add_u32 m0, s18, 98304
    s_nop 0
    buffer_load_dwordx4 v2, s[20:23], s31 offen sc1 lds
    s_nop 0
    buffer_load_dwordx4 v2, s[20:23], s31 offen offset:1024 sc1 lds
    s_nop 0
    s_add_u32 m0, s18, 106496
    s_nop 0
    buffer_load_dwordx4 v3, s[20:23], s31 offen sc1 lds
    s_nop 0
    buffer_load_dwordx4 v6, s[20:23], s31 offen offset:1024 sc1 lds
    s_add_u32 s31, s31, 8192
    s_and_b32 s31, s31, 0x1ffff
    s_nop 0
    buffer_load_dwordx4 a[96:99], v1, s[20:23], s46 offen offset:0 sc1
    s_nop 0
    buffer_load_dwordx4 a[100:103], v1, s[20:23], s46 offen offset:1024 sc1
    s_nop 0
    buffer_load_dwordx4 a[104:107], v1, s[20:23], s46 offen offset:2048 sc1
    s_nop 0
    buffer_load_dwordx4 a[108:111], v1, s[20:23], s46 offen offset:3072 sc1
    s_nop 0
    s_add_u32 m0, s18, 114688
    s_nop 0
    buffer_load_dwordx4 v2, s[20:23], s31 offen sc1 lds
    s_nop 0
    buffer_load_dwordx4 v2, s[20:23], s31 offen offset:1024 sc1 lds
    s_nop 0
    s_add_u32 m0, s18, 122880
    s_nop 0
    buffer_load_dwordx4 v3, s[20:23], s31 offen sc1 lds
    s_nop 0
    buffer_load_dwordx4 v6, s[20:23], s31 offen offset:1024 sc1 lds
    s_add_u32 s31, s31, 8192
    s_and_b32 s31, s31, 0x1ffff
    s_nop 0
    s_add_u32 m0, s18, 131072
    s_nop 0
    buffer_load_dwordx4 v2, s[20:23], s31 offen sc1 lds
    s_nop 0
    buffer_load_dwordx4 v2, s[20:23], s31 offen offset:1024 sc1 lds
    s_nop 0
    s_add_u32 m0, s18, 139264
    s_nop 0
    buffer_load_dwordx4 v3, s[20:23], s31 offen sc1 lds
    s_nop 0
    buffer_load_dwordx4 v6, s[20:23], s31 offen offset:1024 sc1 lds
    s_add_u32 s31, s31, 8192
    s_and_b32 s31, s31, 0x1ffff
    v_mov_b32 v218, v13
    v_mov_b32 v216, v22
    v_mov_b32 v217, 0x7ff00000
    s_cmp_eq_u32 s89, 1
    s_cbranch_scc1 L_at_begin
    s_branch L_at_late
L_g1_ft1_0:
    s_waitcnt vmcnt(8)
    s_branch L_g1_ft1_0r
L_g1_ft1_1:
    s_waitcnt vmcnt(15)
    s_branch L_g1_ft1_1r
L_g1_ft1_2:
    s_waitcnt vmcnt(22)
    s_branch L_g1_ft1_2r
L_g1_fx1:
    s_add_u32 s84, s10, 0x3200000
    s_addc_u32 s85, s11, 0
    s_mov_b32 s86, 0x8000
    s_mov_b32 s87, 0x00020000
    v_lshlrev_b32 v23, 4, v0
    s_lshl_b32 s19, s3, 9
    s_add_u32 s19, s19, 28672
    buffer_load_dword a236, v23, s[84:87], s19 offen sc1
    s_branch L_g1_loopn1
L_g1_rm1:
    v_and_b32 v10, 7, v0
    v_lshlrev_b32 v10, 5, v10
    v_accvgpr_read_b32 v11, a237
    s_mov_b32 s22, 0xc00000
    s_waitcnt vmcnt(0)
    s_mov_b32 s19, 0x80000
L_fw_all1:
    v_cmp_gt_u32 vcc, 32, v11
    s_nop 1
    s_cmp_eq_u64 vcc, 0
    s_cbranch_scc1 L_fwd_all1
    s_sleep 1
    buffer_load_dword v11, v10, s[80:83], s88 offen sc1
    s_waitcnt vmcnt(0)
    s_sub_u32 s19, s19, 1
    s_cmp_lg_u32 s19, 0
    s_cbranch_scc1 L_fw_all1
L_fwd_all1:
    s_sub_u32 s76, s76, 131072
    buffer_store_dwordx4 v[84:87], v22, s[20:23], s76 offen offset:0 sc1
    buffer_store_dwordx4 v[80:83], v22, s[20:23], s76 offen offset:256 sc1
    buffer_store_dwordx4 v[76:79], v22, s[20:23], s76 offen offset:2048 sc1
    buffer_store_dwordx4 v[72:75], v22, s[20:23], s76 offen offset:2304 sc1
    s_add_u32 s76, s76, 4096
    buffer_store_dwordx4 v[68:71], v22, s[20:23], s76 offen offset:0 sc1
    buffer_store_dwordx4 v[64:67], v22, s[20:23], s76 offen offset:256 sc1
    buffer_store_dwordx4 v[60:63], v22, s[20:23], s76 offen offset:2048 sc1
    buffer_store_dwordx4 v[56:59], v22, s[20:23], s76 offen offset:2304 sc1
    s_add_u32 s76, s76, 126976
    s_waitcnt vmcnt(0)
    s_mov_b64 exec, 1
    buffer_store_dword v12, off, s[24:27], s29 sc1
    s_mov_b64 exec, -1
    s_branch L_g1_rr1
L_g1_rm2:
    v_and_b32 v10, 7, v0
    v_lshlrev_b32 v10, 5, v10
    v_accvgpr_read_b32 v11, a237
    s_mov_b32 s22, 0xc00000
    s_waitcnt vmcnt(0)
    s_mov_b32 s19, 0x80000
L_fw_all2:
    v_cmp_gt_u32 vcc, 32, v11
    s_nop 1
    s_cmp_eq_u64 vcc, 0
    s_cbranch_scc1 L_fwd_all2
    s_sleep 1
    buffer_load_dword v11, v10, s[80:83], s88 offen sc1
    s_waitcnt vmcnt(0)
    s_sub_u32 s19, s19, 1
    s_cmp_lg_u32 s19, 0
    s_cbranch_scc1 L_fw_all2
L_fwd_all2:
    s_sub_u32 s76, s76, 393216
    buffer_store_dwordx4 v[212:215], v22, s[20:23], s76 offen offset:0 sc1
    buffer_store_dwordx4 v[208:211], v22, s[20:23], s76 offen offset:256 sc1
    buffer_store_dwordx4 v[204:207], v22, s[20:23], s76 offen offset:2048 sc1
    buffer_store_dwordx4 v[200:203], v22, s[20:23], s76 offen offset:2304 sc1
    s_add_u32 s76, s76, 4096
    buffer_store_dwordx4 v[196:199], v22, s[20:23], s76 offen offset:0 sc1
    buffer_store_dwordx4 v[192:195], v22, s[20:23], s76 offen offset:256 sc1
    buffer_store_dwordx4 v[188:191], v22, s[20:23], s76 offen offset:2048 sc1
    buffer_store_dwordx4 v[184:187], v22, s[20:23], s76 offen offset:2304 sc1
    s_add_u32 s76, s76, 126976
    buffer_store_dwordx4 v[148:151], v22, s[20:23], s76 offen offset:0 sc1
    buffer_store_dwordx4 v[144:147], v22, s[20:23], s76 offen offset:256 sc1
    buffer_store_dwordx4 v[140:143], v22, s[20:23], s76 offen offset:2048 sc1
    buffer_store_dwordx4 v[136:139], v22, s[20:23], s76 offen offset:2304 sc1
    s_add_u32 s76, s76, 4096
    buffer_store_dwordx4 v[132:135], v22, s[20:23], s76 offen offset:0 sc1
    buffer_store_dwordx4 v[128:131], v22, s[20:23], s76 offen offset:256 sc1
    buffer_store_dwordx4 v[124:127], v22, s[20:23], s76 offen offset:2048 sc1
    buffer_store_dwordx4 v[120:123], v22, s[20:23], s76 offen offset:2304 sc1
    s_add_u32 s76, s76, 126976
    buffer_store_dwordx4 v[84:87], v22, s[20:23], s76 offen offset:0 sc1
    buffer_store_dwordx4 v[80:83], v22, s[20:23], s76 offen offset:256 sc1
    buffer_store_dwordx4 v[76:79], v22, s[20:23], s76 offen offset:2048 sc1
    buffer_store_dwordx4 v[72:75], v22, s[20:23], s76 offen offset:2304 sc1
    s_add_u32 s76, s76, 4096
    buffer_store_dwordx4 v[68:71], v22, s[20:23], s76 offen offset:0 sc1
    buffer_store_dwordx4 v[64:67], v22, s[20:23], s76 offen offset:256 sc1
    buffer_store_dwordx4 v[60:63], v22, s[20:23], s76 offen offset:2048 sc1
    buffer_store_dwordx4 v[56:59], v22, s[20:23], s76 offen offset:2304 sc1
    s_add_u32 s76, s76, 126976
    s_waitcnt vmcnt(0)
    s_mov_b64 exec, 1
    buffer_store_dword v12, off, s[24:27], s29 sc1
    s_mov_b64 exec, -1
    s_branch L_g1_rr2
L_at_late:
    buffer_load_dwordx2 v[10:11], v8, s[24:27], s28 offen sc1
    s_waitcnt vmcnt(0)
    s_mov_b32 s19, 0x80000
L_fw_q:
    v_and_b32 v10, v10, v11
    v_cmp_ne_u32 vcc, 1, v10
    s_nop 1
    s_cmp_eq_u64 vcc, 0
    s_cbranch_scc1 L_fwd_q
    s_sleep 1
    buffer_load_dwordx2 v[10:11], v8, s[24:27], s28 offen sc1
    s_waitcnt vmcnt(0)
    s_sub_u32 s19, s19, 1
    s_cmp_lg_u32 s19, 0
    s_cbranch_scc1 L_fw_q
L_fwd_q:
    s_mov_b32 s22, 0xc00000
    s_mov_b32 s31, 0
    s_add_u32 m0, s18, 98304
    s_nop 0
    buffer_load_dwordx4 v2, s[20:23], s31 offen sc1 lds
    buffer_load_dwordx4 v2, s[20:23], s31 offen offset:1024 sc1 lds
    s_add_u32 m0, s18, 106496
    s_nop 0
    buffer_load_dwordx4 v3, s[20:23], s31 offen sc1 lds
    buffer_load_dwordx4 v6, s[20:23], s31 offen offset:1024 sc1 lds
    s_add_u32 s31, s31, 8192
    s_and_b32 s31, s31, 0x1ffff
    buffer_load_dwordx4 a[96:99], v1, s[20:23], s46 offen offset:0 sc1
    buffer_load_dwordx4 a[100:103], v1, s[20:23], s46 offen offset:1024 sc1
    buffer_load_dwordx4 a[104:107], v1, s[20:23], s46 offen offset:2048 sc1
    buffer_load_dwordx4 a[108:111], v1, s[20:23], s46 offen offset:3072 sc1
    s_add_u32 m0, s18, 114688
    s_nop 0
    buffer_load_dwordx4 v2, s[20:23], s31 offen sc1 lds
    buffer_load_dwordx4 v2, s[20:23], s31 offen offset:1024 sc1 lds
    s_add_u32 m0, s18, 122880
    s_nop 0
    buffer_load_dwordx4 v3, s[20:23], s31 offen sc1 lds
    buffer_load_dwordx4 v6, s[20:23], s31 offen offset:1024 sc1 lds
    s_add_u32 s31, s31, 8192
    s_and_b32 s31, s31, 0x1ffff
    s_add_u32 m0, s18, 131072
    s_nop 0
    buffer_load_dwordx4 v2, s[20:23], s31 offen sc1 lds
    buffer_load_dwordx4 v2, s[20:23], s31 offen offset:1024 sc1 lds
    s_add_u32 m0, s18, 139264
    s_nop 0
    buffer_load_dwordx4 v3, s[20:23], s31 offen sc1 lds
    buffer_load_dwordx4 v6, s[20:23], s31 offen offset:1024 sc1 lds
    s_add_u32 s31, s31, 8192
    s_and_b32 s31, s31, 0x1ffff
L_at_begin:
    v_and_b32 v8, 6, v0
    v_mov_b32 v9, 0x3f803f80
    v_cmp_eq_u32 vcc, 0, v8
    v_cmp_eq_u32 s[32:33], 4, v8
    v_and_b32 v8, 1, v0
    v_cndmask_b32 v160, 0, v9, vcc
    v_cndmask_b32 v161, 0, v9, vcc
    v_cndmask_b32 v162, 0, v9, s[32:33]
    v_cndmask_b32 v163, 0, v9, s[32:33]
    v_cmp_eq_u32 vcc, 1, v8
    v_mov_b32 v8, 0x44444444
    v_mov_b32 v9, 0xeeeeeeee
    v_cndmask_b32 v16, v8, v9, vcc
    v_mov_b32 v80, 0
    v_mov_b32 v81, 0
    v_mov_b32 v82, 0
    v_mov_b32 v83, 0
    v_mov_b32 v84, 0
    v_mov_b32 v85, 0
    v_mov_b32 v86, 0
    v_mov_b32 v87, 0
    v_mov_b32 v88, 0
    v_mov_b32 v89, 0
    v_mov_b32 v90, 0
    v_mov_b32 v91, 0
    v_mov_b32 v92, 0
    v_mov_b32 v93, 0
    v_mov_b32 v94, 0
    v_mov_b32 v95, 0
    v_mov_b32 v152, 0
    v_mov_b32 v153, 0
    v_mov_b32 v154, 0
    v_mov_b32 v155, 0
    v_mov_b32 v96, 0
    v_mov_b32 v97, 0
    v_mov_b32 v98, 0
    v_mov_b32 v99, 0
    v_mov_b32 v100, 0
    v_mov_b32 v101, 0
    v_mov_b32 v102, 0
    v_mov_b32 v103, 0
    v_mov_b32 v104, 0
    v_mov_b32 v105, 0
    v_mov_b32 v106, 0
    v_mov_b32 v107, 0
    v_mov_b32 v108, 0
    v_mov_b32 v109, 0
    v_mov_b32 v110, 0
    v_mov_b32 v111, 0
    v_mov_b32 v156, 0
    v_mov_b32 v157, 0
    v_mov_b32 v158, 0
    v_mov_b32 v159, 0
    v_mov_b32 v112, 0
    v_mov_b32 v116, 0
    v_mov_b32 v148, 0
    v_mov_b32 v113, 0
    v_mov_b32 v117, 0
    v_mov_b32 v149, 0
    v_mov_b32 v114, 0
    v_mov_b32 v118, 0
    v_mov_b32 v150, 0
    v_mov_b32 v115, 0
    v_mov_b32 v119, 0
    v_mov_b32 v151, 0
    s_waitcnt vmcnt(0) lgkmcnt(0)
    s_barrier
    ds_read_b128 v[120:123], v23 offset:0
    ds_read_b128 v[124:127], v23 offset:1024
    ds_read_b64_tr_b16 v[136:137], v4 offset:8192
    ds_read_b64_tr_b16 v[138:139], v5 offset:8192
    ds_read_b64_tr_b16 v[140:141], v4 offset:8448
    ds_read_b64_tr_b16 v[142:143], v5 offset:8448
    s_mov_b32 s36, s4
    s_mov_b32 s37, s5
    s_mov_b32 s38, 0x200000
    s_mov_b32 s39, 0x00020000
    s_mov_b32 s40, s6
    s_mov_b32 s41, s7
    s_mov_b32 s42, 0x700000
    s_mov_b32 s43, 0x00020000
    s_mov_b32 s44, 0
    s_mov_b32 s45, 0
    s_and_b32 s85, s2, 7
    s_lshr_b32 s86, s2, 3
    s_waitcnt lgkmcnt(4)
    v_mfma_f32_32x32x16_bf16 v[48:63], v[120:123], a[96:99], 0
    s_and_b32 s73, s86, 1
    s_lshr_b32 s86, s86, 1
    s_lshr_b32 s76, s85, 1
    s_lshl_b32 s76, s76, 2
    s_lshr_b32 s72, s86, 2
    v_mfma_f32_32x32x16_bf16 v[48:63], v[124:127], a[100:103], v[48:63]
    s_add_u32 s76, s76, s72
    s_and_b32 s77, s85, 1
    s_lshl_b32 s77, s77, 2
    s_and_b32 s72, s86, 3
    s_add_u32 s77, s77, s72
    v_mfma_f32_32x32x16_bf16 v[64:79], v[120:123], a[104:107], 0
    s_and_b32 s74, s14, 1
    s_lshr_b32 s75, s14, 1
    s_mov_b32 s88, s4
    s_mov_b32 s89, s5
    v_lshlrev_b32 v208, 2, v0
    v_mfma_f32_32x32x16_bf16 v[64:79], v[124:127], a[108:111], v[64:79]
    v_lshlrev_b32 v210, 4, v0
    s_add_u32 s48, s10, 0x1000000
    s_addc_u32 s49, s11, 0
    s_mov_b32 s50, 0x1200000
    s_mov_b32 s51, 0x00020000
    s_mov_b32 s52, s6
    s_mov_b32 s53, s7
    s_mov_b32 s54, 0x700000
    s_mov_b32 s55, 0x00020000
    s_mov_b32 s56, s8
    s_mov_b32 s57, s9
    s_mov_b32 s58, 0x400000
    s_mov_b32 s59, 0x00020000
    s_mov_b32 s60, s34
    s_mov_b32 s61, s35
    s_mov_b32 s62, 0x400000
    s_mov_b32 s63, 0x00020000
    s_add_u32 s64, s10, 0x2800000
    s_addc_u32 s65, s11, 0
    s_mov_b32 s66, 0x800000
    s_mov_b32 s67, 0x00020000
    s_cmp_eq_u32 s93, 0
    s_cselect_b32 s66, s66, 0
    s_cmp_eq_u32 s73, 0
    s_cselect_b32 s69, 0, 0x380000
    s_mov_b32 s85, 0x2c000
    s_cselect_b32 s68, 0x10000, s85
    v_lshrrev_b32 v211, 4, v0
    v_lshlrev_b32 v211, 9, v211
    v_max3_f32 v164, v48, v49, v50
    v_max3_f32 v164, v164, v51, v52
    v_max3_f32 v164, v164, v53, v54
    v_max3_f32 v164, v164, v55, v56
    v_max3_f32 v164, v164, v57, v58
    v_max3_f32 v164, v164, v59, v60
    v_max3_f32 v164, v164, v61, v62
    v_max_f32 v164, v164, v63
    v_max3_f32 v164, v164, v64, v65
    v_max3_f32 v164, v164, v66, v67
    v_max3_f32 v164, v164, v68, v69
    v_max3_f32 v164, v164, v70, v71
    v_max3_f32 v164, v164, v72, v73
    v_max3_f32 v164, v164, v74, v75
    v_max3_f32 v164, v164, v76, v77
    v_max3_f32 v164, v164, v78, v79
    v_mov_b32 v165, v164
    s_nop 1
    v_permlane32_swap_b32 v164, v165
    s_nop 1
    v_max_f32 v164, v164, v165
    v_sub_f32 v164, 0, v164
    v_mov_b32 v32, v164
    v_mov_b32 v33, v164
    v_mov_b32 v34, v164
    v_mov_b32 v35, v164
    v_mov_b32 v36, v164
    v_mov_b32 v37, v164
    v_mov_b32 v38, v164
    v_mov_b32 v39, v164
    v_mov_b32 v40, v164
    v_mov_b32 v41, v164
    v_mov_b32 v42, v164
    v_mov_b32 v43, v164
    v_mov_b32 v44, v164
    v_mov_b32 v45, v164
    v_mov_b32 v46, v164
    v_mov_b32 v47, v164
    s_nop 1
    v_mfma_f32_32x32x16_bf16 v[48:63], v[120:123], a[96:99], v[32:47]
    v_and_b32 v212, 15, v0
    v_lshl_add_u32 v211, v212, 4, v211
    s_lshl_b32 s85, s76, 2
    s_lshl_b32 s86, s75, 1
    s_add_u32 s85, s85, s86
    v_mfma_f32_32x32x16_bf16 v[48:63], v[124:127], a[100:103], v[48:63]
    s_add_u32 s80, s85, s74
    s_lshl_b32 s86, s74, 11
    s_mul_i32 s85, s80, 294912
    s_add_u32 s85, s85, s86
    s_lshl_b32 s72, s73, 8
    v_xor_b32 v211, s72, v211
    v_add_u32 v244, s85, v211
    v_xor_b32 v245, 0x100, v244
    s_xor_b32 s85, s80, 1
    s_mul_i32 s85, s85, 294912
    s_add_u32 s85, s85, s86
    v_add_u32 v246, s85, v211
    v_xor_b32 v247, 0x100, v246
    s_lshl_b32 s70, s14, 12
    s_lshl_b32 s81, s76, 8
    s_add_u32 s82, s81, 8192
    s_add_u32 s81, s81, 4096
    s_lshl_b32 s85, s76, 3
    s_add_u32 s85, s85, s77
    s_mov_b32 s83, s92
    s_lshl_b32 s85, s85, 16
    s_lshl_b32 s86, s14, 13
    s_add_u32 s84, s85, s86
    s_lshl_b32 s86, s73, 15
    s_add_u32 s84, s84, s86
    v_lshrrev_b32 v211, 4, v0
    v_bfe_u32 v212, v0, 1, 3
    v_and_b32 v213, 1, v0
    s_lshl_b32 s85, s77, 8
    s_lshl_b32 s86, s75, 16
    s_add_u32 s85, s85, s86
    v_lshlrev_b32 v214, 11, v211
    v_add_u32 v214, s85, v214
    v_xor_b32 v215, v212, v211
    v_lshl_add_u32 v215, v215, 1, v213
    v_lshl_add_u32 v215, v215, 4, v214
    s_cmp_eq_u32 s74, 0
    s_mov_b32 s85, 32768
    s_cselect_b32 s85, 0, s85
    v_add_u32 v182, s85, v215
    s_cmp_eq_u32 s74, 0
    s_mov_b32 s85, 16384
    s_cselect_b32 s85, 0, s85
    v_add_u32 v186, s85, v215
    v_xor_b32 v215, v212, v211
    v_xor_b32 v215, 4, v215
    v_lshl_add_u32 v215, v215, 1, v213
    v_lshl_add_u32 v215, v215, 4, v214
    s_cmp_eq_u32 s74, 0
    s_mov_b32 s85, 39936
    s_cselect_b32 s85, 7168, s85
    v_add_u32 v183, s85, v215
    s_cmp_eq_u32 s74, 0
    s_mov_b32 s85, 23552
    s_cselect_b32 s85, 7168, s85
    v_add_u32 v187, s85, v215
    v_xor_b32 v215, v212, v211
    v_lshl_add_u32 v215, v215, 1, v213
    v_lshl_add_u32 v215, v215, 4, v214
    s_cmp_eq_u32 s74, 0
    s_mov_b32 s85, 47104
    s_cselect_b32 s85, 14336, s85
    v_add_u32 v184, s85, v215
    s_cmp_eq_u32 s74, 0
    s_mov_b32 s85, 47104
    s_cselect_b32 s85, 30720, s85
    v_add_u32 v188, s85, v215
    v_xor_b32 v215, v212, v211
    v_xor_b32 v215, 4, v215
    v_lshl_add_u32 v215, v215, 1, v213
    v_lshl_add_u32 v215, v215, 4, v214
    s_cmp_eq_u32 s74, 0
    s_mov_b32 s85, 54272
    s_cselect_b32 s85, 21504, s85
    v_add_u32 v185, s85, v215
    s_cmp_eq_u32 s74, 0
    s_mov_b32 s85, 54272
    s_cselect_b32 s85, 37888, s85
    v_add_u32 v189, s85, v215
    v_lshrrev_b32 v211, 4, v0
    v_bfe_u32 v212, v0, 2, 2
    v_lshl_add_u32 v211, v211, 2, v212
    v_and_b32 v212, 7, v211
    v_lshlrev_b32 v211, 8, v211
    v_and_b32 v213, 3, v0
    v_lshl_add_u32 v211, v213, 3, v211
    s_lshl_b32 s85, s74, 13
    v_add_u32 v211, s85, v211
    v_xor_b32 v213, 0, v212
    v_lshl_add_u32 v190, v213, 5, v211
    v_add_u32 v198, 0x10000, v190
    v_xor_b32 v213, 1, v212
    v_lshl_add_u32 v191, v213, 5, v211
    v_add_u32 v199, 0x10000, v191
    v_xor_b32 v213, 2, v212
    v_lshl_add_u32 v192, v213, 5, v211
    v_add_u32 v200, 0x10000, v192
    v_xor_b32 v213, 3, v212
    v_lshl_add_u32 v193, v213, 5, v211
    v_add_u32 v201, 0x10000, v193
    v_xor_b32 v213, 4, v212
    v_lshl_add_u32 v194, v213, 5, v211
    v_add_u32 v202, 0x10000, v194
    v_xor_b32 v213, 5, v212
    v_lshl_add_u32 v195, v213, 5, v211
    v_add_u32 v203, 0x10000, v195
    v_xor_b32 v213, 6, v212
    v_lshl_add_u32 v196, v213, 5, v211
    v_add_u32 v204, 0x10000, v196
    v_xor_b32 v213, 7, v212
    v_lshl_add_u32 v197, v213, 5, v211
    v_add_u32 v205, 0x10000, v197
    s_lshl_b32 s85, s80, 16
    s_lshl_b32 s86, s77, 8
    s_add_u32 s85, s85, s86
    v_and_b32 v211, 15, v0
    v_lshlrev_b32 v211, 11, v211
    v_bfe_u32 v212, v0, 4, 1
    v_lshlrev_b32 v212, 5, v212
    v_lshrrev_b32 v213, 5, v0
    v_lshlrev_b32 v213, 4, v213
    v_add3_u32 v211, v211, v212, v213
    s_lshl_b32 s86, s73, 15
    s_add_u32 s85, s85, s86
    v_add_u32 v206, s85, v211
    s_mov_b32 s47, 2
L_at_loop8:
    s_waitcnt lgkmcnt(0)
    v_mfma_f32_32x32x16_bf16 v[64:79], v[120:123], a[104:107], v[32:47]
    ds_read_b128 v[128:131], v23 offset:2048
    v_exp_f32 v48, v48
    v_exp_f32 v49, v49
    v_exp_f32 v50, v50
    v_exp_f32 v51, v51
    v_mfma_f32_32x32x16_bf16 v[96:111], v[148:151], v[116:119], v[96:111]
    ds_read_b128 v[132:135], v23 offset:3072
    v_exp_f32 v52, v52
    v_exp_f32 v53, v53
    v_exp_f32 v54, v54
    v_exp_f32 v55, v55
    v_smfmac_f32_16x16x64_bf16 v[156:159], v[160:163], v[112:119], v16
    v_cvt_pk_bf16_f32 v112, v48, v49
    v_cvt_pk_bf16_f32 v113, v50, v51
    v_cvt_pk_bf16_f32 v114, v52, v53
    v_cvt_pk_bf16_f32 v115, v54, v55
    v_mfma_f32_32x32x16_bf16 v[64:79], v[124:127], a[108:111], v[64:79]
    ds_read_b64_tr_b16 v[144:145], v4 offset:10240
    v_exp_f32 v56, v56
    v_exp_f32 v57, v57
    v_exp_f32 v58, v58
    v_exp_f32 v59, v59
    v_mfma_f32_32x32x16_bf16 v[80:95], v[136:139], v[112:115], v[80:95]
    v_exp_f32 v60, v60
    v_exp_f32 v61, v61
    v_exp_f32 v62, v62
    v_exp_f32 v63, v63
    v_cvt_pk_bf16_f32 v116, v56, v57
    v_cvt_pk_bf16_f32 v117, v58, v59
    v_cvt_pk_bf16_f32 v118, v60, v61
    v_cvt_pk_bf16_f32 v119, v62, v63
    s_waitcnt lgkmcnt(1)
    v_mfma_f32_32x32x16_bf16 v[48:63], v[128:131], a[96:99], v[32:47]
    ds_read_b64_tr_b16 v[146:147], v5 offset:10240
    v_exp_f32 v64, v64
    v_exp_f32 v65, v65
    ds_read_b128 v[220:223], v218 offset:0
    v_exp_f32 v66, v66
    v_exp_f32 v67, v67
    v_mfma_f32_32x32x16_bf16 v[80:95], v[140:143], v[116:119], v[80:95]
    ds_read_b64_tr_b16 v[148:149], v4 offset:10496
    v_exp_f32 v68, v68
    v_exp_f32 v69, v69
    v_exp_f32 v70, v70
    v_exp_f32 v71, v71
    v_smfmac_f32_16x16x64_bf16 v[152:155], v[160:163], v[112:119], v16
    v_cvt_pk_bf16_f32 v112, v64, v65
    v_cvt_pk_bf16_f32 v113, v66, v67
    v_cvt_pk_bf16_f32 v114, v68, v69
    v_cvt_pk_bf16_f32 v115, v70, v71
    v_mfma_f32_32x32x16_bf16 v[48:63], v[132:135], a[100:103], v[48:63]
    ds_read_b64_tr_b16 v[150:151], v5 offset:10496
    v_exp_f32 v72, v72
    v_exp_f32 v73, v73
    v_exp_f32 v74, v74
    v_exp_f32 v75, v75
    v_mfma_f32_32x32x16_bf16 v[96:111], v[136:139], v[112:115], v[96:111]
    v_exp_f32 v76, v76
    v_exp_f32 v77, v77
    v_exp_f32 v78, v78
    v_exp_f32 v79, v79
    v_cvt_pk_bf16_f32 v116, v72, v73
    v_cvt_pk_bf16_f32 v117, v74, v75
    v_cvt_pk_bf16_f32 v118, v76, v77
    v_cvt_pk_bf16_f32 v119, v78, v79
    s_waitcnt lgkmcnt(0)
    v_mfma_f32_32x32x16_bf16 v[64:79], v[128:131], a[104:107], v[32:47]
    ds_read_b128 v[120:123], v23 offset:4096
    v_exp_f32 v48, v48
    v_exp_f32 v49, v49
    buffer_store_dwordx4 v[220:223], v216, s[48:51], s90 offen offset:0 sc1
    v_exp_f32 v50, v50
    v_exp_f32 v51, v51
    v_mfma_f32_32x32x16_bf16 v[96:111], v[140:143], v[116:119], v[96:111]
    ds_read_b128 v[124:127], v23 offset:5120
    v_exp_f32 v52, v52
    v_exp_f32 v53, v53
    v_exp_f32 v54, v54
    v_exp_f32 v55, v55
    v_smfmac_f32_16x16x64_bf16 v[156:159], v[160:163], v[112:119], v16
    v_cvt_pk_bf16_f32 v112, v48, v49
    v_cvt_pk_bf16_f32 v113, v50, v51
    v_cvt_pk_bf16_f32 v114, v52, v53
    v_cvt_pk_bf16_f32 v115, v54, v55
    v_mfma_f32_32x32x16_bf16 v[64:79], v[132:135], a[108:111], v[64:79]
    ds_read_b64_tr_b16 v[136:137], v4 offset:12288
    v_exp_f32 v56, v56
    v_exp_f32 v57, v57
    v_exp_f32 v58, v58
    v_exp_f32 v59, v59
    v_mfma_f32_32x32x16_bf16 v[80:95], v[144:147], v[112:115], v[80:95]
    v_exp_f32 v60, v60
    v_exp_f32 v61, v61
    v_exp_f32 v62, v62
    v_exp_f32 v63, v63
    v_cvt_pk_bf16_f32 v116, v56, v57
    v_cvt_pk_bf16_f32 v117, v58, v59
    v_cvt_pk_bf16_f32 v118, v60, v61
    v_cvt_pk_bf16_f32 v119, v62, v63
    s_waitcnt lgkmcnt(1)
    v_mfma_f32_32x32x16_bf16 v[48:63], v[120:123], a[96:99], v[32:47]
    ds_read_b64_tr_b16 v[138:139], v5 offset:12288
    v_exp_f32 v64, v64
    v_exp_f32 v65, v65
    ds_read_b128 v[220:223], v218 offset:1024
    v_exp_f32 v66, v66
    v_exp_f32 v67, v67
    v_mfma_f32_32x32x16_bf16 v[80:95], v[148:151], v[116:119], v[80:95]
    ds_read_b64_tr_b16 v[140:141], v4 offset:12544
    v_exp_f32 v68, v68
    v_exp_f32 v69, v69
    v_exp_f32 v70, v70
    v_exp_f32 v71, v71
    v_smfmac_f32_16x16x64_bf16 v[152:155], v[160:163], v[112:119], v16
    v_cvt_pk_bf16_f32 v112, v64, v65
    v_cvt_pk_bf16_f32 v113, v66, v67
    v_cvt_pk_bf16_f32 v114, v68, v69
    v_cvt_pk_bf16_f32 v115, v70, v71
    v_mfma_f32_32x32x16_bf16 v[48:63], v[124:127], a[100:103], v[48:63]
    ds_read_b64_tr_b16 v[142:143], v5 offset:12544
    v_exp_f32 v72, v72
    v_exp_f32 v73, v73
    v_exp_f32 v74, v74
    v_exp_f32 v75, v75
    v_mfma_f32_32x32x16_bf16 v[96:111], v[144:147], v[112:115], v[96:111]
    v_exp_f32 v76, v76
    v_exp_f32 v77, v77
    v_exp_f32 v78, v78
    v_exp_f32 v79, v79
    v_cvt_pk_bf16_f32 v116, v72, v73
    v_cvt_pk_bf16_f32 v117, v74, v75
    v_cvt_pk_bf16_f32 v118, v76, v77
    v_cvt_pk_bf16_f32 v119, v78, v79
    s_waitcnt lgkmcnt(0)
    v_mfma_f32_32x32x16_bf16 v[64:79], v[120:123], a[104:107], v[32:47]
    ds_read_b128 v[128:131], v23 offset:6144
    v_exp_f32 v48, v48
    v_exp_f32 v49, v49
    buffer_store_dwordx4 v[220:223], v216, s[48:51], s90 offen offset:256 sc1
    v_exp_f32 v50, v50
    v_exp_f32 v51, v51
    v_mfma_f32_32x32x16_bf16 v[96:111], v[148:151], v[116:119], v[96:111]
    ds_read_b128 v[132:135], v23 offset:7168
    v_exp_f32 v52, v52
    v_exp_f32 v53, v53
    v_exp_f32 v54, v54
    v_exp_f32 v55, v55
    v_smfmac_f32_16x16x64_bf16 v[156:159], v[160:163], v[112:119], v16
    v_cvt_pk_bf16_f32 v112, v48, v49
    v_cvt_pk_bf16_f32 v113, v50, v51
    v_cvt_pk_bf16_f32 v114, v52, v53
    v_cvt_pk_bf16_f32 v115, v54, v55
    v_mfma_f32_32x32x16_bf16 v[64:79], v[124:127], a[108:111], v[64:79]
    ds_read_b64_tr_b16 v[144:145], v4 offset:14336
    v_exp_f32 v56, v56
    v_exp_f32 v57, v57
    v_exp_f32 v58, v58
    v_exp_f32 v59, v59
    v_mfma_f32_32x32x16_bf16 v[80:95], v[136:139], v[112:115], v[80:95]
    v_exp_f32 v60, v60
    v_exp_f32 v61, v61
    v_exp_f32 v62, v62
    v_exp_f32 v63, v63
    v_cvt_pk_bf16_f32 v116, v56, v57
    v_cvt_pk_bf16_f32 v117, v58, v59
    v_cvt_pk_bf16_f32 v118, v60, v61
    v_cvt_pk_bf16_f32 v119, v62, v63
    s_waitcnt lgkmcnt(1)
    v_mfma_f32_32x32x16_bf16 v[48:63], v[128:131], a[96:99], v[32:47]
    ds_read_b64_tr_b16 v[146:147], v5 offset:14336
    v_exp_f32 v64, v64
    v_exp_f32 v65, v65
    v_exp_f32 v66, v66
    v_exp_f32 v67, v67
    v_mfma_f32_32x32x16_bf16 v[80:95], v[140:143], v[116:119], v[80:95]
    ds_read_b64_tr_b16 v[148:149], v4 offset:14592
    v_exp_f32 v68, v68
    v_exp_f32 v69, v69
    v_exp_f32 v70, v70
    v_exp_f32 v71, v71
    v_smfmac_f32_16x16x64_bf16 v[152:155], v[160:163], v[112:119], v16
    v_cvt_pk_bf16_f32 v112, v64, v65
    v_cvt_pk_bf16_f32 v113, v66, v67
    v_cvt_pk_bf16_f32 v114, v68, v69
    v_cvt_pk_bf16_f32 v115, v70, v71
    v_mfma_f32_32x32x16_bf16 v[48:63], v[132:135], a[100:103], v[48:63]
    ds_read_b64_tr_b16 v[150:151], v5 offset:14592
    v_exp_f32 v72, v72
    v_exp_f32 v73, v73
    v_exp_f32 v74, v74
    v_exp_f32 v75, v75
    v_mfma_f32_32x32x16_bf16 v[96:111], v[136:139], v[112:115], v[96:111]
    v_exp_f32 v76, v76
    v_exp_f32 v77, v77
    v_exp_f32 v78, v78
    v_exp_f32 v79, v79
    v_cvt_pk_bf16_f32 v116, v72, v73
    v_cvt_pk_bf16_f32 v117, v74, v75
    v_cvt_pk_bf16_f32 v118, v76, v77
    v_cvt_pk_bf16_f32 v119, v78, v79
    s_waitcnt lgkmcnt(0)
    v_mfma_f32_32x32x16_bf16 v[64:79], v[128:131], a[104:107], v[32:47]
    s_waitcnt vmcnt(8)
    s_barrier
    ds_read_b128 v[120:123], v23 offset:16384
    v_exp_f32 v48, v48
    v_exp_f32 v49, v49
    s_add_u32 m0, s18, 98304
    v_exp_f32 v50, v50
    v_exp_f32 v51, v51
    v_mfma_f32_32x32x16_bf16 v[96:111], v[140:143], v[116:119], v[96:111]
    ds_read_b128 v[124:127], v23 offset:17408
    v_exp_f32 v52, v52
    v_exp_f32 v53, v53
    buffer_load_dwordx4 v2, s[20:23], s31 offen sc1 lds
    v_exp_f32 v54, v54
    v_exp_f32 v55, v55
    v_smfmac_f32_16x16x64_bf16 v[156:159], v[160:163], v[112:119], v16
    buffer_load_dwordx4 v2, s[20:23], s31 offen offset:1024 sc1 lds
    v_cvt_pk_bf16_f32 v112, v48, v49
    v_cvt_pk_bf16_f32 v113, v50, v51
    v_cvt_pk_bf16_f32 v114, v52, v53
    v_cvt_pk_bf16_f32 v115, v54, v55
    s_add_u32 m0, s18, 106496
    v_mfma_f32_32x32x16_bf16 v[64:79], v[132:135], a[108:111], v[64:79]
    ds_read_b64_tr_b16 v[136:137], v4 offset:24576
    v_exp_f32 v56, v56
    v_exp_f32 v57, v57
    buffer_load_dwordx4 v3, s[20:23], s31 offen sc1 lds
    v_exp_f32 v58, v58
    v_exp_f32 v59, v59
    v_mfma_f32_32x32x16_bf16 v[80:95], v[144:147], v[112:115], v[80:95]
    v_exp_f32 v60, v60
    v_exp_f32 v61, v61
    buffer_load_dwordx4 v6, s[20:23], s31 offen offset:1024 sc1 lds
    s_add_u32 s31, s31, 8192
    s_and_b32 s31, s31, 0x1ffff
    v_exp_f32 v62, v62
    v_exp_f32 v63, v63
    buffer_load_dwordx4 v[176:179], v7, s[36:39], s44 offen
    s_add_u32 s44, s44, 0x100000
    v_cvt_pk_bf16_f32 v116, v56, v57
    v_cvt_pk_bf16_f32 v117, v58, v59
    v_cvt_pk_bf16_f32 v118, v60, v61
    v_cvt_pk_bf16_f32 v119, v62, v63
    s_waitcnt lgkmcnt(1)
    v_mfma_f32_32x32x16_bf16 v[48:63], v[120:123], a[96:99], v[32:47]
    ds_read_b64_tr_b16 v[138:139], v5 offset:24576
    v_exp_f32 v64, v64
    v_exp_f32 v65, v65
    ds_read_b128 v[220:223], v218 offset:2048
    v_exp_f32 v66, v66
    v_exp_f32 v67, v67
    v_mfma_f32_32x32x16_bf16 v[80:95], v[148:151], v[116:119], v[80:95]
    ds_read_b64_tr_b16 v[140:141], v4 offset:24832
    v_exp_f32 v68, v68
    v_exp_f32 v69, v69
    v_exp_f32 v70, v70
    v_exp_f32 v71, v71
    v_smfmac_f32_16x16x64_bf16 v[152:155], v[160:163], v[112:119], v16
    v_cvt_pk_bf16_f32 v112, v64, v65
    v_cvt_pk_bf16_f32 v113, v66, v67
    v_cvt_pk_bf16_f32 v114, v68, v69
    v_cvt_pk_bf16_f32 v115, v70, v71
    v_mfma_f32_32x32x16_bf16 v[48:63], v[124:127], a[100:103], v[48:63]
    ds_read_b64_tr_b16 v[142:143], v5 offset:24832
    v_exp_f32 v72, v72
    v_exp_f32 v73, v73
    v_exp_f32 v74, v74
    v_exp_f32 v75, v75
    v_mfma_f32_32x32x16_bf16 v[96:111], v[144:147], v[112:115], v[96:111]
    v_exp_f32 v76, v76
    v_exp_f32 v77, v77
    v_exp_f32 v78, v78
    v_exp_f32 v79, v79
    v_cvt_pk_bf16_f32 v116, v72, v73
    v_cvt_pk_bf16_f32 v117, v74, v75
    v_cvt_pk_bf16_f32 v118, v76, v77
    v_cvt_pk_bf16_f32 v119, v78, v79
    s_waitcnt lgkmcnt(0)
    v_mfma_f32_32x32x16_bf16 v[64:79], v[120:123], a[104:107], v[32:47]
    ds_read_b128 v[128:131], v23 offset:18432
    v_exp_f32 v48, v48
    v_exp_f32 v49, v49
    buffer_store_dwordx4 v[220:223], v217, s[48:51], s90 offen offset:2048 sc1
    v_exp_f32 v50, v50
    v_exp_f32 v51, v51
    v_mfma_f32_32x32x16_bf16 v[96:111], v[148:151], v[116:119], v[96:111]
    ds_read_b128 v[132:135], v23 offset:19456
    v_exp_f32 v52, v52
    v_exp_f32 v53, v53
    v_exp_f32 v54, v54
    v_exp_f32 v55, v55
    v_smfmac_f32_16x16x64_bf16 v[156:159], v[160:163], v[112:119], v16
    v_cvt_pk_bf16_f32 v112, v48, v49
    v_cvt_pk_bf16_f32 v113, v50, v51
    v_cvt_pk_bf16_f32 v114, v52, v53
    v_cvt_pk_bf16_f32 v115, v54, v55
    v_mfma_f32_32x32x16_bf16 v[64:79], v[124:127], a[108:111], v[64:79]
    ds_read_b64_tr_b16 v[144:145], v4 offset:26624
    v_exp_f32 v56, v56
    v_exp_f32 v57, v57
    v_exp_f32 v58, v58
    v_exp_f32 v59, v59
    v_mfma_f32_32x32x16_bf16 v[80:95], v[136:139], v[112:115], v[80:95]
    v_exp_f32 v60, v60
    v_exp_f32 v61, v61
    v_exp_f32 v62, v62
    v_exp_f32 v63, v63
    v_cvt_pk_bf16_f32 v116, v56, v57
    v_cvt_pk_bf16_f32 v117, v58, v59
    v_cvt_pk_bf16_f32 v118, v60, v61
    v_cvt_pk_bf16_f32 v119, v62, v63
    s_waitcnt lgkmcnt(1)
    v_mfma_f32_32x32x16_bf16 v[48:63], v[128:131], a[96:99], v[32:47]
    ds_read_b64_tr_b16 v[146:147], v5 offset:26624
    v_exp_f32 v64, v64
    v_exp_f32 v65, v65
    ds_read_b128 v[220:223], v218 offset:3072
    v_exp_f32 v66, v66
    v_exp_f32 v67, v67
    v_mfma_f32_32x32x16_bf16 v[80:95], v[140:143], v[116:119], v[80:95]
    ds_read_b64_tr_b16 v[148:149], v4 offset:26880
    v_exp_f32 v68, v68
    v_exp_f32 v69, v69
    v_exp_f32 v70, v70
    v_exp_f32 v71, v71
    v_smfmac_f32_16x16x64_bf16 v[152:155], v[160:163], v[112:119], v16
    v_cvt_pk_bf16_f32 v112, v64, v65
    v_cvt_pk_bf16_f32 v113, v66, v67
    v_cvt_pk_bf16_f32 v114, v68, v69
    v_cvt_pk_bf16_f32 v115, v70, v71
    v_mfma_f32_32x32x16_bf16 v[48:63], v[132:135], a[100:103], v[48:63]
    ds_read_b64_tr_b16 v[150:151], v5 offset:26880
    v_exp_f32 v72, v72
    v_exp_f32 v73, v73
    v_exp_f32 v74, v74
    v_exp_f32 v75, v75
    v_mfma_f32_32x32x16_bf16 v[96:111], v[136:139], v[112:115], v[96:111]
    v_exp_f32 v76, v76
    v_exp_f32 v77, v77
    v_exp_f32 v78, v78
    v_exp_f32 v79, v79
    v_cvt_pk_bf16_f32 v116, v72, v73
    v_cvt_pk_bf16_f32 v117, v74, v75
    v_cvt_pk_bf16_f32 v118, v76, v77
    v_cvt_pk_bf16_f32 v119, v78, v79
    s_waitcnt lgkmcnt(0)
    v_mfma_f32_32x32x16_bf16 v[64:79], v[128:131], a[104:107], v[32:47]
    ds_read_b128 v[120:123], v23 offset:20480
    v_exp_f32 v48, v48
    v_exp_f32 v49, v49
    buffer_store_dwordx4 v[220:223], v217, s[48:51], s90 offen offset:2304 sc1
    s_add_u32 s90, s90, 294912
    v_add_u32 v218, 0x1000, v218
    v_exp_f32 v50, v50
    v_exp_f32 v51, v51
    v_mfma_f32_32x32x16_bf16 v[96:111], v[140:143], v[116:119], v[96:111]
    ds_read_b128 v[124:127], v23 offset:21504
    v_exp_f32 v52, v52
    v_exp_f32 v53, v53
    v_exp_f32 v54, v54
    v_exp_f32 v55, v55
    v_smfmac_f32_16x16x64_bf16 v[156:159], v[160:163], v[112:119], v16
    v_cvt_pk_bf16_f32 v112, v48, v49
    v_cvt_pk_bf16_f32 v113, v50, v51
    v_cvt_pk_bf16_f32 v114, v52, v53
    v_cvt_pk_bf16_f32 v115, v54, v55
    v_mfma_f32_32x32x16_bf16 v[64:79], v[132:135], a[108:111], v[64:79]
    ds_read_b64_tr_b16 v[136:137], v4 offset:28672
    v_exp_f32 v56, v56
    v_exp_f32 v57, v57
    v_exp_f32 v58, v58
    v_exp_f32 v59, v59
    v_mfma_f32_32x32x16_bf16 v[80:95], v[144:147], v[112:115], v[80:95]
    v_exp_f32 v60, v60
    v_exp_f32 v61, v61
    v_exp_f32 v62, v62
    v_exp_f32 v63, v63
    v_cvt_pk_bf16_f32 v116, v56, v57
    v_cvt_pk_bf16_f32 v117, v58, v59
    v_cvt_pk_bf16_f32 v118, v60, v61
    v_cvt_pk_bf16_f32 v119, v62, v63
    s_waitcnt lgkmcnt(1)
    v_mfma_f32_32x32x16_bf16 v[48:63], v[120:123], a[96:99], v[32:47]
    ds_read_b64_tr_b16 v[138:139], v5 offset:28672
    v_exp_f32 v64, v64
    v_exp_f32 v65, v65
    ds_read_b128 v[220:223], v218 offset:0
    v_exp_f32 v66, v66
    v_exp_f32 v67, v67
    v_mfma_f32_32x32x16_bf16 v[80:95], v[148:151], v[116:119], v[80:95]
    ds_read_b64_tr_b16 v[140:141], v4 offset:28928
    v_exp_f32 v68, v68
    v_exp_f32 v69, v69
    v_exp_f32 v70, v70
    v_exp_f32 v71, v71
    v_smfmac_f32_16x16x64_bf16 v[152:155], v[160:163], v[112:119], v16
    v_cvt_pk_bf16_f32 v112, v64, v65
    v_cvt_pk_bf16_f32 v113, v66, v67
    v_cvt_pk_bf16_f32 v114, v68, v69
    v_cvt_pk_bf16_f32 v115, v70, v71
    v_mfma_f32_32x32x16_bf16 v[48:63], v[124:127], a[100:103], v[48:63]
    ds_read_b64_tr_b16 v[142:143], v5 offset:28928
    v_exp_f32 v72, v72
    v_exp_f32 v73, v73
    v_exp_f32 v74, v74
    v_exp_f32 v75, v75
    v_mfma_f32_32x32x16_bf16 v[96:111], v[144:147], v[112:115], v[96:111]
    v_exp_f32 v76, v76
    v_exp_f32 v77, v77
    v_exp_f32 v78, v78
    v_exp_f32 v79, v79
    v_cvt_pk_bf16_f32 v116, v72, v73
    v_cvt_pk_bf16_f32 v117, v74, v75
    v_cvt_pk_bf16_f32 v118, v76, v77
    v_cvt_pk_bf16_f32 v119, v78, v79
    s_waitcnt lgkmcnt(0)
    v_mfma_f32_32x32x16_bf16 v[64:79], v[120:123], a[104:107], v[32:47]
    ds_read_b128 v[128:131], v23 offset:22528
    v_exp_f32 v48, v48
    v_exp_f32 v49, v49
    buffer_store_dwordx4 v[220:223], v216, s[48:51], s90 offen offset:0 sc1
    v_exp_f32 v50, v50
    v_exp_f32 v51, v51
    v_mfma_f32_32x32x16_bf16 v[96:111], v[148:151], v[116:119], v[96:111]
    ds_read_b128 v[132:135], v23 offset:23552
    v_exp_f32 v52, v52
    v_exp_f32 v53, v53
    v_exp_f32 v54, v54
    v_exp_f32 v55, v55
    v_smfmac_f32_16x16x64_bf16 v[156:159], v[160:163], v[112:119], v16
    v_cvt_pk_bf16_f32 v112, v48, v49
    v_cvt_pk_bf16_f32 v113, v50, v51
    v_cvt_pk_bf16_f32 v114, v52, v53
    v_cvt_pk_bf16_f32 v115, v54, v55
    v_mfma_f32_32x32x16_bf16 v[64:79], v[124:127], a[108:111], v[64:79]
    ds_read_b64_tr_b16 v[144:145], v4 offset:30720
    v_exp_f32 v56, v56
    v_exp_f32 v57, v57
    v_exp_f32 v58, v58
    v_exp_f32 v59, v59
    v_mfma_f32_32x32x16_bf16 v[80:95], v[136:139], v[112:115], v[80:95]
    v_exp_f32 v60, v60
    v_exp_f32 v61, v61
    v_exp_f32 v62, v62
    v_exp_f32 v63, v63
    v_cvt_pk_bf16_f32 v116, v56, v57
    v_cvt_pk_bf16_f32 v117, v58, v59
    v_cvt_pk_bf16_f32 v118, v60, v61
    v_cvt_pk_bf16_f32 v119, v62, v63
    s_waitcnt lgkmcnt(1)
    v_mfma_f32_32x32x16_bf16 v[48:63], v[128:131], a[96:99], v[32:47]
    ds_read_b64_tr_b16 v[146:147], v5 offset:30720
    v_exp_f32 v64, v64
    v_exp_f32 v65, v65
    v_exp_f32 v66, v66
    v_exp_f32 v67, v67
    v_mfma_f32_32x32x16_bf16 v[80:95], v[140:143], v[116:119], v[80:95]
    ds_read_b64_tr_b16 v[148:149], v4 offset:30976
    v_exp_f32 v68, v68
    v_exp_f32 v69, v69
    v_exp_f32 v70, v70
    v_exp_f32 v71, v71
    v_smfmac_f32_16x16x64_bf16 v[152:155], v[160:163], v[112:119], v16
    v_cvt_pk_bf16_f32 v112, v64, v65
    v_cvt_pk_bf16_f32 v113, v66, v67
    v_cvt_pk_bf16_f32 v114, v68, v69
    v_cvt_pk_bf16_f32 v115, v70, v71
    v_mfma_f32_32x32x16_bf16 v[48:63], v[132:135], a[100:103], v[48:63]
    ds_read_b64_tr_b16 v[150:151], v5 offset:30976
    v_exp_f32 v72, v72
    v_exp_f32 v73, v73
    v_exp_f32 v74, v74
    v_exp_f32 v75, v75
    v_mfma_f32_32x32x16_bf16 v[96:111], v[136:139], v[112:115], v[96:111]
    v_exp_f32 v76, v76
    v_exp_f32 v77, v77
    v_exp_f32 v78, v78
    v_exp_f32 v79, v79
    v_cvt_pk_bf16_f32 v116, v72, v73
    v_cvt_pk_bf16_f32 v117, v74, v75
    v_cvt_pk_bf16_f32 v118, v76, v77
    v_cvt_pk_bf16_f32 v119, v78, v79
    s_waitcnt lgkmcnt(0)
    v_mfma_f32_32x32x16_bf16 v[64:79], v[128:131], a[104:107], v[32:47]
    s_waitcnt vmcnt(11)
    s_barrier
    ds_read_b128 v[120:123], v23 offset:32768
    v_exp_f32 v48, v48
    v_exp_f32 v49, v49
    s_add_u32 m0, s18, 114688
    v_exp_f32 v50, v50
    v_exp_f32 v51, v51
    v_mfma_f32_32x32x16_bf16 v[96:111], v[140:143], v[116:119], v[96:111]
    ds_read_b128 v[124:127], v23 offset:33792
    v_exp_f32 v52, v52
    v_exp_f32 v53, v53
    buffer_load_dwordx4 v2, s[20:23], s31 offen sc1 lds
    v_exp_f32 v54, v54
    v_exp_f32 v55, v55
    v_smfmac_f32_16x16x64_bf16 v[156:159], v[160:163], v[112:119], v16
    buffer_load_dwordx4 v2, s[20:23], s31 offen offset:1024 sc1 lds
    v_cvt_pk_bf16_f32 v112, v48, v49
    v_cvt_pk_bf16_f32 v113, v50, v51
    v_cvt_pk_bf16_f32 v114, v52, v53
    v_cvt_pk_bf16_f32 v115, v54, v55
    s_add_u32 m0, s18, 122880
    v_mfma_f32_32x32x16_bf16 v[64:79], v[132:135], a[108:111], v[64:79]
    ds_read_b64_tr_b16 v[136:137], v4 offset:40960
    v_exp_f32 v56, v56
    v_exp_f32 v57, v57
    buffer_load_dwordx4 v3, s[20:23], s31 offen sc1 lds
    v_exp_f32 v58, v58
    v_exp_f32 v59, v59
    v_mfma_f32_32x32x16_bf16 v[80:95], v[144:147], v[112:115], v[80:95]
    v_exp_f32 v60, v60
    v_exp_f32 v61, v61
    buffer_load_dwordx4 v6, s[20:23], s31 offen offset:1024 sc1 lds
    s_add_u32 s31, s31, 8192
    s_and_b32 s31, s31, 0x1ffff
    v_exp_f32 v62, v62
    v_exp_f32 v63, v63
    buffer_load_dwordx4 v[176:179], v7, s[40:43], s45 offen
    s_add_u32 s45, s45, 0x100000
    v_cvt_pk_bf16_f32 v116, v56, v57
    v_cvt_pk_bf16_f32 v117, v58, v59
    v_cvt_pk_bf16_f32 v118, v60, v61
    v_cvt_pk_bf16_f32 v119, v62, v63
    s_waitcnt lgkmcnt(1)
    v_mfma_f32_32x32x16_bf16 v[48:63], v[120:123], a[96:99], v[32:47]
    ds_read_b64_tr_b16 v[138:139], v5 offset:40960
    v_exp_f32 v64, v64
    v_exp_f32 v65, v65
    ds_read_b128 v[220:223], v218 offset:1024
    v_exp_f32 v66, v66
    v_exp_f32 v67, v67
    v_mfma_f32_32x32x16_bf16 v[80:95], v[148:151], v[116:119], v[80:95]
    ds_read_b64_tr_b16 v[140:141], v4 offset:41216
    v_exp_f32 v68, v68
    v_exp_f32 v69, v69
    v_exp_f32 v70, v70
    v_exp_f32 v71, v71
    v_smfmac_f32_16x16x64_bf16 v[152:155], v[160:163], v[112:119], v16
    v_cvt_pk_bf16_f32 v112, v64, v65
    v_cvt_pk_bf16_f32 v113, v66, v67
    v_cvt_pk_bf16_f32 v114, v68, v69
    v_cvt_pk_bf16_f32 v115, v70, v71
    v_mfma_f32_32x32x16_bf16 v[48:63], v[124:127], a[100:103], v[48:63]
    ds_read_b64_tr_b16 v[142:143], v5 offset:41216
    v_exp_f32 v72, v72
    v_exp_f32 v73, v73
    v_exp_f32 v74, v74
    v_exp_f32 v75, v75
    v_mfma_f32_32x32x16_bf16 v[96:111], v[144:147], v[112:115], v[96:111]
    v_exp_f32 v76, v76
    v_exp_f32 v77, v77
    v_exp_f32 v78, v78
    v_exp_f32 v79, v79
    v_cvt_pk_bf16_f32 v116, v72, v73
    v_cvt_pk_bf16_f32 v117, v74, v75
    v_cvt_pk_bf16_f32 v118, v76, v77
    v_cvt_pk_bf16_f32 v119, v78, v79
    s_waitcnt lgkmcnt(0)
    v_mfma_f32_32x32x16_bf16 v[64:79], v[120:123], a[104:107], v[32:47]
    ds_read_b128 v[128:131], v23 offset:34816
    v_exp_f32 v48, v48
    v_exp_f32 v49, v49
    buffer_store_dwordx4 v[220:223], v216, s[48:51], s90 offen offset:256 sc1
    v_exp_f32 v50, v50
    v_exp_f32 v51, v51
    v_mfma_f32_32x32x16_bf16 v[96:111], v[148:151], v[116:119], v[96:111]
    ds_read_b128 v[132:135], v23 offset:35840
    v_exp_f32 v52, v52
    v_exp_f32 v53, v53
    v_exp_f32 v54, v54
    v_exp_f32 v55, v55
    v_smfmac_f32_16x16x64_bf16 v[156:159], v[160:163], v[112:119], v16
    v_cvt_pk_bf16_f32 v112, v48, v49
    v_cvt_pk_bf16_f32 v113, v50, v51
    v_cvt_pk_bf16_f32 v114, v52, v53
    v_cvt_pk_bf16_f32 v115, v54, v55
    v_mfma_f32_32x32x16_bf16 v[64:79], v[124:127], a[108:111], v[64:79]
    ds_read_b64_tr_b16 v[144:145], v4 offset:43008
    v_exp_f32 v56, v56
    v_exp_f32 v57, v57
    v_exp_f32 v58, v58
    v_exp_f32 v59, v59
    v_mfma_f32_32x32x16_bf16 v[80:95], v[136:139], v[112:115], v[80:95]
    v_exp_f32 v60, v60
    v_exp_f32 v61, v61
    v_exp_f32 v62, v62
    v_exp_f32 v63, v63
    v_cvt_pk_bf16_f32 v116, v56, v57
    v_cvt_pk_bf16_f32 v117, v58, v59
    v_cvt_pk_bf16_f32 v118, v60, v61
    v_cvt_pk_bf16_f32 v119, v62, v63
    s_waitcnt lgkmcnt(1)
    v_mfma_f32_32x32x16_bf16 v[48:63], v[128:131], a[96:99], v[32:47]
    ds_read_b64_tr_b16 v[146:147], v5 offset:43008
    v_exp_f32 v64, v64
    v_exp_f32 v65, v65
    ds_read_b128 v[220:223], v218 offset:2048
    v_exp_f32 v66, v66
    v_exp_f32 v67, v67
    v_mfma_f32_32x32x16_bf16 v[80:95], v[140:143], v[116:119], v[80:95]
    ds_read_b64_tr_b16 v[148:149], v4 offset:43264
    v_exp_f32 v68, v68
    v_exp_f32 v69, v69
    v_exp_f32 v70, v70
    v_exp_f32 v71, v71
    v_smfmac_f32_16x16x64_bf16 v[152:155], v[160:163], v[112:119], v16
    v_cvt_pk_bf16_f32 v112, v64, v65
    v_cvt_pk_bf16_f32 v113, v66, v67
    v_cvt_pk_bf16_f32 v114, v68, v69
    v_cvt_pk_bf16_f32 v115, v70, v71
    v_mfma_f32_32x32x16_bf16 v[48:63], v[132:135], a[100:103], v[48:63]
    ds_read_b64_tr_b16 v[150:151], v5 offset:43264
    v_exp_f32 v72, v72
    v_exp_f32 v73, v73
    v_exp_f32 v74, v74
    v_exp_f32 v75, v75
    v_mfma_f32_32x32x16_bf16 v[96:111], v[136:139], v[112:115], v[96:111]
    v_exp_f32 v76, v76
    v_exp_f32 v77, v77
    v_exp_f32 v78, v78
    v_exp_f32 v79, v79
    v_cvt_pk_bf16_f32 v116, v72, v73
    v_cvt_pk_bf16_f32 v117, v74, v75
    v_cvt_pk_bf16_f32 v118, v76, v77
    v_cvt_pk_bf16_f32 v119, v78, v79
    s_waitcnt lgkmcnt(0)
    v_mfma_f32_32x32x16_bf16 v[64:79], v[128:131], a[104:107], v[32:47]
    ds_read_b128 v[120:123], v23 offset:36864
    v_exp_f32 v48, v48
    v_exp_f32 v49, v49
    buffer_store_dwordx4 v[220:223], v217, s[48:51], s90 offen offset:2048 sc1
    v_exp_f32 v50, v50
    v_exp_f32 v51, v51
    v_mfma_f32_32x32x16_bf16 v[96:111], v[140:143], v[116:119], v[96:111]
    ds_read_b128 v[124:127], v23 offset:37888
    v_exp_f32 v52, v52
    v_exp_f32 v53, v53
    v_exp_f32 v54, v54
    v_exp_f32 v55, v55
    v_smfmac_f32_16x16x64_bf16 v[156:159], v[160:163], v[112:119], v16
    v_cvt_pk_bf16_f32 v112, v48, v49
    v_cvt_pk_bf16_f32 v113, v50, v51
    v_cvt_pk_bf16_f32 v114, v52, v53
    v_cvt_pk_bf16_f32 v115, v54, v55
    v_mfma_f32_32x32x16_bf16 v[64:79], v[132:135], a[108:111], v[64:79]
    ds_read_b64_tr_b16 v[136:137], v4 offset:45056
    v_exp_f32 v56, v56
    v_exp_f32 v57, v57
    v_exp_f32 v58, v58
    v_exp_f32 v59, v59
    v_mfma_f32_32x32x16_bf16 v[80:95], v[144:147], v[112:115], v[80:95]
    v_exp_f32 v60, v60
    v_exp_f32 v61, v61
    v_exp_f32 v62, v62
    v_exp_f32 v63, v63
    v_cvt_pk_bf16_f32 v116, v56, v57
    v_cvt_pk_bf16_f32 v117, v58, v59
    v_cvt_pk_bf16_f32 v118, v60, v61
    v_cvt_pk_bf16_f32 v119, v62, v63
    s_waitcnt lgkmcnt(1)
    v_mfma_f32_32x32x16_bf16 v[48:63], v[120:123], a[96:99], v[32:47]
    ds_read_b64_tr_b16 v[138:139], v5 offset:45056
    v_exp_f32 v64, v64
    v_exp_f32 v65, v65
    ds_read_b128 v[220:223], v218 offset:3072
    v_exp_f32 v66, v66
    v_exp_f32 v67, v67
    v_mfma_f32_32x32x16_bf16 v[80:95], v[148:151], v[116:119], v[80:95]
    ds_read_b64_tr_b16 v[140:141], v4 offset:45312
    v_exp_f32 v68, v68
    v_exp_f32 v69, v69
    v_exp_f32 v70, v70
    v_exp_f32 v71, v71
    v_smfmac_f32_16x16x64_bf16 v[152:155], v[160:163], v[112:119], v16
    v_cvt_pk_bf16_f32 v112, v64, v65
    v_cvt_pk_bf16_f32 v113, v66, v67
    v_cvt_pk_bf16_f32 v114, v68, v69
    v_cvt_pk_bf16_f32 v115, v70, v71
    v_mfma_f32_32x32x16_bf16 v[48:63], v[124:127], a[100:103], v[48:63]
    ds_read_b64_tr_b16 v[142:143], v5 offset:45312
    v_exp_f32 v72, v72
    v_exp_f32 v73, v73
    v_exp_f32 v74, v74
    v_exp_f32 v75, v75
    v_mfma_f32_32x32x16_bf16 v[96:111], v[144:147], v[112:115], v[96:111]
    v_exp_f32 v76, v76
    v_exp_f32 v77, v77
    v_exp_f32 v78, v78
    v_exp_f32 v79, v79
    v_cvt_pk_bf16_f32 v116, v72, v73
    v_cvt_pk_bf16_f32 v117, v74, v75
    v_cvt_pk_bf16_f32 v118, v76, v77
    v_cvt_pk_bf16_f32 v119, v78, v79
    s_waitcnt lgkmcnt(0)
    v_mfma_f32_32x32x16_bf16 v[64:79], v[120:123], a[104:107], v[32:47]
    ds_read_b128 v[128:131], v23 offset:38912
    v_exp_f32 v48, v48
    v_exp_f32 v49, v49
    buffer_store_dwordx4 v[220:223], v217, s[48:51], s90 offen offset:2304 sc1
    s_add_u32 s90, s90, 294912
    v_add_u32 v218, 0x1000, v218
    v_exp_f32 v50, v50
    v_exp_f32 v51, v51
    v_mfma_f32_32x32x16_bf16 v[96:111], v[148:151], v[116:119], v[96:111]
    ds_read_b128 v[132:135], v23 offset:39936
    v_exp_f32 v52, v52
    v_exp_f32 v53, v53
    v_exp_f32 v54, v54
    v_exp_f32 v55, v55
    v_smfmac_f32_16x16x64_bf16 v[156:159], v[160:163], v[112:119], v16
    v_cvt_pk_bf16_f32 v112, v48, v49
    v_cvt_pk_bf16_f32 v113, v50, v51
    v_cvt_pk_bf16_f32 v114, v52, v53
    v_cvt_pk_bf16_f32 v115, v54, v55
    v_mfma_f32_32x32x16_bf16 v[64:79], v[124:127], a[108:111], v[64:79]
    ds_read_b64_tr_b16 v[144:145], v4 offset:47104
    v_exp_f32 v56, v56
    v_exp_f32 v57, v57
    v_exp_f32 v58, v58
    v_exp_f32 v59, v59
    v_mfma_f32_32x32x16_bf16 v[80:95], v[136:139], v[112:115], v[80:95]
    v_exp_f32 v60, v60
    v_exp_f32 v61, v61
    v_exp_f32 v62, v62
    v_exp_f32 v63, v63
    v_cvt_pk_bf16_f32 v116, v56, v57
    v_cvt_pk_bf16_f32 v117, v58, v59
    v_cvt_pk_bf16_f32 v118, v60, v61
    v_cvt_pk_bf16_f32 v119, v62, v63
    s_waitcnt lgkmcnt(1)
    v_mfma_f32_32x32x16_bf16 v[48:63], v[128:131], a[96:99], v[32:47]
    ds_read_b64_tr_b16 v[146:147], v5 offset:47104
    v_exp_f32 v64, v64
    v_exp_f32 v65, v65
    v_exp_f32 v66, v66
    v_exp_f32 v67, v67
    v_mfma_f32_32x32x16_bf16 v[80:95], v[140:143], v[116:119], v[80:95]
    ds_read_b64_tr_b16 v[148:149], v4 offset:47360
    v_exp_f32 v68, v68
    v_exp_f32 v69, v69
    v_exp_f32 v70, v70
    v_exp_f32 v71, v71
    v_smfmac_f32_16x16x64_bf16 v[152:155], v[160:163], v[112:119], v16
    v_cvt_pk_bf16_f32 v112, v64, v65
    v_cvt_pk_bf16_f32 v113, v66, v67
    v_cvt_pk_bf16_f32 v114, v68, v69
    v_cvt_pk_bf16_f32 v115, v70, v71
    v_mfma_f32_32x32x16_bf16 v[48:63], v[132:135], a[100:103], v[48:63]
    ds_read_b64_tr_b16 v[150:151], v5 offset:47360
    v_exp_f32 v72, v72
    v_exp_f32 v73, v73
    v_exp_f32 v74, v74
    v_exp_f32 v75, v75
    v_mfma_f32_32x32x16_bf16 v[96:111], v[136:139], v[112:115], v[96:111]
    v_exp_f32 v76, v76
    v_exp_f32 v77, v77
    v_exp_f32 v78, v78
    v_exp_f32 v79, v79
    v_cvt_pk_bf16_f32 v116, v72, v73
    v_cvt_pk_bf16_f32 v117, v74, v75
    v_cvt_pk_bf16_f32 v118, v76, v77
    v_cvt_pk_bf16_f32 v119, v78, v79
    s_waitcnt lgkmcnt(0)
    v_mfma_f32_32x32x16_bf16 v[64:79], v[128:131], a[104:107], v[32:47]
    s_waitcnt vmcnt(12)
    s_barrier
    ds_read_b128 v[120:123], v23 offset:0
    v_exp_f32 v48, v48
    v_exp_f32 v49, v49
    s_add_u32 m0, s18, 131072
    v_exp_f32 v50, v50
    v_exp_f32 v51, v51
    v_mfma_f32_32x32x16_bf16 v[96:111], v[140:143], v[116:119], v[96:111]
    ds_read_b128 v[124:127], v23 offset:1024
    v_exp_f32 v52, v52
    v_exp_f32 v53, v53
    buffer_load_dwordx4 v2, s[20:23], s31 offen sc1 lds
    v_exp_f32 v54, v54
    v_exp_f32 v55, v55
    v_smfmac_f32_16x16x64_bf16 v[156:159], v[160:163], v[112:119], v16
    buffer_load_dwordx4 v2, s[20:23], s31 offen offset:1024 sc1 lds
    v_cvt_pk_bf16_f32 v112, v48, v49
    v_cvt_pk_bf16_f32 v113, v50, v51
    v_cvt_pk_bf16_f32 v114, v52, v53
    v_cvt_pk_bf16_f32 v115, v54, v55
    s_add_u32 m0, s18, 139264
    v_mfma_f32_32x32x16_bf16 v[64:79], v[132:135], a[108:111], v[64:79]
    ds_read_b64_tr_b16 v[136:137], v4 offset:8192
    v_exp_f32 v56, v56
    v_exp_f32 v57, v57
    buffer_load_dwordx4 v3, s[20:23], s31 offen sc1 lds
    v_exp_f32 v58, v58
    v_exp_f32 v59, v59
    v_mfma_f32_32x32x16_bf16 v[80:95], v[144:147], v[112:115], v[80:95]
    v_exp_f32 v60, v60
    v_exp_f32 v61, v61
    buffer_load_dwordx4 v6, s[20:23], s31 offen offset:1024 sc1 lds
    s_add_u32 s31, s31, 8192
    s_and_b32 s31, s31, 0x1ffff
    v_exp_f32 v62, v62
    v_exp_f32 v63, v63
    buffer_load_dwordx4 v[176:179], v7, s[40:43], s45 offen
    s_add_u32 s45, s45, 0x100000
    v_cvt_pk_bf16_f32 v116, v56, v57
    v_cvt_pk_bf16_f32 v117, v58, v59
    v_cvt_pk_bf16_f32 v118, v60, v61
    v_cvt_pk_bf16_f32 v119, v62, v63
    s_waitcnt lgkmcnt(1)
    v_mfma_f32_32x32x16_bf16 v[48:63], v[120:123], a[96:99], v[32:47]
    ds_read_b64_tr_b16 v[138:139], v5 offset:8192
    v_exp_f32 v64, v64
    v_exp_f32 v65, v65
    v_exp_f32 v66, v66
    v_exp_f32 v67, v67
    v_mfma_f32_32x32x16_bf16 v[80:95], v[148:151], v[116:119], v[80:95]
    ds_read_b64_tr_b16 v[140:141], v4 offset:8448
    v_exp_f32 v68, v68
    v_exp_f32 v69, v69
    v_exp_f32 v70, v70
    v_exp_f32 v71, v71
    v_smfmac_f32_16x16x64_bf16 v[152:155], v[160:163], v[112:119], v16
    v_cvt_pk_bf16_f32 v112, v64, v65
    v_cvt_pk_bf16_f32 v113, v66, v67
    v_cvt_pk_bf16_f32 v114, v68, v69
    v_cvt_pk_bf16_f32 v115, v70, v71
    v_mfma_f32_32x32x16_bf16 v[48:63], v[124:127], a[100:103], v[48:63]
    ds_read_b64_tr_b16 v[142:143], v5 offset:8448
    v_exp_f32 v72, v72
    v_exp_f32 v73, v73
    v_exp_f32 v74, v74
    v_exp_f32 v75, v75
    v_mfma_f32_32x32x16_bf16 v[96:111], v[144:147], v[112:115], v[96:111]
    v_exp_f32 v76, v76
    v_exp_f32 v77, v77
    v_exp_f32 v78, v78
    v_exp_f32 v79, v79
    v_cvt_pk_bf16_f32 v116, v72, v73
    v_cvt_pk_bf16_f32 v117, v74, v75
    v_cvt_pk_bf16_f32 v118, v76, v77
    v_cvt_pk_bf16_f32 v119, v78, v79
    s_sub_u32 s47, s47, 1
    s_cmp_lg_u32 s47, 0
    s_cbranch_scc1 L_at_loop8
    s_mov_b32 s47, 2
L_at_loop0:
    s_waitcnt lgkmcnt(0)
    v_mfma_f32_32x32x16_bf16 v[64:79], v[120:123], a[104:107], v[32:47]
    ds_read_b128 v[128:131], v23 offset:2048
    v_exp_f32 v48, v48
    v_exp_f32 v49, v49
    v_exp_f32 v50, v50
    v_exp_f32 v51, v51
    v_mfma_f32_32x32x16_bf16 v[96:111], v[148:151], v[116:119], v[96:111]
    ds_read_b128 v[132:135], v23 offset:3072
    v_exp_f32 v52, v52
    v_exp_f32 v53, v53
    v_exp_f32 v54, v54
    v_exp_f32 v55, v55
    v_smfmac_f32_16x16x64_bf16 v[156:159], v[160:163], v[112:119], v16
    v_cvt_pk_bf16_f32 v112, v48, v49
    v_cvt_pk_bf16_f32 v113, v50, v51
    v_cvt_pk_bf16_f32 v114, v52, v53
    v_cvt_pk_bf16_f32 v115, v54, v55
    v_mfma_f32_32x32x16_bf16 v[64:79], v[124:127], a[108:111], v[64:79]
    ds_read_b64_tr_b16 v[144:145], v4 offset:10240
    v_exp_f32 v56, v56
    v_exp_f32 v57, v57
    v_exp_f32 v58, v58
    v_exp_f32 v59, v59
    v_mfma_f32_32x32x16_bf16 v[80:95], v[136:139], v[112:115], v[80:95]
    v_exp_f32 v60, v60
    v_exp_f32 v61, v61
    v_exp_f32 v62, v62
    v_exp_f32 v63, v63
    v_cvt_pk_bf16_f32 v116, v56, v57
    v_cvt_pk_bf16_f32 v117, v58, v59
    v_cvt_pk_bf16_f32 v118, v60, v61
    v_cvt_pk_bf16_f32 v119, v62, v63
    s_waitcnt lgkmcnt(1)
    v_mfma_f32_32x32x16_bf16 v[48:63], v[128:131], a[96:99], v[32:47]
    ds_read_b64_tr_b16 v[146:147], v5 offset:10240
    v_exp_f32 v64, v64
    v_exp_f32 v65, v65
    v_exp_f32 v66, v66
    v_exp_f32 v67, v67
    v_mfma_f32_32x32x16_bf16 v[80:95], v[140:143], v[116:119], v[80:95]
    ds_read_b64_tr_b16 v[148:149], v4 offset:10496
    v_exp_f32 v68, v68
    v_exp_f32 v69, v69
    v_exp_f32 v70, v70
    v_exp_f32 v71, v71
    v_smfmac_f32_16x16x64_bf16 v[152:155], v[160:163], v[112:119], v16
    v_cvt_pk_bf16_f32 v112, v64, v65
    v_cvt_pk_bf16_f32 v113, v66, v67
    v_cvt_pk_bf16_f32 v114, v68, v69
    v_cvt_pk_bf16_f32 v115, v70, v71
    v_mfma_f32_32x32x16_bf16 v[48:63], v[132:135], a[100:103], v[48:63]
    ds_read_b64_tr_b16 v[150:151], v5 offset:10496
    v_exp_f32 v72, v72
    v_exp_f32 v73, v73
    v_exp_f32 v74, v74
    v_exp_f32 v75, v75
    v_mfma_f32_32x32x16_bf16 v[96:111], v[136:139], v[112:115], v[96:111]
    v_exp_f32 v76, v76
    v_exp_f32 v77, v77
    v_exp_f32 v78, v78
    v_exp_f32 v79, v79
    v_cvt_pk_bf16_f32 v116, v72, v73
    v_cvt_pk_bf16_f32 v117, v74, v75
    v_cvt_pk_bf16_f32 v118, v76, v77
    v_cvt_pk_bf16_f32 v119, v78, v79
    s_waitcnt lgkmcnt(0)
    v_mfma_f32_32x32x16_bf16 v[64:79], v[128:131], a[104:107], v[32:47]
    ds_read_b128 v[120:123], v23 offset:4096
    v_exp_f32 v48, v48
    v_exp_f32 v49, v49
    v_exp_f32 v50, v50
    v_exp_f32 v51, v51
    v_mfma_f32_32x32x16_bf16 v[96:111], v[140:143], v[116:119], v[96:111]
    ds_read_b128 v[124:127], v23 offset:5120
    v_exp_f32 v52, v52
    v_exp_f32 v53, v53
    v_exp_f32 v54, v54
    v_exp_f32 v55, v55
    v_smfmac_f32_16x16x64_bf16 v[156:159], v[160:163], v[112:119], v16
    v_cvt_pk_bf16_f32 v112, v48, v49
    v_cvt_pk_bf16_f32 v113, v50, v51
    v_cvt_pk_bf16_f32 v114, v52, v53
    v_cvt_pk_bf16_f32 v115, v54, v55
    v_mfma_f32_32x32x16_bf16 v[64:79], v[132:135], a[108:111], v[64:79]
    ds_read_b64_tr_b16 v[136:137], v4 offset:12288
    v_exp_f32 v56, v56
    v_exp_f32 v57, v57
    v_exp_f32 v58, v58
    v_exp_f32 v59, v59
    v_mfma_f32_32x32x16_bf16 v[80:95], v[144:147], v[112:115], v[80:95]
    v_exp_f32 v60, v60
    v_exp_f32 v61, v61
    v_exp_f32 v62, v62
    v_exp_f32 v63, v63
    v_cvt_pk_bf16_f32 v116, v56, v57
    v_cvt_pk_bf16_f32 v117, v58, v59
    v_cvt_pk_bf16_f32 v118, v60, v61
    v_cvt_pk_bf16_f32 v119, v62, v63
    s_waitcnt lgkmcnt(1)
    v_mfma_f32_32x32x16_bf16 v[48:63], v[120:123], a[96:99], v[32:47]
    ds_read_b64_tr_b16 v[138:139], v5 offset:12288
    v_exp_f32 v64, v64
    v_exp_f32 v65, v65
    v_exp_f32 v66, v66
    v_exp_f32 v67, v67
    v_mfma_f32_32x32x16_bf16 v[80:95], v[148:151], v[116:119], v[80:95]
    ds_read_b64_tr_b16 v[140:141], v4 offset:12544
    v_exp_f32 v68, v68
    v_exp_f32 v69, v69
    v_exp_f32 v70, v70
    v_exp_f32 v71, v71
    v_smfmac_f32_16x16x64_bf16 v[152:155], v[160:163], v[112:119], v16
    v_cvt_pk_bf16_f32 v112, v64, v65
    v_cvt_pk_bf16_f32 v113, v66, v67
    v_cvt_pk_bf16_f32 v114, v68, v69
    v_cvt_pk_bf16_f32 v115, v70, v71
    v_mfma_f32_32x32x16_bf16 v[48:63], v[124:127], a[100:103], v[48:63]
    ds_read_b64_tr_b16 v[142:143], v5 offset:12544
    v_exp_f32 v72, v72
    v_exp_f32 v73, v73
    v_exp_f32 v74, v74
    v_exp_f32 v75, v75
    v_mfma_f32_32x32x16_bf16 v[96:111], v[144:147], v[112:115], v[96:111]
    v_exp_f32 v76, v76
    v_exp_f32 v77, v77
    v_exp_f32 v78, v78
    v_exp_f32 v79, v79
    v_cvt_pk_bf16_f32 v116, v72, v73
    v_cvt_pk_bf16_f32 v117, v74, v75
    v_cvt_pk_bf16_f32 v118, v76, v77
    v_cvt_pk_bf16_f32 v119, v78, v79
    s_waitcnt lgkmcnt(0)
    v_mfma_f32_32x32x16_bf16 v[64:79], v[120:123], a[104:107], v[32:47]
    ds_read_b128 v[128:131], v23 offset:6144
    v_exp_f32 v48, v48
    v_exp_f32 v49, v49
    v_exp_f32 v50, v50
    v_exp_f32 v51, v51
    v_mfma_f32_32x32x16_bf16 v[96:111], v[148:151], v[116:119], v[96:111]
    ds_read_b128 v[132:135], v23 offset:7168
    v_exp_f32 v52, v52
    v_exp_f32 v53, v53
    v_exp_f32 v54, v54
    v_exp_f32 v55, v55
    v_smfmac_f32_16x16x64_bf16 v[156:159], v[160:163], v[112:119], v16
    v_cvt_pk_bf16_f32 v112, v48, v49
    v_cvt_pk_bf16_f32 v113, v50, v51
    v_cvt_pk_bf16_f32 v114, v52, v53
    v_cvt_pk_bf16_f32 v115, v54, v55
    v_mfma_f32_32x32x16_bf16 v[64:79], v[124:127], a[108:111], v[64:79]
    ds_read_b64_tr_b16 v[144:145], v4 offset:14336
    v_exp_f32 v56, v56
    v_exp_f32 v57, v57
    v_exp_f32 v58, v58
    v_exp_f32 v59, v59
    v_mfma_f32_32x32x16_bf16 v[80:95], v[136:139], v[112:115], v[80:95]
    v_exp_f32 v60, v60
    v_exp_f32 v61, v61
    v_exp_f32 v62, v62
    v_exp_f32 v63, v63
    v_cvt_pk_bf16_f32 v116, v56, v57
    v_cvt_pk_bf16_f32 v117, v58, v59
    v_cvt_pk_bf16_f32 v118, v60, v61
    v_cvt_pk_bf16_f32 v119, v62, v63
    s_waitcnt lgkmcnt(1)
    v_mfma_f32_32x32x16_bf16 v[48:63], v[128:131], a[96:99], v[32:47]
    ds_read_b64_tr_b16 v[146:147], v5 offset:14336
    v_exp_f32 v64, v64
    v_exp_f32 v65, v65
    v_exp_f32 v66, v66
    v_exp_f32 v67, v67
    v_mfma_f32_32x32x16_bf16 v[80:95], v[140:143], v[116:119], v[80:95]
    ds_read_b64_tr_b16 v[148:149], v4 offset:14592
    v_exp_f32 v68, v68
    v_exp_f32 v69, v69
    v_exp_f32 v70, v70
    v_exp_f32 v71, v71
    v_smfmac_f32_16x16x64_bf16 v[152:155], v[160:163], v[112:119], v16
    v_cvt_pk_bf16_f32 v112, v64, v65
    v_cvt_pk_bf16_f32 v113, v66, v67
    v_cvt_pk_bf16_f32 v114, v68, v69
    v_cvt_pk_bf16_f32 v115, v70, v71
    v_mfma_f32_32x32x16_bf16 v[48:63], v[132:135], a[100:103], v[48:63]
    ds_read_b64_tr_b16 v[150:151], v5 offset:14592
    v_exp_f32 v72, v72
    v_exp_f32 v73, v73
    v_exp_f32 v74, v74
    v_exp_f32 v75, v75
    v_mfma_f32_32x32x16_bf16 v[96:111], v[136:139], v[112:115], v[96:111]
    v_exp_f32 v76, v76
    v_exp_f32 v77, v77
    v_exp_f32 v78, v78
    v_exp_f32 v79, v79
    v_cvt_pk_bf16_f32 v116, v72, v73
    v_cvt_pk_bf16_f32 v117, v74, v75
    v_cvt_pk_bf16_f32 v118, v76, v77
    v_cvt_pk_bf16_f32 v119, v78, v79
    s_waitcnt lgkmcnt(0)
    v_mfma_f32_32x32x16_bf16 v[64:79], v[128:131], a[104:107], v[32:47]
    s_waitcnt vmcnt(6)
    s_barrier
    ds_read_b128 v[120:123], v23 offset:16384
    v_exp_f32 v48, v48
    v_exp_f32 v49, v49
    s_add_u32 m0, s18, 98304
    v_exp_f32 v50, v50
    v_exp_f32 v51, v51
    v_mfma_f32_32x32x16_bf16 v[96:111], v[140:143], v[116:119], v[96:111]
    ds_read_b128 v[124:127], v23 offset:17408
    v_exp_f32 v52, v52
    v_exp_f32 v53, v53
    buffer_load_dwordx4 v2, s[20:23], s31 offen sc1 lds
    v_exp_f32 v54, v54
    v_exp_f32 v55, v55
    v_smfmac_f32_16x16x64_bf16 v[156:159], v[160:163], v[112:119], v16
    buffer_load_dwordx4 v2, s[20:23], s31 offen offset:1024 sc1 lds
    v_cvt_pk_bf16_f32 v112, v48, v49
    v_cvt_pk_bf16_f32 v113, v50, v51
    v_cvt_pk_bf16_f32 v114, v52, v53
    v_cvt_pk_bf16_f32 v115, v54, v55
    s_add_u32 m0, s18, 106496
    v_mfma_f32_32x32x16_bf16 v[64:79], v[132:135], a[108:111], v[64:79]
    ds_read_b64_tr_b16 v[136:137], v4 offset:24576
    v_exp_f32 v56, v56
    v_exp_f32 v57, v57
    buffer_load_dwordx4 v3, s[20:23], s31 offen sc1 lds
    v_exp_f32 v58, v58
    v_exp_f32 v59, v59
    v_mfma_f32_32x32x16_bf16 v[80:95], v[144:147], v[112:115], v[80:95]
    v_exp_f32 v60, v60
    v_exp_f32 v61, v61
    buffer_load_dwordx4 v6, s[20:23], s31 offen offset:1024 sc1 lds
    s_add_u32 s31, s31, 8192
    s_and_b32 s31, s31, 0x1ffff
    v_exp_f32 v62, v62
    v_exp_f32 v63, v63
    buffer_load_dwordx4 v[176:179], v7, s[36:39], s44 offen
    s_add_u32 s44, s44, 0x100000
    v_cvt_pk_bf16_f32 v116, v56, v57
    v_cvt_pk_bf16_f32 v117, v58, v59
    v_cvt_pk_bf16_f32 v118, v60, v61
    v_cvt_pk_bf16_f32 v119, v62, v63
    s_waitcnt lgkmcnt(1)
    v_mfma_f32_32x32x16_bf16 v[48:63], v[120:123], a[96:99], v[32:47]
    ds_read_b64_tr_b16 v[138:139], v5 offset:24576
    v_exp_f32 v64, v64
    v_exp_f32 v65, v65
    v_exp_f32 v66, v66
    v_exp_f32 v67, v67
    v_mfma_f32_32x32x16_bf16 v[80:95], v[148:151], v[116:119], v[80:95]
    ds_read_b64_tr_b16 v[140:141], v4 offset:24832
    v_exp_f32 v68, v68
    v_exp_f32 v69, v69
    v_exp_f32 v70, v70
    v_exp_f32 v71, v71
    v_smfmac_f32_16x16x64_bf16 v[152:155], v[160:163], v[112:119], v16
    v_cvt_pk_bf16_f32 v112, v64, v65
    v_cvt_pk_bf16_f32 v113, v66, v67
    v_cvt_pk_bf16_f32 v114, v68, v69
    v_cvt_pk_bf16_f32 v115, v70, v71
    v_mfma_f32_32x32x16_bf16 v[48:63], v[124:127], a[100:103], v[48:63]
    ds_read_b64_tr_b16 v[142:143], v5 offset:24832
    v_exp_f32 v72, v72
    v_exp_f32 v73, v73
    v_exp_f32 v74, v74
    v_exp_f32 v75, v75
    v_mfma_f32_32x32x16_bf16 v[96:111], v[144:147], v[112:115], v[96:111]
    v_exp_f32 v76, v76
    v_exp_f32 v77, v77
    v_exp_f32 v78, v78
    v_exp_f32 v79, v79
    v_cvt_pk_bf16_f32 v116, v72, v73
    v_cvt_pk_bf16_f32 v117, v74, v75
    v_cvt_pk_bf16_f32 v118, v76, v77
    v_cvt_pk_bf16_f32 v119, v78, v79
    s_waitcnt lgkmcnt(0)
    v_mfma_f32_32x32x16_bf16 v[64:79], v[120:123], a[104:107], v[32:47]
    ds_read_b128 v[128:131], v23 offset:18432
    v_exp_f32 v48, v48
    v_exp_f32 v49, v49
    v_exp_f32 v50, v50
    v_exp_f32 v51, v51
    v_mfma_f32_32x32x16_bf16 v[96:111], v[148:151], v[116:119], v[96:111]
    ds_read_b128 v[132:135], v23 offset:19456
    v_exp_f32 v52, v52
    v_exp_f32 v53, v53
    v_exp_f32 v54, v54
    v_exp_f32 v55, v55
    v_smfmac_f32_16x16x64_bf16 v[156:159], v[160:163], v[112:119], v16
    v_cvt_pk_bf16_f32 v112, v48, v49
    v_cvt_pk_bf16_f32 v113, v50, v51
    v_cvt_pk_bf16_f32 v114, v52, v53
    v_cvt_pk_bf16_f32 v115, v54, v55
    v_mfma_f32_32x32x16_bf16 v[64:79], v[124:127], a[108:111], v[64:79]
    ds_read_b64_tr_b16 v[144:145], v4 offset:26624
    v_exp_f32 v56, v56
    v_exp_f32 v57, v57
    v_exp_f32 v58, v58
    v_exp_f32 v59, v59
    v_mfma_f32_32x32x16_bf16 v[80:95], v[136:139], v[112:115], v[80:95]
    v_exp_f32 v60, v60
    v_exp_f32 v61, v61
    v_exp_f32 v62, v62
    v_exp_f32 v63, v63
    v_cvt_pk_bf16_f32 v116, v56, v57
    v_cvt_pk_bf16_f32 v117, v58, v59
    v_cvt_pk_bf16_f32 v118, v60, v61
    v_cvt_pk_bf16_f32 v119, v62, v63
    s_waitcnt lgkmcnt(1)
    v_mfma_f32_32x32x16_bf16 v[48:63], v[128:131], a[96:99], v[32:47]
    ds_read_b64_tr_b16 v[146:147], v5 offset:26624
    v_exp_f32 v64, v64
    v_exp_f32 v65, v65
    v_exp_f32 v66, v66
    v_exp_f32 v67, v67
    v_mfma_f32_32x32x16_bf16 v[80:95], v[140:143], v[116:119], v[80:95]
    ds_read_b64_tr_b16 v[148:149], v4 offset:26880
    v_exp_f32 v68, v68
    v_exp_f32 v69, v69
    v_exp_f32 v70, v70
    v_exp_f32 v71, v71
    v_smfmac_f32_16x16x64_bf16 v[152:155], v[160:163], v[112:119], v16
    v_cvt_pk_bf16_f32 v112, v64, v65
    v_cvt_pk_bf16_f32 v113, v66, v67
    v_cvt_pk_bf16_f32 v114, v68, v69
    v_cvt_pk_bf16_f32 v115, v70, v71
    v_mfma_f32_32x32x16_bf16 v[48:63], v[132:135], a[100:103], v[48:63]
    ds_read_b64_tr_b16 v[150:151], v5 offset:26880
    v_exp_f32 v72, v72
    v_exp_f32 v73, v73
    v_exp_f32 v74, v74
    v_exp_f32 v75, v75
    v_mfma_f32_32x32x16_bf16 v[96:111], v[136:139], v[112:115], v[96:111]
    v_exp_f32 v76, v76
    v_exp_f32 v77, v77
    v_exp_f32 v78, v78
    v_exp_f32 v79, v79
    v_cvt_pk_bf16_f32 v116, v72, v73
    v_cvt_pk_bf16_f32 v117, v74, v75
    v_cvt_pk_bf16_f32 v118, v76, v77
    v_cvt_pk_bf16_f32 v119, v78, v79
    s_waitcnt lgkmcnt(0)
    v_mfma_f32_32x32x16_bf16 v[64:79], v[128:131], a[104:107], v[32:47]
    ds_read_b128 v[120:123], v23 offset:20480
    v_exp_f32 v48, v48
    v_exp_f32 v49, v49
    v_exp_f32 v50, v50
    v_exp_f32 v51, v51
    v_mfma_f32_32x32x16_bf16 v[96:111], v[140:143], v[116:119], v[96:111]
    ds_read_b128 v[124:127], v23 offset:21504
    v_exp_f32 v52, v52
    v_exp_f32 v53, v53
    v_exp_f32 v54, v54
    v_exp_f32 v55, v55
    v_smfmac_f32_16x16x64_bf16 v[156:159], v[160:163], v[112:119], v16
    v_cvt_pk_bf16_f32 v112, v48, v49
    v_cvt_pk_bf16_f32 v113, v50, v51
    v_cvt_pk_bf16_f32 v114, v52, v53
    v_cvt_pk_bf16_f32 v115, v54, v55
    v_mfma_f32_32x32x16_bf16 v[64:79], v[132:135], a[108:111], v[64:79]
    ds_read_b64_tr_b16 v[136:137], v4 offset:28672
    v_exp_f32 v56, v56
    v_exp_f32 v57, v57
    v_exp_f32 v58, v58
    v_exp_f32 v59, v59
    v_mfma_f32_32x32x16_bf16 v[80:95], v[144:147], v[112:115], v[80:95]
    v_exp_f32 v60, v60
    v_exp_f32 v61, v61
    v_exp_f32 v62, v62
    v_exp_f32 v63, v63
    v_cvt_pk_bf16_f32 v116, v56, v57
    v_cvt_pk_bf16_f32 v117, v58, v59
    v_cvt_pk_bf16_f32 v118, v60, v61
    v_cvt_pk_bf16_f32 v119, v62, v63
    s_waitcnt lgkmcnt(1)
    v_mfma_f32_32x32x16_bf16 v[48:63], v[120:123], a[96:99], v[32:47]
    ds_read_b64_tr_b16 v[138:139], v5 offset:28672
    v_exp_f32 v64, v64
    v_exp_f32 v65, v65
    v_exp_f32 v66, v66
    v_exp_f32 v67, v67
    v_mfma_f32_32x32x16_bf16 v[80:95], v[148:151], v[116:119], v[80:95]
    ds_read_b64_tr_b16 v[140:141], v4 offset:28928
    v_exp_f32 v68, v68
    v_exp_f32 v69, v69
    v_exp_f32 v70, v70
    v_exp_f32 v71, v71
    v_smfmac_f32_16x16x64_bf16 v[152:155], v[160:163], v[112:119], v16
    v_cvt_pk_bf16_f32 v112, v64, v65
    v_cvt_pk_bf16_f32 v113, v66, v67
    v_cvt_pk_bf16_f32 v114, v68, v69
    v_cvt_pk_bf16_f32 v115, v70, v71
    v_mfma_f32_32x32x16_bf16 v[48:63], v[124:127], a[100:103], v[48:63]
    ds_read_b64_tr_b16 v[142:143], v5 offset:28928
    v_exp_f32 v72, v72
    v_exp_f32 v73, v73
    v_exp_f32 v74, v74
    v_exp_f32 v75, v75
    v_mfma_f32_32x32x16_bf16 v[96:111], v[144:147], v[112:115], v[96:111]
    v_exp_f32 v76, v76
    v_exp_f32 v77, v77
    v_exp_f32 v78, v78
    v_exp_f32 v79, v79
    v_cvt_pk_bf16_f32 v116, v72, v73
    v_cvt_pk_bf16_f32 v117, v74, v75
    v_cvt_pk_bf16_f32 v118, v76, v77
    v_cvt_pk_bf16_f32 v119, v78, v79
    s_waitcnt lgkmcnt(0)
    v_mfma_f32_32x32x16_bf16 v[64:79], v[120:123], a[104:107], v[32:47]
    ds_read_b128 v[128:131], v23 offset:22528
    v_exp_f32 v48, v48
    v_exp_f32 v49, v49
    v_exp_f32 v50, v50
    v_exp_f32 v51, v51
    v_mfma_f32_32x32x16_bf16 v[96:111], v[148:151], v[116:119], v[96:111]
    ds_read_b128 v[132:135], v23 offset:23552
    v_exp_f32 v52, v52
    v_exp_f32 v53, v53
    v_exp_f32 v54, v54
    v_exp_f32 v55, v55
    v_smfmac_f32_16x16x64_bf16 v[156:159], v[160:163], v[112:119], v16
    v_cvt_pk_bf16_f32 v112, v48, v49
    v_cvt_pk_bf16_f32 v113, v50, v51
    v_cvt_pk_bf16_f32 v114, v52, v53
    v_cvt_pk_bf16_f32 v115, v54, v55
    v_mfma_f32_32x32x16_bf16 v[64:79], v[124:127], a[108:111], v[64:79]
    ds_read_b64_tr_b16 v[144:145], v4 offset:30720
    v_exp_f32 v56, v56
    v_exp_f32 v57, v57
    v_exp_f32 v58, v58
    v_exp_f32 v59, v59
    v_mfma_f32_32x32x16_bf16 v[80:95], v[136:139], v[112:115], v[80:95]
    v_exp_f32 v60, v60
    v_exp_f32 v61, v61
    v_exp_f32 v62, v62
    v_exp_f32 v63, v63
    v_cvt_pk_bf16_f32 v116, v56, v57
    v_cvt_pk_bf16_f32 v117, v58, v59
    v_cvt_pk_bf16_f32 v118, v60, v61
    v_cvt_pk_bf16_f32 v119, v62, v63
    s_waitcnt lgkmcnt(1)
    v_mfma_f32_32x32x16_bf16 v[48:63], v[128:131], a[96:99], v[32:47]
    ds_read_b64_tr_b16 v[146:147], v5 offset:30720
    v_exp_f32 v64, v64
    v_exp_f32 v65, v65
    v_exp_f32 v66, v66
    v_exp_f32 v67, v67
    v_mfma_f32_32x32x16_bf16 v[80:95], v[140:143], v[116:119], v[80:95]
    ds_read_b64_tr_b16 v[148:149], v4 offset:30976
    v_exp_f32 v68, v68
    v_exp_f32 v69, v69
    v_exp_f32 v70, v70
    v_exp_f32 v71, v71
    v_smfmac_f32_16x16x64_bf16 v[152:155], v[160:163], v[112:119], v16
    v_cvt_pk_bf16_f32 v112, v64, v65
    v_cvt_pk_bf16_f32 v113, v66, v67
    v_cvt_pk_bf16_f32 v114, v68, v69
    v_cvt_pk_bf16_f32 v115, v70, v71
    v_mfma_f32_32x32x16_bf16 v[48:63], v[132:135], a[100:103], v[48:63]
    ds_read_b64_tr_b16 v[150:151], v5 offset:30976
    v_exp_f32 v72, v72
    v_exp_f32 v73, v73
    v_exp_f32 v74, v74
    v_exp_f32 v75, v75
    v_mfma_f32_32x32x16_bf16 v[96:111], v[136:139], v[112:115], v[96:111]
    v_exp_f32 v76, v76
    v_exp_f32 v77, v77
    v_exp_f32 v78, v78
    v_exp_f32 v79, v79
    v_cvt_pk_bf16_f32 v116, v72, v73
    v_cvt_pk_bf16_f32 v117, v74, v75
    v_cvt_pk_bf16_f32 v118, v76, v77
    v_cvt_pk_bf16_f32 v119, v78, v79
    s_waitcnt lgkmcnt(0)
    v_mfma_f32_32x32x16_bf16 v[64:79], v[128:131], a[104:107], v[32:47]
    s_waitcnt vmcnt(6)
    s_barrier
    ds_read_b128 v[120:123], v23 offset:32768
    v_exp_f32 v48, v48
    v_exp_f32 v49, v49
    s_add_u32 m0, s18, 114688
    v_exp_f32 v50, v50
    v_exp_f32 v51, v51
    v_mfma_f32_32x32x16_bf16 v[96:111], v[140:143], v[116:119], v[96:111]
    ds_read_b128 v[124:127], v23 offset:33792
    v_exp_f32 v52, v52
    v_exp_f32 v53, v53
    buffer_load_dwordx4 v2, s[20:23], s31 offen sc1 lds
    v_exp_f32 v54, v54
    v_exp_f32 v55, v55
    v_smfmac_f32_16x16x64_bf16 v[156:159], v[160:163], v[112:119], v16
    buffer_load_dwordx4 v2, s[20:23], s31 offen offset:1024 sc1 lds
    v_cvt_pk_bf16_f32 v112, v48, v49
    v_cvt_pk_bf16_f32 v113, v50, v51
    v_cvt_pk_bf16_f32 v114, v52, v53
    v_cvt_pk_bf16_f32 v115, v54, v55
    s_add_u32 m0, s18, 122880
    v_mfma_f32_32x32x16_bf16 v[64:79], v[132:135], a[108:111], v[64:79]
    ds_read_b64_tr_b16 v[136:137], v4 offset:40960
    v_exp_f32 v56, v56
    v_exp_f32 v57, v57
    buffer_load_dwordx4 v3, s[20:23], s31 offen sc1 lds
    v_exp_f32 v58, v58
    v_exp_f32 v59, v59
    v_mfma_f32_32x32x16_bf16 v[80:95], v[144:147], v[112:115], v[80:95]
    v_exp_f32 v60, v60
    v_exp_f32 v61, v61
    buffer_load_dwordx4 v6, s[20:23], s31 offen offset:1024 sc1 lds
    s_add_u32 s31, s31, 8192
    s_and_b32 s31, s31, 0x1ffff
    v_exp_f32 v62, v62
    v_exp_f32 v63, v63
    buffer_load_dwordx4 v[176:179], v7, s[40:43], s45 offen
    s_add_u32 s45, s45, 0x100000
    v_cvt_pk_bf16_f32 v116, v56, v57
    v_cvt_pk_bf16_f32 v117, v58, v59
    v_cvt_pk_bf16_f32 v118, v60, v61
    v_cvt_pk_bf16_f32 v119, v62, v63
    s_waitcnt lgkmcnt(1)
    v_mfma_f32_32x32x16_bf16 v[48:63], v[120:123], a[96:99], v[32:47]
    ds_read_b64_tr_b16 v[138:139], v5 offset:40960
    v_exp_f32 v64, v64
    v_exp_f32 v65, v65
    v_exp_f32 v66, v66
    v_exp_f32 v67, v67
    v_mfma_f32_32x32x16_bf16 v[80:95], v[148:151], v[116:119], v[80:95]
    ds_read_b64_tr_b16 v[140:141], v4 offset:41216
    v_exp_f32 v68, v68
    v_exp_f32 v69, v69
    v_exp_f32 v70, v70
    v_exp_f32 v71, v71
    v_smfmac_f32_16x16x64_bf16 v[152:155], v[160:163], v[112:119], v16
    v_cvt_pk_bf16_f32 v112, v64, v65
    v_cvt_pk_bf16_f32 v113, v66, v67
    v_cvt_pk_bf16_f32 v114, v68, v69
    v_cvt_pk_bf16_f32 v115, v70, v71
    v_mfma_f32_32x32x16_bf16 v[48:63], v[124:127], a[100:103], v[48:63]
    ds_read_b64_tr_b16 v[142:143], v5 offset:41216
    v_exp_f32 v72, v72
    v_exp_f32 v73, v73
    v_exp_f32 v74, v74
    v_exp_f32 v75, v75
    v_mfma_f32_32x32x16_bf16 v[96:111], v[144:147], v[112:115], v[96:111]
    v_exp_f32 v76, v76
    v_exp_f32 v77, v77
    v_exp_f32 v78, v78
    v_exp_f32 v79, v79
    v_cvt_pk_bf16_f32 v116, v72, v73
    v_cvt_pk_bf16_f32 v117, v74, v75
    v_cvt_pk_bf16_f32 v118, v76, v77
    v_cvt_pk_bf16_f32 v119, v78, v79
    s_waitcnt lgkmcnt(0)
    v_mfma_f32_32x32x16_bf16 v[64:79], v[120:123], a[104:107], v[32:47]
    ds_read_b128 v[128:131], v23 offset:34816
    v_exp_f32 v48, v48
    v_exp_f32 v49, v49
    v_exp_f32 v50, v50
    v_exp_f32 v51, v51
    v_mfma_f32_32x32x16_bf16 v[96:111], v[148:151], v[116:119], v[96:111]
    ds_read_b128 v[132:135], v23 offset:35840
    v_exp_f32 v52, v52
    v_exp_f32 v53, v53
    v_exp_f32 v54, v54
    v_exp_f32 v55, v55
    v_smfmac_f32_16x16x64_bf16 v[156:159], v[160:163], v[112:119], v16
    v_cvt_pk_bf16_f32 v112, v48, v49
    v_cvt_pk_bf16_f32 v113, v50, v51
    v_cvt_pk_bf16_f32 v114, v52, v53
    v_cvt_pk_bf16_f32 v115, v54, v55
    v_mfma_f32_32x32x16_bf16 v[64:79], v[124:127], a[108:111], v[64:79]
    ds_read_b64_tr_b16 v[144:145], v4 offset:43008
    v_exp_f32 v56, v56
    v_exp_f32 v57, v57
    v_exp_f32 v58, v58
    v_exp_f32 v59, v59
    v_mfma_f32_32x32x16_bf16 v[80:95], v[136:139], v[112:115], v[80:95]
    v_exp_f32 v60, v60
    v_exp_f32 v61, v61
    v_exp_f32 v62, v62
    v_exp_f32 v63, v63
    v_cvt_pk_bf16_f32 v116, v56, v57
    v_cvt_pk_bf16_f32 v117, v58, v59
    v_cvt_pk_bf16_f32 v118, v60, v61
    v_cvt_pk_bf16_f32 v119, v62, v63
    s_waitcnt lgkmcnt(1)
    v_mfma_f32_32x32x16_bf16 v[48:63], v[128:131], a[96:99], v[32:47]
    ds_read_b64_tr_b16 v[146:147], v5 offset:43008
    v_exp_f32 v64, v64
    v_exp_f32 v65, v65
    v_exp_f32 v66, v66
    v_exp_f32 v67, v67
    v_mfma_f32_32x32x16_bf16 v[80:95], v[140:143], v[116:119], v[80:95]
    ds_read_b64_tr_b16 v[148:149], v4 offset:43264
    v_exp_f32 v68, v68
    v_exp_f32 v69, v69
    v_exp_f32 v70, v70
    v_exp_f32 v71, v71
    v_smfmac_f32_16x16x64_bf16 v[152:155], v[160:163], v[112:119], v16
    v_cvt_pk_bf16_f32 v112, v64, v65
    v_cvt_pk_bf16_f32 v113, v66, v67
    v_cvt_pk_bf16_f32 v114, v68, v69
    v_cvt_pk_bf16_f32 v115, v70, v71
    v_mfma_f32_32x32x16_bf16 v[48:63], v[132:135], a[100:103], v[48:63]
    ds_read_b64_tr_b16 v[150:151], v5 offset:43264
    v_exp_f32 v72, v72
    v_exp_f32 v73, v73
    v_exp_f32 v74, v74
    v_exp_f32 v75, v75
    v_mfma_f32_32x32x16_bf16 v[96:111], v[136:139], v[112:115], v[96:111]
    v_exp_f32 v76, v76
    v_exp_f32 v77, v77
    v_exp_f32 v78, v78
    v_exp_f32 v79, v79
    v_cvt_pk_bf16_f32 v116, v72, v73
    v_cvt_pk_bf16_f32 v117, v74, v75
    v_cvt_pk_bf16_f32 v118, v76, v77
    v_cvt_pk_bf16_f32 v119, v78, v79
    s_waitcnt lgkmcnt(0)
    v_mfma_f32_32x32x16_bf16 v[64:79], v[128:131], a[104:107], v[32:47]
    ds_read_b128 v[120:123], v23 offset:36864
    v_exp_f32 v48, v48
    v_exp_f32 v49, v49
    v_exp_f32 v50, v50
    v_exp_f32 v51, v51
    v_mfma_f32_32x32x16_bf16 v[96:111], v[140:143], v[116:119], v[96:111]
    ds_read_b128 v[124:127], v23 offset:37888
    v_exp_f32 v52, v52
    v_exp_f32 v53, v53
    v_exp_f32 v54, v54
    v_exp_f32 v55, v55
    v_smfmac_f32_16x16x64_bf16 v[156:159], v[160:163], v[112:119], v16
    v_cvt_pk_bf16_f32 v112, v48, v49
    v_cvt_pk_bf16_f32 v113, v50, v51
    v_cvt_pk_bf16_f32 v114, v52, v53
    v_cvt_pk_bf16_f32 v115, v54, v55
    v_mfma_f32_32x32x16_bf16 v[64:79], v[132:135], a[108:111], v[64:79]
    ds_read_b64_tr_b16 v[136:137], v4 offset:45056
    v_exp_f32 v56, v56
    v_exp_f32 v57, v57
    v_exp_f32 v58, v58
    v_exp_f32 v59, v59
    v_mfma_f32_32x32x16_bf16 v[80:95], v[144:147], v[112:115], v[80:95]
    v_exp_f32 v60, v60
    v_exp_f32 v61, v61
    v_exp_f32 v62, v62
    v_exp_f32 v63, v63
    v_cvt_pk_bf16_f32 v116, v56, v57
    v_cvt_pk_bf16_f32 v117, v58, v59
    v_cvt_pk_bf16_f32 v118, v60, v61
    v_cvt_pk_bf16_f32 v119, v62, v63
    s_waitcnt lgkmcnt(1)
    v_mfma_f32_32x32x16_bf16 v[48:63], v[120:123], a[96:99], v[32:47]
    ds_read_b64_tr_b16 v[138:139], v5 offset:45056
    v_exp_f32 v64, v64
    v_exp_f32 v65, v65
    v_exp_f32 v66, v66
    v_exp_f32 v67, v67
    v_mfma_f32_32x32x16_bf16 v[80:95], v[148:151], v[116:119], v[80:95]
    ds_read_b64_tr_b16 v[140:141], v4 offset:45312
    v_exp_f32 v68, v68
    v_exp_f32 v69, v69
    v_exp_f32 v70, v70
    v_exp_f32 v71, v71
    v_smfmac_f32_16x16x64_bf16 v[152:155], v[160:163], v[112:119], v16
    v_cvt_pk_bf16_f32 v112, v64, v65
    v_cvt_pk_bf16_f32 v113, v66, v67
    v_cvt_pk_bf16_f32 v114, v68, v69
    v_cvt_pk_bf16_f32 v115, v70, v71
    v_mfma_f32_32x32x16_bf16 v[48:63], v[124:127], a[100:103], v[48:63]
    ds_read_b64_tr_b16 v[142:143], v5 offset:45312
    v_exp_f32 v72, v72
    v_exp_f32 v73, v73
    v_exp_f32 v74, v74
    v_exp_f32 v75, v75
    v_mfma_f32_32x32x16_bf16 v[96:111], v[144:147], v[112:115], v[96:111]
    v_exp_f32 v76, v76
    v_exp_f32 v77, v77
    v_exp_f32 v78, v78
    v_exp_f32 v79, v79
    v_cvt_pk_bf16_f32 v116, v72, v73
    v_cvt_pk_bf16_f32 v117, v74, v75
    v_cvt_pk_bf16_f32 v118, v76, v77
    v_cvt_pk_bf16_f32 v119, v78, v79
    s_waitcnt lgkmcnt(0)
    v_mfma_f32_32x32x16_bf16 v[64:79], v[120:123], a[104:107], v[32:47]
    ds_read_b128 v[128:131], v23 offset:38912
    v_exp_f32 v48, v48
    v_exp_f32 v49, v49
    v_exp_f32 v50, v50
    v_exp_f32 v51, v51
    v_mfma_f32_32x32x16_bf16 v[96:111], v[148:151], v[116:119], v[96:111]
    ds_read_b128 v[132:135], v23 offset:39936
    v_exp_f32 v52, v52
    v_exp_f32 v53, v53
    v_exp_f32 v54, v54
    v_exp_f32 v55, v55
    v_smfmac_f32_16x16x64_bf16 v[156:159], v[160:163], v[112:119], v16
    v_cvt_pk_bf16_f32 v112, v48, v49
    v_cvt_pk_bf16_f32 v113, v50, v51
    v_cvt_pk_bf16_f32 v114, v52, v53
    v_cvt_pk_bf16_f32 v115, v54, v55
    v_mfma_f32_32x32x16_bf16 v[64:79], v[124:127], a[108:111], v[64:79]
    ds_read_b64_tr_b16 v[144:145], v4 offset:47104
    v_exp_f32 v56, v56
    v_exp_f32 v57, v57
    v_exp_f32 v58, v58
    v_exp_f32 v59, v59
    v_mfma_f32_32x32x16_bf16 v[80:95], v[136:139], v[112:115], v[80:95]
    v_exp_f32 v60, v60
    v_exp_f32 v61, v61
    v_exp_f32 v62, v62
    v_exp_f32 v63, v63
    v_cvt_pk_bf16_f32 v116, v56, v57
    v_cvt_pk_bf16_f32 v117, v58, v59
    v_cvt_pk_bf16_f32 v118, v60, v61
    v_cvt_pk_bf16_f32 v119, v62, v63
    s_waitcnt lgkmcnt(1)
    v_mfma_f32_32x32x16_bf16 v[48:63], v[128:131], a[96:99], v[32:47]
    ds_read_b64_tr_b16 v[146:147], v5 offset:47104
    v_exp_f32 v64, v64
    v_exp_f32 v65, v65
    v_exp_f32 v66, v66
    v_exp_f32 v67, v67
    v_mfma_f32_32x32x16_bf16 v[80:95], v[140:143], v[116:119], v[80:95]
    ds_read_b64_tr_b16 v[148:149], v4 offset:47360
    v_exp_f32 v68, v68
    v_exp_f32 v69, v69
    v_exp_f32 v70, v70
    v_exp_f32 v71, v71
    v_smfmac_f32_16x16x64_bf16 v[152:155], v[160:163], v[112:119], v16
    v_cvt_pk_bf16_f32 v112, v64, v65
    v_cvt_pk_bf16_f32 v113, v66, v67
    v_cvt_pk_bf16_f32 v114, v68, v69
    v_cvt_pk_bf16_f32 v115, v70, v71
    v_mfma_f32_32x32x16_bf16 v[48:63], v[132:135], a[100:103], v[48:63]
    ds_read_b64_tr_b16 v[150:151], v5 offset:47360
    v_exp_f32 v72, v72
    v_exp_f32 v73, v73
    v_exp_f32 v74, v74
    v_exp_f32 v75, v75
    v_mfma_f32_32x32x16_bf16 v[96:111], v[136:139], v[112:115], v[96:111]
    v_exp_f32 v76, v76
    v_exp_f32 v77, v77
    v_exp_f32 v78, v78
    v_exp_f32 v79, v79
    v_cvt_pk_bf16_f32 v116, v72, v73
    v_cvt_pk_bf16_f32 v117, v74, v75
    v_cvt_pk_bf16_f32 v118, v76, v77
    v_cvt_pk_bf16_f32 v119, v78, v79
    s_waitcnt lgkmcnt(0)
    v_mfma_f32_32x32x16_bf16 v[64:79], v[128:131], a[104:107], v[32:47]
    s_waitcnt vmcnt(6)
    s_barrier
    ds_read_b128 v[120:123], v23 offset:0
    v_exp_f32 v48, v48
    v_exp_f32 v49, v49
    s_add_u32 m0, s18, 131072
    v_exp_f32 v50, v50
    v_exp_f32 v51, v51
    v_mfma_f32_32x32x16_bf16 v[96:111], v[140:143], v[116:119], v[96:111]
    ds_read_b128 v[124:127], v23 offset:1024
    v_exp_f32 v52, v52
    v_exp_f32 v53, v53
    buffer_load_dwordx4 v2, s[20:23], s31 offen sc1 lds
    v_exp_f32 v54, v54
    v_exp_f32 v55, v55
    v_smfmac_f32_16x16x64_bf16 v[156:159], v[160:163], v[112:119], v16
    buffer_load_dwordx4 v2, s[20:23], s31 offen offset:1024 sc1 lds
    v_cvt_pk_bf16_f32 v112, v48, v49
    v_cvt_pk_bf16_f32 v113, v50, v51
    v_cvt_pk_bf16_f32 v114, v52, v53
    v_cvt_pk_bf16_f32 v115, v54, v55
    s_add_u32 m0, s18, 139264
    v_mfma_f32_32x32x16_bf16 v[64:79], v[132:135], a[108:111], v[64:79]
    ds_read_b64_tr_b16 v[136:137], v4 offset:8192
    v_exp_f32 v56, v56
    v_exp_f32 v57, v57
    buffer_load_dwordx4 v3, s[20:23], s31 offen sc1 lds
    v_exp_f32 v58, v58
    v_exp_f32 v59, v59
    v_mfma_f32_32x32x16_bf16 v[80:95], v[144:147], v[112:115], v[80:95]
    v_exp_f32 v60, v60
    v_exp_f32 v61, v61
    buffer_load_dwordx4 v6, s[20:23], s31 offen offset:1024 sc1 lds
    s_add_u32 s31, s31, 8192
    s_and_b32 s31, s31, 0x1ffff
    v_exp_f32 v62, v62
    v_exp_f32 v63, v63
    buffer_load_dwordx4 v[176:179], v7, s[40:43], s45 offen
    s_add_u32 s45, s45, 0x100000
    v_cvt_pk_bf16_f32 v116, v56, v57
    v_cvt_pk_bf16_f32 v117, v58, v59
    v_cvt_pk_bf16_f32 v118, v60, v61
    v_cvt_pk_bf16_f32 v119, v62, v63
    s_waitcnt lgkmcnt(1)
    v_mfma_f32_32x32x16_bf16 v[48:63], v[120:123], a[96:99], v[32:47]
    ds_read_b64_tr_b16 v[138:139], v5 offset:8192
    v_exp_f32 v64, v64
    v_exp_f32 v65, v65
    v_exp_f32 v66, v66
    v_exp_f32 v67, v67
    v_mfma_f32_32x32x16_bf16 v[80:95], v[148:151], v[116:119], v[80:95]
    ds_read_b64_tr_b16 v[140:141], v4 offset:8448
    v_exp_f32 v68, v68
    v_exp_f32 v69, v69
    v_exp_f32 v70, v70
    v_exp_f32 v71, v71
    v_smfmac_f32_16x16x64_bf16 v[152:155], v[160:163], v[112:119], v16
    v_cvt_pk_bf16_f32 v112, v64, v65
    v_cvt_pk_bf16_f32 v113, v66, v67
    v_cvt_pk_bf16_f32 v114, v68, v69
    v_cvt_pk_bf16_f32 v115, v70, v71
    v_mfma_f32_32x32x16_bf16 v[48:63], v[124:127], a[100:103], v[48:63]
    ds_read_b64_tr_b16 v[142:143], v5 offset:8448
    v_exp_f32 v72, v72
    v_exp_f32 v73, v73
    v_exp_f32 v74, v74
    v_exp_f32 v75, v75
    v_mfma_f32_32x32x16_bf16 v[96:111], v[144:147], v[112:115], v[96:111]
    v_exp_f32 v76, v76
    v_exp_f32 v77, v77
    v_exp_f32 v78, v78
    v_exp_f32 v79, v79
    v_cvt_pk_bf16_f32 v116, v72, v73
    v_cvt_pk_bf16_f32 v117, v74, v75
    v_cvt_pk_bf16_f32 v118, v76, v77
    v_cvt_pk_bf16_f32 v119, v78, v79
    v_mov_b32 v8, 1
    s_mov_b64 exec, 1
    buffer_store_dword v8, off, s[24:27], s30 sc1
    s_mov_b64 exec, -1
    s_sub_u32 s47, s47, 1
    s_cmp_lg_u32 s47, 0
    s_cbranch_scc1 L_at_loop0
    s_waitcnt lgkmcnt(0)
    v_mfma_f32_32x32x16_bf16 v[64:79], v[120:123], a[104:107], v[32:47]
    ds_read_b128 v[128:131], v23 offset:2048
    v_exp_f32 v48, v48
    v_exp_f32 v49, v49
    buffer_load_dword v209, v208, s[24:27], s81 offen sc1
    v_exp_f32 v50, v50
    v_exp_f32 v51, v51
    v_mfma_f32_32x32x16_bf16 v[96:111], v[148:151], v[116:119], v[96:111]
    ds_read_b128 v[132:135], v23 offset:3072
    v_exp_f32 v52, v52
    v_exp_f32 v53, v53
    v_exp_f32 v54, v54
    v_exp_f32 v55, v55
    v_smfmac_f32_16x16x64_bf16 v[156:159], v[160:163], v[112:119], v16
    v_cvt_pk_bf16_f32 v112, v48, v49
    v_cvt_pk_bf16_f32 v113, v50, v51
    v_cvt_pk_bf16_f32 v114, v52, v53
    v_cvt_pk_bf16_f32 v115, v54, v55
    v_mfma_f32_32x32x16_bf16 v[64:79], v[124:127], a[108:111], v[64:79]
    ds_read_b64_tr_b16 v[144:145], v4 offset:10240
    v_exp_f32 v56, v56
    v_exp_f32 v57, v57
    v_exp_f32 v58, v58
    v_exp_f32 v59, v59
    v_mfma_f32_32x32x16_bf16 v[80:95], v[136:139], v[112:115], v[80:95]
    v_exp_f32 v60, v60
    v_exp_f32 v61, v61
    v_exp_f32 v62, v62
    v_exp_f32 v63, v63
    v_cvt_pk_bf16_f32 v116, v56, v57
    v_cvt_pk_bf16_f32 v117, v58, v59
    v_cvt_pk_bf16_f32 v118, v60, v61
    v_cvt_pk_bf16_f32 v119, v62, v63
    s_waitcnt lgkmcnt(1)
    v_mfma_f32_32x32x16_bf16 v[48:63], v[128:131], a[96:99], v[32:47]
    ds_read_b64_tr_b16 v[146:147], v5 offset:10240
    v_exp_f32 v64, v64
    v_exp_f32 v65, v65
    v_exp_f32 v66, v66
    v_exp_f32 v67, v67
    v_mfma_f32_32x32x16_bf16 v[80:95], v[140:143], v[116:119], v[80:95]
    ds_read_b64_tr_b16 v[148:149], v4 offset:10496
    v_exp_f32 v68, v68
    v_exp_f32 v69, v69
    v_exp_f32 v70, v70
    v_exp_f32 v71, v71
    v_smfmac_f32_16x16x64_bf16 v[152:155], v[160:163], v[112:119], v16
    v_cvt_pk_bf16_f32 v112, v64, v65
    v_cvt_pk_bf16_f32 v113, v66, v67
    v_cvt_pk_bf16_f32 v114, v68, v69
    v_cvt_pk_bf16_f32 v115, v70, v71
    v_mfma_f32_32x32x16_bf16 v[48:63], v[132:135], a[100:103], v[48:63]
    ds_read_b64_tr_b16 v[150:151], v5 offset:10496
    v_exp_f32 v72, v72
    v_exp_f32 v73, v73
    v_exp_f32 v74, v74
    v_exp_f32 v75, v75
    v_mfma_f32_32x32x16_bf16 v[96:111], v[136:139], v[112:115], v[96:111]
    v_exp_f32 v76, v76
    v_exp_f32 v77, v77
    v_exp_f32 v78, v78
    v_exp_f32 v79, v79
    v_cvt_pk_bf16_f32 v116, v72, v73
    v_cvt_pk_bf16_f32 v117, v74, v75
    v_cvt_pk_bf16_f32 v118, v76, v77
    v_cvt_pk_bf16_f32 v119, v78, v79
    s_waitcnt lgkmcnt(0)
    v_mfma_f32_32x32x16_bf16 v[64:79], v[128:131], a[104:107], v[32:47]
    ds_read_b128 v[120:123], v23 offset:4096
    v_exp_f32 v48, v48
    v_exp_f32 v49, v49
    v_exp_f32 v50, v50
    v_exp_f32 v51, v51
    v_mfma_f32_32x32x16_bf16 v[96:111], v[140:143], v[116:119], v[96:111]
    ds_read_b128 v[124:127], v23 offset:5120
    v_exp_f32 v52, v52
    v_exp_f32 v53, v53
    v_exp_f32 v54, v54
    v_exp_f32 v55, v55
    v_smfmac_f32_16x16x64_bf16 v[156:159], v[160:163], v[112:119], v16
    v_cvt_pk_bf16_f32 v112, v48, v49
    v_cvt_pk_bf16_f32 v113, v50, v51
    v_cvt_pk_bf16_f32 v114, v52, v53
    v_cvt_pk_bf16_f32 v115, v54, v55
    v_mfma_f32_32x32x16_bf16 v[64:79], v[132:135], a[108:111], v[64:79]
    ds_read_b64_tr_b16 v[136:137], v4 offset:12288
    v_exp_f32 v56, v56
    v_exp_f32 v57, v57
    v_exp_f32 v58, v58
    v_exp_f32 v59, v59
    v_mfma_f32_32x32x16_bf16 v[80:95], v[144:147], v[112:115], v[80:95]
    v_exp_f32 v60, v60
    v_exp_f32 v61, v61
    v_exp_f32 v62, v62
    v_exp_f32 v63, v63
    v_cvt_pk_bf16_f32 v116, v56, v57
    v_cvt_pk_bf16_f32 v117, v58, v59
    v_cvt_pk_bf16_f32 v118, v60, v61
    v_cvt_pk_bf16_f32 v119, v62, v63
    s_waitcnt lgkmcnt(1)
    v_mfma_f32_32x32x16_bf16 v[48:63], v[120:123], a[96:99], v[32:47]
    ds_read_b64_tr_b16 v[138:139], v5 offset:12288
    v_exp_f32 v64, v64
    v_exp_f32 v65, v65
    v_exp_f32 v66, v66
    v_exp_f32 v67, v67
    v_mfma_f32_32x32x16_bf16 v[80:95], v[148:151], v[116:119], v[80:95]
    ds_read_b64_tr_b16 v[140:141], v4 offset:12544
    v_exp_f32 v68, v68
    v_exp_f32 v69, v69
    v_exp_f32 v70, v70
    v_exp_f32 v71, v71
    v_smfmac_f32_16x16x64_bf16 v[152:155], v[160:163], v[112:119], v16
    v_cvt_pk_bf16_f32 v112, v64, v65
    v_cvt_pk_bf16_f32 v113, v66, v67
    v_cvt_pk_bf16_f32 v114, v68, v69
    v_cvt_pk_bf16_f32 v115, v70, v71
    v_mfma_f32_32x32x16_bf16 v[48:63], v[124:127], a[100:103], v[48:63]
    ds_read_b64_tr_b16 v[142:143], v5 offset:12544
    v_exp_f32 v72, v72
    v_exp_f32 v73, v73
    v_exp_f32 v74, v74
    v_exp_f32 v75, v75
    v_mfma_f32_32x32x16_bf16 v[96:111], v[144:147], v[112:115], v[96:111]
    v_exp_f32 v76, v76
    v_exp_f32 v77, v77
    v_exp_f32 v78, v78
    v_exp_f32 v79, v79
    v_cvt_pk_bf16_f32 v116, v72, v73
    v_cvt_pk_bf16_f32 v117, v74, v75
    v_cvt_pk_bf16_f32 v118, v76, v77
    v_cvt_pk_bf16_f32 v119, v78, v79
    s_waitcnt lgkmcnt(0)
    v_mfma_f32_32x32x16_bf16 v[64:79], v[120:123], a[104:107], v[32:47]
    ds_read_b128 v[128:131], v23 offset:6144
    v_exp_f32 v48, v48
    v_exp_f32 v49, v49
    v_exp_f32 v50, v50
    v_exp_f32 v51, v51
    v_mfma_f32_32x32x16_bf16 v[96:111], v[148:151], v[116:119], v[96:111]
    ds_read_b128 v[132:135], v23 offset:7168
    v_exp_f32 v52, v52
    v_exp_f32 v53, v53
    v_exp_f32 v54, v54
    v_exp_f32 v55, v55
    v_smfmac_f32_16x16x64_bf16 v[156:159], v[160:163], v[112:119], v16
    v_cvt_pk_bf16_f32 v112, v48, v49
    v_cvt_pk_bf16_f32 v113, v50, v51
    v_cvt_pk_bf16_f32 v114, v52, v53
    v_cvt_pk_bf16_f32 v115, v54, v55
    v_mfma_f32_32x32x16_bf16 v[64:79], v[124:127], a[108:111], v[64:79]
    ds_read_b64_tr_b16 v[144:145], v4 offset:14336
    v_exp_f32 v56, v56
    v_exp_f32 v57, v57
    v_exp_f32 v58, v58
    v_exp_f32 v59, v59
    v_mfma_f32_32x32x16_bf16 v[80:95], v[136:139], v[112:115], v[80:95]
    v_exp_f32 v60, v60
    v_exp_f32 v61, v61
    v_exp_f32 v62, v62
    v_exp_f32 v63, v63
    v_cvt_pk_bf16_f32 v116, v56, v57
    v_cvt_pk_bf16_f32 v117, v58, v59
    v_cvt_pk_bf16_f32 v118, v60, v61
    v_cvt_pk_bf16_f32 v119, v62, v63
    s_waitcnt lgkmcnt(1)
    v_mfma_f32_32x32x16_bf16 v[48:63], v[128:131], a[96:99], v[32:47]
    ds_read_b64_tr_b16 v[146:147], v5 offset:14336
    v_exp_f32 v64, v64
    v_exp_f32 v65, v65
    v_exp_f32 v66, v66
    v_exp_f32 v67, v67
    v_mfma_f32_32x32x16_bf16 v[80:95], v[140:143], v[116:119], v[80:95]
    ds_read_b64_tr_b16 v[148:149], v4 offset:14592
    v_exp_f32 v68, v68
    v_exp_f32 v69, v69
    v_exp_f32 v70, v70
    v_exp_f32 v71, v71
    v_smfmac_f32_16x16x64_bf16 v[152:155], v[160:163], v[112:119], v16
    v_cvt_pk_bf16_f32 v112, v64, v65
    v_cvt_pk_bf16_f32 v113, v66, v67
    v_cvt_pk_bf16_f32 v114, v68, v69
    v_cvt_pk_bf16_f32 v115, v70, v71
    v_mfma_f32_32x32x16_bf16 v[48:63], v[132:135], a[100:103], v[48:63]
    ds_read_b64_tr_b16 v[150:151], v5 offset:14592
    v_exp_f32 v72, v72
    v_exp_f32 v73, v73
    v_exp_f32 v74, v74
    v_exp_f32 v75, v75
    v_mfma_f32_32x32x16_bf16 v[96:111], v[136:139], v[112:115], v[96:111]
    v_exp_f32 v76, v76
    v_exp_f32 v77, v77
    v_exp_f32 v78, v78
    v_exp_f32 v79, v79
    v_cvt_pk_bf16_f32 v116, v72, v73
    v_cvt_pk_bf16_f32 v117, v74, v75
    v_cvt_pk_bf16_f32 v118, v76, v77
    v_cvt_pk_bf16_f32 v119, v78, v79
    s_waitcnt lgkmcnt(0)
    v_mfma_f32_32x32x16_bf16 v[64:79], v[128:131], a[104:107], v[32:47]
    s_waitcnt vmcnt(7)
    s_barrier
    ds_read_b128 v[120:123], v23 offset:16384
    v_exp_f32 v48, v48
    v_exp_f32 v49, v49
    s_add_u32 m0, s18, 98304
    v_exp_f32 v50, v50
    v_exp_f32 v51, v51
    v_mfma_f32_32x32x16_bf16 v[96:111], v[140:143], v[116:119], v[96:111]
    ds_read_b128 v[124:127], v23 offset:17408
    v_exp_f32 v52, v52
    v_exp_f32 v53, v53
    buffer_load_dwordx4 v2, s[20:23], s31 offen sc1 lds
    v_exp_f32 v54, v54
    v_exp_f32 v55, v55
    v_smfmac_f32_16x16x64_bf16 v[156:159], v[160:163], v[112:119], v16
    buffer_load_dwordx4 v2, s[20:23], s31 offen offset:1024 sc1 lds
    v_cvt_pk_bf16_f32 v112, v48, v49
    v_cvt_pk_bf16_f32 v113, v50, v51
    v_cvt_pk_bf16_f32 v114, v52, v53
    v_cvt_pk_bf16_f32 v115, v54, v55
    s_add_u32 m0, s18, 106496
    v_mfma_f32_32x32x16_bf16 v[64:79], v[132:135], a[108:111], v[64:79]
    ds_read_b64_tr_b16 v[136:137], v4 offset:24576
    v_exp_f32 v56, v56
    v_exp_f32 v57, v57
    buffer_load_dwordx4 v3, s[20:23], s31 offen sc1 lds
    v_exp_f32 v58, v58
    v_exp_f32 v59, v59
    v_mfma_f32_32x32x16_bf16 v[80:95], v[144:147], v[112:115], v[80:95]
    v_exp_f32 v60, v60
    v_exp_f32 v61, v61
    buffer_load_dwordx4 v6, s[20:23], s31 offen offset:1024 sc1 lds
    s_add_u32 s31, s31, 8192
    s_and_b32 s31, s31, 0x1ffff
    v_exp_f32 v62, v62
    v_exp_f32 v63, v63
    buffer_load_dwordx4 v[176:179], v7, s[36:39], s44 offen
    s_add_u32 s44, s44, 0x100000
    v_cvt_pk_bf16_f32 v116, v56, v57
    v_cvt_pk_bf16_f32 v117, v58, v59
    v_cvt_pk_bf16_f32 v118, v60, v61
    v_cvt_pk_bf16_f32 v119, v62, v63
    s_waitcnt lgkmcnt(1)
    v_mfma_f32_32x32x16_bf16 v[48:63], v[120:123], a[96:99], v[32:47]
    ds_read_b64_tr_b16 v[138:139], v5 offset:24576
    v_exp_f32 v64, v64
    v_exp_f32 v65, v65
    v_exp_f32 v66, v66
    v_exp_f32 v67, v67
    v_mfma_f32_32x32x16_bf16 v[80:95], v[148:151], v[116:119], v[80:95]
    ds_read_b64_tr_b16 v[140:141], v4 offset:24832
    v_exp_f32 v68, v68
    v_exp_f32 v69, v69
    v_exp_f32 v70, v70
    v_exp_f32 v71, v71
    v_smfmac_f32_16x16x64_bf16 v[152:155], v[160:163], v[112:119], v16
    v_cvt_pk_bf16_f32 v112, v64, v65
    v_cvt_pk_bf16_f32 v113, v66, v67
    v_cvt_pk_bf16_f32 v114, v68, v69
    v_cvt_pk_bf16_f32 v115, v70, v71
    v_mfma_f32_32x32x16_bf16 v[48:63], v[124:127], a[100:103], v[48:63]
    ds_read_b64_tr_b16 v[142:143], v5 offset:24832
    v_exp_f32 v72, v72
    v_exp_f32 v73, v73
    v_exp_f32 v74, v74
    v_exp_f32 v75, v75
    v_mfma_f32_32x32x16_bf16 v[96:111], v[144:147], v[112:115], v[96:111]
    v_exp_f32 v76, v76
    v_exp_f32 v77, v77
    v_exp_f32 v78, v78
    v_exp_f32 v79, v79
    v_cvt_pk_bf16_f32 v116, v72, v73
    v_cvt_pk_bf16_f32 v117, v74, v75
    v_cvt_pk_bf16_f32 v118, v76, v77
    v_cvt_pk_bf16_f32 v119, v78, v79
    s_getpc_b64 s[36:37]
L_pc_at:
    s_add_u32 s36, s36, L_code_c - L_pc_at
    s_addc_u32 s37, s37, 0
    s_mov_b32 s38, L_code_b - L_code_c
    s_mov_b32 s39, 0x00020000
    s_lshr_b32 s19, s2, 3
    s_lshl_b32 s19, s19, 2
    s_add_u32 s19, s19, s14
    s_lshl_b32 s19, s19, 10
    buffer_load_dwordx4 v[176:179], v1, s[36:39], s19 offen
L_code_c:
    s_waitcnt vmcnt(6)
    s_mov_b32 s19, 0x80000
L_fw_h:
    v_cmp_ne_u32 vcc, 1, v209
    s_nop 1
    s_cmp_eq_u64 vcc, 0
    s_cbranch_scc1 L_fwd_h
    s_sleep 1
    buffer_load_dword v209, v208, s[24:27], s81 offen sc1
    s_waitcnt vmcnt(0)
    s_sub_u32 s19, s19, 1
    s_cmp_lg_u32 s19, 0
    s_cbranch_scc1 L_fw_h
L_fwd_h:
    s_waitcnt lgkmcnt(0)
    v_mfma_f32_32x32x16_bf16 v[64:79], v[120:123], a[104:107], v[32:47]
    ds_read_b128 v[128:131], v23 offset:18432
    v_exp_f32 v48, v48
    v_exp_f32 v49, v49
    s_add_u32 m0, s70, 0
    v_exp_f32 v50, v50
    v_exp_f32 v51, v51
    v_mfma_f32_32x32x16_bf16 v[96:111], v[148:151], v[116:119], v[96:111]
    ds_read_b128 v[132:135], v23 offset:19456
    v_exp_f32 v52, v52
    v_exp_f32 v53, v53
    buffer_load_dwordx4 v182, s[52:55], s69 offen offset:0 lds
    v_exp_f32 v54, v54
    v_exp_f32 v55, v55
    v_smfmac_f32_16x16x64_bf16 v[156:159], v[160:163], v[112:119], v16
    buffer_load_dwordx4 v183, s[52:55], s69 offen offset:1024 lds
    v_cvt_pk_bf16_f32 v112, v48, v49
    v_cvt_pk_bf16_f32 v113, v50, v51
    v_cvt_pk_bf16_f32 v114, v52, v53
    v_cvt_pk_bf16_f32 v115, v54, v55
    v_mfma_f32_32x32x16_bf16 v[64:79], v[124:127], a[108:111], v[64:79]
    ds_read_b64_tr_b16 v[144:145], v4 offset:26624
    v_exp_f32 v56, v56
    v_exp_f32 v57, v57
    v_exp_f32 v58, v58
    v_exp_f32 v59, v59
    v_mfma_f32_32x32x16_bf16 v[80:95], v[136:139], v[112:115], v[80:95]
    v_exp_f32 v60, v60
    v_exp_f32 v61, v61
    v_exp_f32 v62, v62
    v_exp_f32 v63, v63
    v_cvt_pk_bf16_f32 v116, v56, v57
    v_cvt_pk_bf16_f32 v117, v58, v59
    v_cvt_pk_bf16_f32 v118, v60, v61
    v_cvt_pk_bf16_f32 v119, v62, v63
    s_waitcnt lgkmcnt(1)
    v_mfma_f32_32x32x16_bf16 v[48:63], v[128:131], a[96:99], v[32:47]
    ds_read_b64_tr_b16 v[146:147], v5 offset:26624
    v_exp_f32 v64, v64
    v_exp_f32 v65, v65
    buffer_load_dwordx4 v184, s[52:55], s69 offen offset:2048 lds
    v_exp_f32 v66, v66
    v_exp_f32 v67, v67
    v_mfma_f32_32x32x16_bf16 v[80:95], v[140:143], v[116:119], v[80:95]
    ds_read_b64_tr_b16 v[148:149], v4 offset:26880
    v_exp_f32 v68, v68
    v_exp_f32 v69, v69
    buffer_load_dwordx4 v185, s[52:55], s69 offen offset:3072 lds
    s_add_u32 s69, s69, 131072
    v_exp_f32 v70, v70
    v_exp_f32 v71, v71
    v_smfmac_f32_16x16x64_bf16 v[152:155], v[160:163], v[112:119], v16
    v_cvt_pk_bf16_f32 v112, v64, v65
    v_cvt_pk_bf16_f32 v113, v66, v67
    v_cvt_pk_bf16_f32 v114, v68, v69
    v_cvt_pk_bf16_f32 v115, v70, v71
    v_mfma_f32_32x32x16_bf16 v[48:63], v[132:135], a[100:103], v[48:63]
    ds_read_b64_tr_b16 v[150:151], v5 offset:26880
    v_exp_f32 v72, v72
    v_exp_f32 v73, v73
    v_exp_f32 v74, v74
    v_exp_f32 v75, v75
    v_mfma_f32_32x32x16_bf16 v[96:111], v[136:139], v[112:115], v[96:111]
    v_exp_f32 v76, v76
    v_exp_f32 v77, v77
    v_exp_f32 v78, v78
    v_exp_f32 v79, v79
    v_cvt_pk_bf16_f32 v116, v72, v73
    v_cvt_pk_bf16_f32 v117, v74, v75
    v_cvt_pk_bf16_f32 v118, v76, v77
    v_cvt_pk_bf16_f32 v119, v78, v79
    s_waitcnt lgkmcnt(0)
    v_mfma_f32_32x32x16_bf16 v[64:79], v[128:131], a[104:107], v[32:47]
    ds_read_b128 v[120:123], v23 offset:20480
    v_exp_f32 v48, v48
    v_exp_f32 v49, v49
    buffer_load_dwordx4 a[128:131], v244, s[48:51], s68 offen offset:0 sc1
    v_exp_f32 v50, v50
    v_exp_f32 v51, v51
    v_mfma_f32_32x32x16_bf16 v[96:111], v[140:143], v[116:119], v[96:111]
    ds_read_b128 v[124:127], v23 offset:21504
    v_exp_f32 v52, v52
    v_exp_f32 v53, v53
    buffer_load_dwordx4 a[132:135], v245, s[48:51], s68 offen offset:0 sc1
    v_exp_f32 v54, v54
    v_exp_f32 v55, v55
    v_smfmac_f32_16x16x64_bf16 v[156:159], v[160:163], v[112:119], v16
    buffer_load_dwordx4 a[136:139], v246, s[48:51], s68 offen offset:0 sc1
    v_cvt_pk_bf16_f32 v112, v48, v49
    v_cvt_pk_bf16_f32 v113, v50, v51
    v_cvt_pk_bf16_f32 v114, v52, v53
    v_cvt_pk_bf16_f32 v115, v54, v55
    v_mfma_f32_32x32x16_bf16 v[64:79], v[132:135], a[108:111], v[64:79]
    ds_read_b64_tr_b16 v[136:137], v4 offset:28672
    v_exp_f32 v56, v56
    v_exp_f32 v57, v57
    v_exp_f32 v58, v58
    v_exp_f32 v59, v59
    v_mfma_f32_32x32x16_bf16 v[80:95], v[144:147], v[112:115], v[80:95]
    v_exp_f32 v60, v60
    v_exp_f32 v61, v61
    v_exp_f32 v62, v62
    v_exp_f32 v63, v63
    v_cvt_pk_bf16_f32 v116, v56, v57
    v_cvt_pk_bf16_f32 v117, v58, v59
    v_cvt_pk_bf16_f32 v118, v60, v61
    v_cvt_pk_bf16_f32 v119, v62, v63
    s_waitcnt lgkmcnt(1)
    v_mfma_f32_32x32x16_bf16 v[48:63], v[120:123], a[96:99], v[32:47]
    ds_read_b64_tr_b16 v[138:139], v5 offset:28672
    v_exp_f32 v64, v64
    v_exp_f32 v65, v65
    buffer_load_dwordx4 a[140:143], v247, s[48:51], s68 offen offset:0 sc1
    s_add_u32 s68, s68, 4096
    v_exp_f32 v66, v66
    v_exp_f32 v67, v67
    v_mfma_f32_32x32x16_bf16 v[80:95], v[148:151], v[116:119], v[80:95]
    ds_read_b64_tr_b16 v[140:141], v4 offset:28928
    v_exp_f32 v68, v68
    v_exp_f32 v69, v69
    s_add_u32 m0, s70, 16384
    v_exp_f32 v70, v70
    v_exp_f32 v71, v71
    v_smfmac_f32_16x16x64_bf16 v[152:155], v[160:163], v[112:119], v16
    v_cvt_pk_bf16_f32 v112, v64, v65
    v_cvt_pk_bf16_f32 v113, v66, v67
    v_cvt_pk_bf16_f32 v114, v68, v69
    v_cvt_pk_bf16_f32 v115, v70, v71
    v_mfma_f32_32x32x16_bf16 v[48:63], v[124:127], a[100:103], v[48:63]
    ds_read_b64_tr_b16 v[142:143], v5 offset:28928
    v_exp_f32 v72, v72
    v_exp_f32 v73, v73
    v_exp_f32 v74, v74
    v_exp_f32 v75, v75
    v_mfma_f32_32x32x16_bf16 v[96:111], v[144:147], v[112:115], v[96:111]
    v_exp_f32 v76, v76
    v_exp_f32 v77, v77
    v_exp_f32 v78, v78
    v_exp_f32 v79, v79
    v_cvt_pk_bf16_f32 v116, v72, v73
    v_cvt_pk_bf16_f32 v117, v74, v75
    v_cvt_pk_bf16_f32 v118, v76, v77
    v_cvt_pk_bf16_f32 v119, v78, v79
    s_waitcnt lgkmcnt(0)
    v_mfma_f32_32x32x16_bf16 v[64:79], v[120:123], a[104:107], v[32:47]
    ds_read_b128 v[128:131], v23 offset:22528
    v_exp_f32 v48, v48
    v_exp_f32 v49, v49
    buffer_load_dwordx4 v182, s[52:55], s69 offen offset:0 lds
    v_exp_f32 v50, v50
    v_exp_f32 v51, v51
    v_mfma_f32_32x32x16_bf16 v[96:111], v[148:151], v[116:119], v[96:111]
    ds_read_b128 v[132:135], v23 offset:23552
    v_exp_f32 v52, v52
    v_exp_f32 v53, v53
    buffer_load_dwordx4 v183, s[52:55], s69 offen offset:1024 lds
    v_exp_f32 v54, v54
    v_exp_f32 v55, v55
    v_smfmac_f32_16x16x64_bf16 v[156:159], v[160:163], v[112:119], v16
    buffer_load_dwordx4 v184, s[52:55], s69 offen offset:2048 lds
    v_cvt_pk_bf16_f32 v112, v48, v49
    v_cvt_pk_bf16_f32 v113, v50, v51
    v_cvt_pk_bf16_f32 v114, v52, v53
    v_cvt_pk_bf16_f32 v115, v54, v55
    v_mfma_f32_32x32x16_bf16 v[64:79], v[124:127], a[108:111], v[64:79]
    ds_read_b64_tr_b16 v[144:145], v4 offset:30720
    v_exp_f32 v56, v56
    v_exp_f32 v57, v57
    v_exp_f32 v58, v58
    v_exp_f32 v59, v59
    v_mfma_f32_32x32x16_bf16 v[80:95], v[136:139], v[112:115], v[80:95]
    v_exp_f32 v60, v60
    v_exp_f32 v61, v61
    v_exp_f32 v62, v62
    v_exp_f32 v63, v63
    v_cvt_pk_bf16_f32 v116, v56, v57
    v_cvt_pk_bf16_f32 v117, v58, v59
    v_cvt_pk_bf16_f32 v118, v60, v61
    v_cvt_pk_bf16_f32 v119, v62, v63
    s_waitcnt lgkmcnt(1)
    v_mfma_f32_32x32x16_bf16 v[48:63], v[128:131], a[96:99], v[32:47]
    ds_read_b64_tr_b16 v[146:147], v5 offset:30720
    v_exp_f32 v64, v64
    v_exp_f32 v65, v65
    buffer_load_dwordx4 v185, s[52:55], s69 offen offset:3072 lds
    s_add_u32 s69, s69, 131072
    v_exp_f32 v66, v66
    v_exp_f32 v67, v67
    v_mfma_f32_32x32x16_bf16 v[80:95], v[140:143], v[116:119], v[80:95]
    ds_read_b64_tr_b16 v[148:149], v4 offset:30976
    v_exp_f32 v68, v68
    v_exp_f32 v69, v69
    buffer_load_dwordx4 a[144:147], v244, s[48:51], s68 offen offset:0 sc1
    v_exp_f32 v70, v70
    v_exp_f32 v71, v71
    v_smfmac_f32_16x16x64_bf16 v[152:155], v[160:163], v[112:119], v16
    v_cvt_pk_bf16_f32 v112, v64, v65
    v_cvt_pk_bf16_f32 v113, v66, v67
    v_cvt_pk_bf16_f32 v114, v68, v69
    v_cvt_pk_bf16_f32 v115, v70, v71
    v_mfma_f32_32x32x16_bf16 v[48:63], v[132:135], a[100:103], v[48:63]
    ds_read_b64_tr_b16 v[150:151], v5 offset:30976
    v_exp_f32 v72, v72
    v_exp_f32 v73, v73
    v_exp_f32 v74, v74
    v_exp_f32 v75, v75
    v_mfma_f32_32x32x16_bf16 v[96:111], v[136:139], v[112:115], v[96:111]
    v_exp_f32 v76, v76
    v_exp_f32 v77, v77
    v_exp_f32 v78, v78
    v_exp_f32 v79, v79
    v_cvt_pk_bf16_f32 v116, v72, v73
    v_cvt_pk_bf16_f32 v117, v74, v75
    v_cvt_pk_bf16_f32 v118, v76, v77
    v_cvt_pk_bf16_f32 v119, v78, v79
    s_waitcnt lgkmcnt(0)
    v_mfma_f32_32x32x16_bf16 v[64:79], v[128:131], a[104:107], v[32:47]
    s_waitcnt vmcnt(21)
    s_barrier
    ds_read_b128 v[120:123], v23 offset:32768
    v_exp_f32 v48, v48
    v_exp_f32 v49, v49
    buffer_load_dwordx4 a[148:151], v245, s[48:51], s68 offen offset:0 sc1
    v_exp_f32 v50, v50
    v_exp_f32 v51, v51
    v_mfma_f32_32x32x16_bf16 v[96:111], v[140:143], v[116:119], v[96:111]
    ds_read_b128 v[124:127], v23 offset:33792
    v_exp_f32 v52, v52
    v_exp_f32 v53, v53
    buffer_load_dwordx4 a[152:155], v246, s[48:51], s68 offen offset:0 sc1
    v_exp_f32 v54, v54
    v_exp_f32 v55, v55
    v_smfmac_f32_16x16x64_bf16 v[156:159], v[160:163], v[112:119], v16
    buffer_load_dwordx4 a[156:159], v247, s[48:51], s68 offen offset:0 sc1
    s_add_u32 s68, s68, 4096
    v_cvt_pk_bf16_f32 v112, v48, v49
    v_cvt_pk_bf16_f32 v113, v50, v51
    v_cvt_pk_bf16_f32 v114, v52, v53
    v_cvt_pk_bf16_f32 v115, v54, v55
    v_mfma_f32_32x32x16_bf16 v[64:79], v[132:135], a[108:111], v[64:79]
    ds_read_b64_tr_b16 v[136:137], v4 offset:40960
    v_exp_f32 v56, v56
    v_exp_f32 v57, v57
    v_exp_f32 v58, v58
    v_exp_f32 v59, v59
    v_mfma_f32_32x32x16_bf16 v[80:95], v[144:147], v[112:115], v[80:95]
    v_exp_f32 v60, v60
    v_exp_f32 v61, v61
    v_exp_f32 v62, v62
    v_exp_f32 v63, v63
    v_cvt_pk_bf16_f32 v116, v56, v57
    v_cvt_pk_bf16_f32 v117, v58, v59
    v_cvt_pk_bf16_f32 v118, v60, v61
    v_cvt_pk_bf16_f32 v119, v62, v63
    s_waitcnt lgkmcnt(1)
    v_mfma_f32_32x32x16_bf16 v[48:63], v[120:123], a[96:99], v[32:47]
    ds_read_b64_tr_b16 v[138:139], v5 offset:40960
    v_exp_f32 v64, v64
    v_exp_f32 v65, v65
    s_add_u32 m0, s70, 32768
    v_exp_f32 v66, v66
    v_exp_f32 v67, v67
    v_mfma_f32_32x32x16_bf16 v[80:95], v[148:151], v[116:119], v[80:95]
    ds_read_b64_tr_b16 v[140:141], v4 offset:41216
    v_exp_f32 v68, v68
    v_exp_f32 v69, v69
    buffer_load_dwordx4 v182, s[52:55], s69 offen offset:0 lds
    v_exp_f32 v70, v70
    v_exp_f32 v71, v71
    v_smfmac_f32_16x16x64_bf16 v[152:155], v[160:163], v[112:119], v16
    v_cvt_pk_bf16_f32 v112, v64, v65
    v_cvt_pk_bf16_f32 v113, v66, v67
    v_cvt_pk_bf16_f32 v114, v68, v69
    v_cvt_pk_bf16_f32 v115, v70, v71
    v_mfma_f32_32x32x16_bf16 v[48:63], v[124:127], a[100:103], v[48:63]
    ds_read_b64_tr_b16 v[142:143], v5 offset:41216
    v_exp_f32 v72, v72
    v_exp_f32 v73, v73
    v_exp_f32 v74, v74
    v_exp_f32 v75, v75
    v_mfma_f32_32x32x16_bf16 v[96:111], v[144:147], v[112:115], v[96:111]
    v_exp_f32 v76, v76
    v_exp_f32 v77, v77
    v_exp_f32 v78, v78
    v_exp_f32 v79, v79
    v_cvt_pk_bf16_f32 v116, v72, v73
    v_cvt_pk_bf16_f32 v117, v74, v75
    v_cvt_pk_bf16_f32 v118, v76, v77
    v_cvt_pk_bf16_f32 v119, v78, v79
    s_waitcnt lgkmcnt(0)
    v_mfma_f32_32x32x16_bf16 v[64:79], v[120:123], a[104:107], v[32:47]
    ds_read_b128 v[128:131], v23 offset:34816
    v_exp_f32 v48, v48
    v_exp_f32 v49, v49
    buffer_load_dwordx4 v183, s[52:55], s69 offen offset:1024 lds
    v_exp_f32 v50, v50
    v_exp_f32 v51, v51
    v_mfma_f32_32x32x16_bf16 v[96:111], v[148:151], v[116:119], v[96:111]
    ds_read_b128 v[132:135], v23 offset:35840
    v_exp_f32 v52, v52
    v_exp_f32 v53, v53
    buffer_load_dwordx4 v184, s[52:55], s69 offen offset:2048 lds
    v_exp_f32 v54, v54
    v_exp_f32 v55, v55
    v_smfmac_f32_16x16x64_bf16 v[156:159], v[160:163], v[112:119], v16
    buffer_load_dwordx4 v185, s[52:55], s69 offen offset:3072 lds
    s_add_u32 s69, s69, 131072
    v_cvt_pk_bf16_f32 v112, v48, v49
    v_cvt_pk_bf16_f32 v113, v50, v51
    v_cvt_pk_bf16_f32 v114, v52, v53
    v_cvt_pk_bf16_f32 v115, v54, v55
    v_mfma_f32_32x32x16_bf16 v[64:79], v[124:127], a[108:111], v[64:79]
    ds_read_b64_tr_b16 v[144:145], v4 offset:43008
    v_exp_f32 v56, v56
    v_exp_f32 v57, v57
    v_exp_f32 v58, v58
    v_exp_f32 v59, v59
    v_mfma_f32_32x32x16_bf16 v[80:95], v[136:139], v[112:115], v[80:95]
    v_exp_f32 v60, v60
    v_exp_f32 v61, v61
    v_exp_f32 v62, v62
    v_exp_f32 v63, v63
    v_cvt_pk_bf16_f32 v116, v56, v57
    v_cvt_pk_bf16_f32 v117, v58, v59
    v_cvt_pk_bf16_f32 v118, v60, v61
    v_cvt_pk_bf16_f32 v119, v62, v63
    s_waitcnt lgkmcnt(1)
    v_mfma_f32_32x32x16_bf16 v[48:63], v[128:131], a[96:99], v[32:47]
    ds_read_b64_tr_b16 v[146:147], v5 offset:43008
    v_exp_f32 v64, v64
    v_exp_f32 v65, v65
    buffer_load_dwordx4 a[160:163], v244, s[48:51], s68 offen offset:0 sc1
    v_exp_f32 v66, v66
    v_exp_f32 v67, v67
    v_mfma_f32_32x32x16_bf16 v[80:95], v[140:143], v[116:119], v[80:95]
    ds_read_b64_tr_b16 v[148:149], v4 offset:43264
    v_exp_f32 v68, v68
    v_exp_f32 v69, v69
    buffer_load_dwordx4 a[164:167], v245, s[48:51], s68 offen offset:0 sc1
    v_exp_f32 v70, v70
    v_exp_f32 v71, v71
    v_smfmac_f32_16x16x64_bf16 v[152:155], v[160:163], v[112:119], v16
    v_cvt_pk_bf16_f32 v112, v64, v65
    v_cvt_pk_bf16_f32 v113, v66, v67
    v_cvt_pk_bf16_f32 v114, v68, v69
    v_cvt_pk_bf16_f32 v115, v70, v71
    v_mfma_f32_32x32x16_bf16 v[48:63], v[132:135], a[100:103], v[48:63]
    ds_read_b64_tr_b16 v[150:151], v5 offset:43264
    v_exp_f32 v72, v72
    v_exp_f32 v73, v73
    v_exp_f32 v74, v74
    v_exp_f32 v75, v75
    v_mfma_f32_32x32x16_bf16 v[96:111], v[136:139], v[112:115], v[96:111]
    v_exp_f32 v76, v76
    v_exp_f32 v77, v77
    v_exp_f32 v78, v78
    v_exp_f32 v79, v79
    v_cvt_pk_bf16_f32 v116, v72, v73
    v_cvt_pk_bf16_f32 v117, v74, v75
    v_cvt_pk_bf16_f32 v118, v76, v77
    v_cvt_pk_bf16_f32 v119, v78, v79
    s_waitcnt lgkmcnt(0)
    v_mfma_f32_32x32x16_bf16 v[64:79], v[128:131], a[104:107], v[32:47]
    ds_read_b128 v[120:123], v23 offset:36864
    v_exp_f32 v48, v48
    v_exp_f32 v49, v49
    buffer_load_dwordx4 a[168:171], v246, s[48:51], s68 offen offset:0 sc1
    v_exp_f32 v50, v50
    v_exp_f32 v51, v51
    v_mfma_f32_32x32x16_bf16 v[96:111], v[140:143], v[116:119], v[96:111]
    ds_read_b128 v[124:127], v23 offset:37888
    v_exp_f32 v52, v52
    v_exp_f32 v53, v53
    buffer_load_dwordx4 a[172:175], v247, s[48:51], s68 offen offset:0 sc1
    s_add_u32 s68, s68, 4096
    v_exp_f32 v54, v54
    v_exp_f32 v55, v55
    v_smfmac_f32_16x16x64_bf16 v[156:159], v[160:163], v[112:119], v16
    s_add_u32 m0, s70, 49152
    v_cvt_pk_bf16_f32 v112, v48, v49
    v_cvt_pk_bf16_f32 v113, v50, v51
    v_cvt_pk_bf16_f32 v114, v52, v53
    v_cvt_pk_bf16_f32 v115, v54, v55
    v_mfma_f32_32x32x16_bf16 v[64:79], v[132:135], a[108:111], v[64:79]
    ds_read_b64_tr_b16 v[136:137], v4 offset:45056
    v_exp_f32 v56, v56
    v_exp_f32 v57, v57
    v_exp_f32 v58, v58
    v_exp_f32 v59, v59
    v_mfma_f32_32x32x16_bf16 v[80:95], v[144:147], v[112:115], v[80:95]
    v_exp_f32 v60, v60
    v_exp_f32 v61, v61
    v_exp_f32 v62, v62
    v_exp_f32 v63, v63
    v_cvt_pk_bf16_f32 v116, v56, v57
    v_cvt_pk_bf16_f32 v117, v58, v59
    v_cvt_pk_bf16_f32 v118, v60, v61
    v_cvt_pk_bf16_f32 v119, v62, v63
    s_waitcnt lgkmcnt(1)
    v_mfma_f32_32x32x16_bf16 v[48:63], v[120:123], a[96:99], v[32:47]
    ds_read_b64_tr_b16 v[138:139], v5 offset:45056
    v_exp_f32 v64, v64
    v_exp_f32 v65, v65
    buffer_load_dwordx4 v182, s[52:55], s69 offen offset:0 lds
    v_exp_f32 v66, v66
    v_exp_f32 v67, v67
    v_mfma_f32_32x32x16_bf16 v[80:95], v[148:151], v[116:119], v[80:95]
    ds_read_b64_tr_b16 v[140:141], v4 offset:45312
    v_exp_f32 v68, v68
    v_exp_f32 v69, v69
    buffer_load_dwordx4 v183, s[52:55], s69 offen offset:1024 lds
    v_exp_f32 v70, v70
    v_exp_f32 v71, v71
    v_smfmac_f32_16x16x64_bf16 v[152:155], v[160:163], v[112:119], v16
    v_cvt_pk_bf16_f32 v112, v64, v65
    v_cvt_pk_bf16_f32 v113, v66, v67
    v_cvt_pk_bf16_f32 v114, v68, v69
    v_cvt_pk_bf16_f32 v115, v70, v71
    v_mfma_f32_32x32x16_bf16 v[48:63], v[124:127], a[100:103], v[48:63]
    ds_read_b64_tr_b16 v[142:143], v5 offset:45312
    v_exp_f32 v72, v72
    v_exp_f32 v73, v73
    v_exp_f32 v74, v74
    v_exp_f32 v75, v75
    v_mfma_f32_32x32x16_bf16 v[96:111], v[144:147], v[112:115], v[96:111]
    v_exp_f32 v76, v76
    v_exp_f32 v77, v77
    v_exp_f32 v78, v78
    v_exp_f32 v79, v79
    v_cvt_pk_bf16_f32 v116, v72, v73
    v_cvt_pk_bf16_f32 v117, v74, v75
    v_cvt_pk_bf16_f32 v118, v76, v77
    v_cvt_pk_bf16_f32 v119, v78, v79
    s_waitcnt lgkmcnt(0)
    v_mfma_f32_32x32x16_bf16 v[64:79], v[120:123], a[104:107], v[32:47]
    ds_read_b128 v[128:131], v23 offset:38912
    v_exp_f32 v48, v48
    v_exp_f32 v49, v49
    buffer_load_dwordx4 v184, s[52:55], s69 offen offset:2048 lds
    v_exp_f32 v50, v50
    v_exp_f32 v51, v51
    v_mfma_f32_32x32x16_bf16 v[96:111], v[148:151], v[116:119], v[96:111]
    ds_read_b128 v[132:135], v23 offset:39936
    v_exp_f32 v52, v52
    v_exp_f32 v53, v53
    buffer_load_dwordx4 v185, s[52:55], s69 offen offset:3072 lds
    s_add_u32 s69, s69, 131072
    v_exp_f32 v54, v54
    v_exp_f32 v55, v55
    v_smfmac_f32_16x16x64_bf16 v[156:159], v[160:163], v[112:119], v16
    buffer_load_dwordx4 a[176:179], v244, s[48:51], s68 offen offset:0 sc1
    v_cvt_pk_bf16_f32 v112, v48, v49
    v_cvt_pk_bf16_f32 v113, v50, v51
    v_cvt_pk_bf16_f32 v114, v52, v53
    v_cvt_pk_bf16_f32 v115, v54, v55
    v_mfma_f32_32x32x16_bf16 v[64:79], v[124:127], a[108:111], v[64:79]
    ds_read_b64_tr_b16 v[144:145], v4 offset:47104
    v_exp_f32 v56, v56
    v_exp_f32 v57, v57
    v_exp_f32 v58, v58
    v_exp_f32 v59, v59
    v_mfma_f32_32x32x16_bf16 v[80:95], v[136:139], v[112:115], v[80:95]
    v_exp_f32 v60, v60
    v_exp_f32 v61, v61
    v_exp_f32 v62, v62
    v_exp_f32 v63, v63
    v_cvt_pk_bf16_f32 v116, v56, v57
    v_cvt_pk_bf16_f32 v117, v58, v59
    v_cvt_pk_bf16_f32 v118, v60, v61
    v_cvt_pk_bf16_f32 v119, v62, v63
    s_waitcnt lgkmcnt(1)
    v_mfma_f32_32x32x16_bf16 v[48:63], v[128:131], a[96:99], v[32:47]
    ds_read_b64_tr_b16 v[146:147], v5 offset:47104
    v_exp_f32 v64, v64
    v_exp_f32 v65, v65
    buffer_load_dwordx4 a[180:183], v245, s[48:51], s68 offen offset:0 sc1
    v_exp_f32 v66, v66
    v_exp_f32 v67, v67
    v_mfma_f32_32x32x16_bf16 v[80:95], v[140:143], v[116:119], v[80:95]
    ds_read_b64_tr_b16 v[148:149], v4 offset:47360
    v_exp_f32 v68, v68
    v_exp_f32 v69, v69
    buffer_load_dwordx4 a[184:187], v246, s[48:51], s68 offen offset:0 sc1
    v_exp_f32 v70, v70
    v_exp_f32 v71, v71
    v_smfmac_f32_16x16x64_bf16 v[152:155], v[160:163], v[112:119], v16
    v_cvt_pk_bf16_f32 v112, v64, v65
    v_cvt_pk_bf16_f32 v113, v66, v67
    v_cvt_pk_bf16_f32 v114, v68, v69
    v_cvt_pk_bf16_f32 v115, v70, v71
    v_mfma_f32_32x32x16_bf16 v[48:63], v[132:135], a[100:103], v[48:63]
    ds_read_b64_tr_b16 v[150:151], v5 offset:47360
    v_exp_f32 v72, v72
    v_exp_f32 v73, v73
    v_exp_f32 v74, v74
    v_exp_f32 v75, v75
    v_mfma_f32_32x32x16_bf16 v[96:111], v[136:139], v[112:115], v[96:111]
    v_exp_f32 v76, v76
    v_exp_f32 v77, v77
    v_exp_f32 v78, v78
    v_exp_f32 v79, v79
    v_cvt_pk_bf16_f32 v116, v72, v73
    v_cvt_pk_bf16_f32 v117, v74, v75
    v_cvt_pk_bf16_f32 v118, v76, v77
    v_cvt_pk_bf16_f32 v119, v78, v79
    s_waitcnt lgkmcnt(0)
    v_mfma_f32_32x32x16_bf16 v[64:79], v[128:131], a[104:107], v[32:47]
    s_waitcnt vmcnt(33)
    s_barrier
    ds_read_b128 v[120:123], v23 offset:0
    v_exp_f32 v48, v48
    v_exp_f32 v49, v49
    buffer_load_dwordx4 a[188:191], v247, s[48:51], s68 offen offset:0 sc1
    s_add_u32 s68, s68, 4096
    v_exp_f32 v50, v50
    v_exp_f32 v51, v51
    v_mfma_f32_32x32x16_bf16 v[96:111], v[140:143], v[116:119], v[96:111]
    ds_read_b128 v[124:127], v23 offset:1024
    v_exp_f32 v52, v52
    v_exp_f32 v53, v53
    s_add_u32 m0, s70, 65536
    v_exp_f32 v54, v54
    v_exp_f32 v55, v55
    v_smfmac_f32_16x16x64_bf16 v[156:159], v[160:163], v[112:119], v16
    buffer_load_dwordx4 v182, s[52:55], s69 offen offset:0 lds
    v_cvt_pk_bf16_f32 v112, v48, v49
    v_cvt_pk_bf16_f32 v113, v50, v51
    v_cvt_pk_bf16_f32 v114, v52, v53
    v_cvt_pk_bf16_f32 v115, v54, v55
    v_mfma_f32_32x32x16_bf16 v[64:79], v[132:135], a[108:111], v[64:79]
    ds_read_b64_tr_b16 v[136:137], v4 offset:8192
    v_exp_f32 v56, v56
    v_exp_f32 v57, v57
    v_exp_f32 v58, v58
    v_exp_f32 v59, v59
    v_mfma_f32_32x32x16_bf16 v[80:95], v[144:147], v[112:115], v[80:95]
    v_exp_f32 v60, v60
    v_exp_f32 v61, v61
    v_exp_f32 v62, v62
    v_exp_f32 v63, v63
    v_cvt_pk_bf16_f32 v116, v56, v57
    v_cvt_pk_bf16_f32 v117, v58, v59
    v_cvt_pk_bf16_f32 v118, v60, v61
    v_cvt_pk_bf16_f32 v119, v62, v63
    s_waitcnt lgkmcnt(1)
    v_mfma_f32_32x32x16_bf16 v[48:63], v[120:123], a[96:99], v[32:47]
    ds_read_b64_tr_b16 v[138:139], v5 offset:8192
    v_exp_f32 v64, v64
    v_exp_f32 v65, v65
    buffer_load_dwordx4 v183, s[52:55], s69 offen offset:1024 lds
    v_exp_f32 v66, v66
    v_exp_f32 v67, v67
    v_mfma_f32_32x32x16_bf16 v[80:95], v[148:151], v[116:119], v[80:95]
    ds_read_b64_tr_b16 v[140:141], v4 offset:8448
    v_exp_f32 v68, v68
    v_exp_f32 v69, v69
    buffer_load_dwordx4 v184, s[52:55], s69 offen offset:2048 lds
    v_exp_f32 v70, v70
    v_exp_f32 v71, v71
    v_smfmac_f32_16x16x64_bf16 v[152:155], v[160:163], v[112:119], v16
    v_cvt_pk_bf16_f32 v112, v64, v65
    v_cvt_pk_bf16_f32 v113, v66, v67
    v_cvt_pk_bf16_f32 v114, v68, v69
    v_cvt_pk_bf16_f32 v115, v70, v71
    v_mfma_f32_32x32x16_bf16 v[48:63], v[124:127], a[100:103], v[48:63]
    ds_read_b64_tr_b16 v[142:143], v5 offset:8448
    v_exp_f32 v72, v72
    v_exp_f32 v73, v73
    v_exp_f32 v74, v74
    v_exp_f32 v75, v75
    v_mfma_f32_32x32x16_bf16 v[96:111], v[144:147], v[112:115], v[96:111]
    v_exp_f32 v76, v76
    v_exp_f32 v77, v77
    v_exp_f32 v78, v78
    v_exp_f32 v79, v79
    v_cvt_pk_bf16_f32 v116, v72, v73
    v_cvt_pk_bf16_f32 v117, v74, v75
    v_cvt_pk_bf16_f32 v118, v76, v77
    v_cvt_pk_bf16_f32 v119, v78, v79
    s_waitcnt lgkmcnt(0)
    v_mfma_f32_32x32x16_bf16 v[64:79], v[120:123], a[104:107], v[32:47]
    ds_read_b128 v[128:131], v23 offset:2048
    v_exp_f32 v48, v48
    v_exp_f32 v49, v49
    buffer_load_dwordx4 v185, s[52:55], s69 offen offset:3072 lds
    s_add_u32 s69, s69, 131072
    v_exp_f32 v50, v50
    v_exp_f32 v51, v51
    v_mfma_f32_32x32x16_bf16 v[96:111], v[148:151], v[116:119], v[96:111]
    ds_read_b128 v[132:135], v23 offset:3072
    v_exp_f32 v52, v52
    v_exp_f32 v53, v53
    buffer_load_dwordx4 a[192:195], v244, s[48:51], s68 offen offset:0 sc1
    v_exp_f32 v54, v54
    v_exp_f32 v55, v55
    v_smfmac_f32_16x16x64_bf16 v[156:159], v[160:163], v[112:119], v16
    buffer_load_dwordx4 a[196:199], v245, s[48:51], s68 offen offset:0 sc1
    v_cvt_pk_bf16_f32 v112, v48, v49
    v_cvt_pk_bf16_f32 v113, v50, v51
    v_cvt_pk_bf16_f32 v114, v52, v53
    v_cvt_pk_bf16_f32 v115, v54, v55
    v_mfma_f32_32x32x16_bf16 v[64:79], v[124:127], a[108:111], v[64:79]
    ds_read_b64_tr_b16 v[144:145], v4 offset:10240
    v_exp_f32 v56, v56
    v_exp_f32 v57, v57
    v_exp_f32 v58, v58
    v_exp_f32 v59, v59
    v_mfma_f32_32x32x16_bf16 v[80:95], v[136:139], v[112:115], v[80:95]
    v_exp_f32 v60, v60
    v_exp_f32 v61, v61
    v_exp_f32 v62, v62
    v_exp_f32 v63, v63
    v_cvt_pk_bf16_f32 v116, v56, v57
    v_cvt_pk_bf16_f32 v117, v58, v59
    v_cvt_pk_bf16_f32 v118, v60, v61
    v_cvt_pk_bf16_f32 v119, v62, v63
    s_waitcnt lgkmcnt(1)
    v_mfma_f32_32x32x16_bf16 v[48:63], v[128:131], a[96:99], v[32:47]
    ds_read_b64_tr_b16 v[146:147], v5 offset:10240
    v_exp_f32 v64, v64
    v_exp_f32 v65, v65
    buffer_load_dwordx4 a[200:203], v246, s[48:51], s68 offen offset:0 sc1
    v_exp_f32 v66, v66
    v_exp_f32 v67, v67
    v_mfma_f32_32x32x16_bf16 v[80:95], v[140:143], v[116:119], v[80:95]
    ds_read_b64_tr_b16 v[148:149], v4 offset:10496
    v_exp_f32 v68, v68
    v_exp_f32 v69, v69
    buffer_load_dwordx4 a[204:207], v247, s[48:51], s68 offen offset:0 sc1
    s_add_u32 s68, s68, 4096
    v_exp_f32 v70, v70
    v_exp_f32 v71, v71
    v_smfmac_f32_16x16x64_bf16 v[152:155], v[160:163], v[112:119], v16
    v_cvt_pk_bf16_f32 v112, v64, v65
    v_cvt_pk_bf16_f32 v113, v66, v67
    v_cvt_pk_bf16_f32 v114, v68, v69
    v_cvt_pk_bf16_f32 v115, v70, v71
    v_mfma_f32_32x32x16_bf16 v[48:63], v[132:135], a[100:103], v[48:63]
    ds_read_b64_tr_b16 v[150:151], v5 offset:10496
    v_exp_f32 v72, v72
    v_exp_f32 v73, v73
    v_exp_f32 v74, v74
    v_exp_f32 v75, v75
    v_mfma_f32_32x32x16_bf16 v[96:111], v[136:139], v[112:115], v[96:111]
    v_exp_f32 v76, v76
    v_exp_f32 v77, v77
    v_exp_f32 v78, v78
    v_exp_f32 v79, v79
    v_cvt_pk_bf16_f32 v116, v72, v73
    v_cvt_pk_bf16_f32 v117, v74, v75
    v_cvt_pk_bf16_f32 v118, v76, v77
    v_cvt_pk_bf16_f32 v119, v78, v79
    s_waitcnt lgkmcnt(0)
    v_mfma_f32_32x32x16_bf16 v[64:79], v[128:131], a[104:107], v[32:47]
    ds_read_b128 v[120:123], v23 offset:4096
    v_exp_f32 v48, v48
    v_exp_f32 v49, v49
    s_add_u32 m0, s70, 81920
    v_exp_f32 v50, v50
    v_exp_f32 v51, v51
    v_mfma_f32_32x32x16_bf16 v[96:111], v[140:143], v[116:119], v[96:111]
    ds_read_b128 v[124:127], v23 offset:5120
    v_exp_f32 v52, v52
    v_exp_f32 v53, v53
    buffer_load_dwordx4 v182, s[52:55], s69 offen offset:0 lds
    v_exp_f32 v54, v54
    v_exp_f32 v55, v55
    v_smfmac_f32_16x16x64_bf16 v[156:159], v[160:163], v[112:119], v16
    buffer_load_dwordx4 v183, s[52:55], s69 offen offset:1024 lds
    v_cvt_pk_bf16_f32 v112, v48, v49
    v_cvt_pk_bf16_f32 v113, v50, v51
    v_cvt_pk_bf16_f32 v114, v52, v53
    v_cvt_pk_bf16_f32 v115, v54, v55
    v_mfma_f32_32x32x16_bf16 v[64:79], v[132:135], a[108:111], v[64:79]
    ds_read_b64_tr_b16 v[136:137], v4 offset:12288
    v_exp_f32 v56, v56
    v_exp_f32 v57, v57
    v_exp_f32 v58, v58
    v_exp_f32 v59, v59
    v_mfma_f32_32x32x16_bf16 v[80:95], v[144:147], v[112:115], v[80:95]
    v_exp_f32 v60, v60
    v_exp_f32 v61, v61
    v_exp_f32 v62, v62
    v_exp_f32 v63, v63
    v_cvt_pk_bf16_f32 v116, v56, v57
    v_cvt_pk_bf16_f32 v117, v58, v59
    v_cvt_pk_bf16_f32 v118, v60, v61
    v_cvt_pk_bf16_f32 v119, v62, v63
    s_waitcnt lgkmcnt(1)
    v_mfma_f32_32x32x16_bf16 v[48:63], v[120:123], a[96:99], v[32:47]
    ds_read_b64_tr_b16 v[138:139], v5 offset:12288
    v_exp_f32 v64, v64
    v_exp_f32 v65, v65
    buffer_load_dwordx4 v184, s[52:55], s69 offen offset:2048 lds
    v_exp_f32 v66, v66
    v_exp_f32 v67, v67
    v_mfma_f32_32x32x16_bf16 v[80:95], v[148:151], v[116:119], v[80:95]
    ds_read_b64_tr_b16 v[140:141], v4 offset:12544
    v_exp_f32 v68, v68
    v_exp_f32 v69, v69
    buffer_load_dwordx4 v185, s[52:55], s69 offen offset:3072 lds
    s_add_u32 s69, s69, 131072
    v_exp_f32 v70, v70
    v_exp_f32 v71, v71
    v_smfmac_f32_16x16x64_bf16 v[152:155], v[160:163], v[112:119], v16
    v_cvt_pk_bf16_f32 v112, v64, v65
    v_cvt_pk_bf16_f32 v113, v66, v67
    v_cvt_pk_bf16_f32 v114, v68, v69
    v_cvt_pk_bf16_f32 v115, v70, v71
    v_mfma_f32_32x32x16_bf16 v[48:63], v[124:127], a[100:103], v[48:63]
    ds_read_b64_tr_b16 v[142:143], v5 offset:12544
    v_exp_f32 v72, v72
    v_exp_f32 v73, v73
    v_exp_f32 v74, v74
    v_exp_f32 v75, v75
    v_mfma_f32_32x32x16_bf16 v[96:111], v[144:147], v[112:115], v[96:111]
    v_exp_f32 v76, v76
    v_exp_f32 v77, v77
    v_exp_f32 v78, v78
    v_exp_f32 v79, v79
    v_cvt_pk_bf16_f32 v116, v72, v73
    v_cvt_pk_bf16_f32 v117, v74, v75
    v_cvt_pk_bf16_f32 v118, v76, v77
    v_cvt_pk_bf16_f32 v119, v78, v79
    s_waitcnt lgkmcnt(0)
    v_mfma_f32_32x32x16_bf16 v[64:79], v[120:123], a[104:107], v[32:47]
    ds_read_b128 v[128:131], v23 offset:6144
    v_exp_f32 v48, v48
    v_exp_f32 v49, v49
    buffer_load_dwordx4 a[208:211], v244, s[48:51], s68 offen offset:0 sc1
    v_exp_f32 v50, v50
    v_exp_f32 v51, v51
    v_mfma_f32_32x32x16_bf16 v[96:111], v[148:151], v[116:119], v[96:111]
    ds_read_b128 v[132:135], v23 offset:7168
    v_exp_f32 v52, v52
    v_exp_f32 v53, v53
    buffer_load_dwordx4 a[212:215], v245, s[48:51], s68 offen offset:0 sc1
    v_exp_f32 v54, v54
    v_exp_f32 v55, v55
    v_smfmac_f32_16x16x64_bf16 v[156:159], v[160:163], v[112:119], v16
    buffer_load_dwordx4 a[216:219], v246, s[48:51], s68 offen offset:0 sc1
    v_cvt_pk_bf16_f32 v112, v48, v49
    v_cvt_pk_bf16_f32 v113, v50, v51
    v_cvt_pk_bf16_f32 v114, v52, v53
    v_cvt_pk_bf16_f32 v115, v54, v55
    v_mfma_f32_32x32x16_bf16 v[64:79], v[124:127], a[108:111], v[64:79]
    ds_read_b64_tr_b16 v[144:145], v4 offset:14336
    v_exp_f32 v56, v56
    v_exp_f32 v57, v57
    v_exp_f32 v58, v58
    v_exp_f32 v59, v59
    v_mfma_f32_32x32x16_bf16 v[80:95], v[136:139], v[112:115], v[80:95]
    v_exp_f32 v60, v60
    v_exp_f32 v61, v61
    v_exp_f32 v62, v62
    v_exp_f32 v63, v63
    v_cvt_pk_bf16_f32 v116, v56, v57
    v_cvt_pk_bf16_f32 v117, v58, v59
    v_cvt_pk_bf16_f32 v118, v60, v61
    v_cvt_pk_bf16_f32 v119, v62, v63
    s_waitcnt lgkmcnt(1)
    v_mfma_f32_32x32x16_bf16 v[48:63], v[128:131], a[96:99], v[32:47]
    ds_read_b64_tr_b16 v[146:147], v5 offset:14336
    v_exp_f32 v64, v64
    v_exp_f32 v65, v65
    buffer_load_dwordx4 a[220:223], v247, s[48:51], s68 offen offset:0 sc1
    s_add_u32 s68, s68, 4096
    v_exp_f32 v66, v66
    v_exp_f32 v67, v67
    v_mfma_f32_32x32x16_bf16 v[80:95], v[140:143], v[116:119], v[80:95]
    ds_read_b64_tr_b16 v[148:149], v4 offset:14592
    v_exp_f32 v68, v68
    v_exp_f32 v69, v69
    v_exp_f32 v70, v70
    v_exp_f32 v71, v71
    v_smfmac_f32_16x16x64_bf16 v[152:155], v[160:163], v[112:119], v16
    v_cvt_pk_bf16_f32 v112, v64, v65
    v_cvt_pk_bf16_f32 v113, v66, v67
    v_cvt_pk_bf16_f32 v114, v68, v69
    v_cvt_pk_bf16_f32 v115, v70, v71
    v_mfma_f32_32x32x16_bf16 v[48:63], v[132:135], a[100:103], v[48:63]
    ds_read_b64_tr_b16 v[150:151], v5 offset:14592
    v_exp_f32 v72, v72
    v_exp_f32 v73, v73
    v_exp_f32 v74, v74
    v_exp_f32 v75, v75
    v_mfma_f32_32x32x16_bf16 v[96:111], v[136:139], v[112:115], v[96:111]
    v_exp_f32 v76, v76
    v_exp_f32 v77, v77
    v_exp_f32 v78, v78
    v_exp_f32 v79, v79
    v_cvt_pk_bf16_f32 v116, v72, v73
    v_cvt_pk_bf16_f32 v117, v74, v75
    v_cvt_pk_bf16_f32 v118, v76, v77
    v_cvt_pk_bf16_f32 v119, v78, v79
    s_waitcnt lgkmcnt(0)
    v_mfma_f32_32x32x16_bf16 v[64:79], v[128:131], a[104:107], v[32:47]
    ds_read_b128 v[120:123], v23 offset:16384
    v_exp_f32 v48, v48
    v_exp_f32 v49, v49
    v_exp_f32 v50, v50
    v_exp_f32 v51, v51
    v_mfma_f32_32x32x16_bf16 v[96:111], v[140:143], v[116:119], v[96:111]
    ds_read_b128 v[124:127], v23 offset:17408
    v_exp_f32 v52, v52
    v_exp_f32 v53, v53
    v_exp_f32 v54, v54
    v_exp_f32 v55, v55
    v_smfmac_f32_16x16x64_bf16 v[156:159], v[160:163], v[112:119], v16
    v_cvt_pk_bf16_f32 v112, v48, v49
    v_cvt_pk_bf16_f32 v113, v50, v51
    v_cvt_pk_bf16_f32 v114, v52, v53
    v_cvt_pk_bf16_f32 v115, v54, v55
    v_mfma_f32_32x32x16_bf16 v[64:79], v[132:135], a[108:111], v[64:79]
    ds_read_b64_tr_b16 v[136:137], v4 offset:24576
    v_exp_f32 v56, v56
    v_exp_f32 v57, v57
    v_exp_f32 v58, v58
    v_exp_f32 v59, v59
    v_mfma_f32_32x32x16_bf16 v[80:95], v[144:147], v[112:115], v[80:95]
    v_exp_f32 v60, v60
    v_exp_f32 v61, v61
    v_exp_f32 v62, v62
    v_exp_f32 v63, v63
    v_cvt_pk_bf16_f32 v116, v56, v57
    v_cvt_pk_bf16_f32 v117, v58, v59
    v_cvt_pk_bf16_f32 v118, v60, v61
    v_cvt_pk_bf16_f32 v119, v62, v63
    s_waitcnt lgkmcnt(1)
    v_mfma_f32_32x32x16_bf16 v[48:63], v[120:123], a[96:99], v[32:47]
    ds_read_b64_tr_b16 v[138:139], v5 offset:24576
    v_exp_f32 v64, v64
    v_exp_f32 v65, v65
    v_exp_f32 v66, v66
    v_exp_f32 v67, v67
    v_mfma_f32_32x32x16_bf16 v[80:95], v[148:151], v[116:119], v[80:95]
    ds_read_b64_tr_b16 v[140:141], v4 offset:24832
    v_exp_f32 v68, v68
    v_exp_f32 v69, v69
    v_exp_f32 v70, v70
    v_exp_f32 v71, v71
    v_smfmac_f32_16x16x64_bf16 v[152:155], v[160:163], v[112:119], v16
    v_cvt_pk_bf16_f32 v112, v64, v65
    v_cvt_pk_bf16_f32 v113, v66, v67
    v_cvt_pk_bf16_f32 v114, v68, v69
    v_cvt_pk_bf16_f32 v115, v70, v71
    v_mfma_f32_32x32x16_bf16 v[48:63], v[124:127], a[100:103], v[48:63]
    ds_read_b64_tr_b16 v[142:143], v5 offset:24832
    v_exp_f32 v72, v72
    v_exp_f32 v73, v73
    v_exp_f32 v74, v74
    v_exp_f32 v75, v75
    v_mfma_f32_32x32x16_bf16 v[96:111], v[144:147], v[112:115], v[96:111]
    v_exp_f32 v76, v76
    v_exp_f32 v77, v77
    v_exp_f32 v78, v78
    v_exp_f32 v79, v79
    v_cvt_pk_bf16_f32 v116, v72, v73
    v_cvt_pk_bf16_f32 v117, v74, v75
    v_cvt_pk_bf16_f32 v118, v76, v77
    v_cvt_pk_bf16_f32 v119, v78, v79
    s_waitcnt lgkmcnt(0)
    s_nop 1
    v_mfma_f32_32x32x16_bf16 v[96:111], v[148:151], v[116:119], v[96:111]
    v_smfmac_f32_16x16x64_bf16 v[156:159], v[160:163], v[112:119], v16
    s_nop 15
    s_mul_i32 s19, s13, 294912
    s_lshl_b32 s33, s12, 11
    s_add_u32 s33, s33, s19
    v_mov_b32 v164, 0
    v_fma_f32 v164, v80, 0, v164
    v_fma_f32 v164, v81, 0, v164
    v_fma_f32 v164, v82, 0, v164
    v_fma_f32 v164, v83, 0, v164
    v_fma_f32 v164, v84, 0, v164
    v_fma_f32 v164, v85, 0, v164
    v_fma_f32 v164, v86, 0, v164
    v_fma_f32 v164, v87, 0, v164
    v_fma_f32 v164, v88, 0, v164
    v_fma_f32 v164, v89, 0, v164
    v_fma_f32 v164, v90, 0, v164
    v_fma_f32 v164, v91, 0, v164
    v_fma_f32 v164, v92, 0, v164
    v_fma_f32 v164, v93, 0, v164
    v_fma_f32 v164, v94, 0, v164
    v_fma_f32 v164, v95, 0, v164
    v_add_f32 v164, v164, v152
    v_add_f32 v164, v164, v153
    v_mov_b32 v165, 0x5f800000
    v_mov_b32 v166, 0x1f800000
    v_cmp_nlt_f32 vcc, v164, v165
    v_cmp_ngt_f32 s[34:35], v164, v166
    s_nop 1
    s_or_b64 vcc, vcc, s[34:35]
    s_cbranch_scc1 L_at_slow0
L_at_fin0:
    v_add_f32 v164, v152, v153
    v_rcp_f32 v164, v164
    s_nop 0
    v_mul_f32 v80, v80, v164
    v_mul_f32 v81, v81, v164
    v_mul_f32 v82, v82, v164
    v_mul_f32 v83, v83, v164
    v_mul_f32 v84, v84, v164
    v_mul_f32 v85, v85, v164
    v_mul_f32 v86, v86, v164
    v_mul_f32 v87, v87, v164
    v_mul_f32 v88, v88, v164
    v_mul_f32 v89, v89, v164
    v_mul_f32 v90, v90, v164
    v_mul_f32 v91, v91, v164
    v_mul_f32 v92, v92, v164
    v_mul_f32 v93, v93, v164
    v_mul_f32 v94, v94, v164
    v_mul_f32 v95, v95, v164
    v_cvt_pk_bf16_f32 v80, v80, v81
    v_cvt_pk_bf16_f32 v81, v82, v83
    v_cvt_pk_bf16_f32 v82, v84, v85
    v_cvt_pk_bf16_f32 v83, v86, v87
    v_cvt_pk_bf16_f32 v84, v88, v89
    v_cvt_pk_bf16_f32 v85, v90, v91
    v_cvt_pk_bf16_f32 v86, v92, v93
    v_cvt_pk_bf16_f32 v87, v94, v95
    buffer_store_dwordx4 v[80:83], v1, s[48:51], s33 offen sc1
    buffer_store_dwordx4 v[84:87], v1, s[48:51], s33 offen offset:1024 sc1
    s_add_u32 s33, s33, 294912
    v_mov_b32 v164, 0
    v_fma_f32 v164, v96, 0, v164
    v_fma_f32 v164, v97, 0, v164
    v_fma_f32 v164, v98, 0, v164
    v_fma_f32 v164, v99, 0, v164
    v_fma_f32 v164, v100, 0, v164
    v_fma_f32 v164, v101, 0, v164
    v_fma_f32 v164, v102, 0, v164
    v_fma_f32 v164, v103, 0, v164
    v_fma_f32 v164, v104, 0, v164
    v_fma_f32 v164, v105, 0, v164
    v_fma_f32 v164, v106, 0, v164
    v_fma_f32 v164, v107, 0, v164
    v_fma_f32 v164, v108, 0, v164
    v_fma_f32 v164, v109, 0, v164
    v_fma_f32 v164, v110, 0, v164
    v_fma_f32 v164, v111, 0, v164
    v_add_f32 v164, v164, v156
    v_add_f32 v164, v164, v157
    v_mov_b32 v165, 0x5f800000
    v_mov_b32 v166, 0x1f800000
    v_cmp_nlt_f32 vcc, v164, v165
    v_cmp_ngt_f32 s[34:35], v164, v166
    s_nop 1
    s_or_b64 vcc, vcc, s[34:35]
    s_cbranch_scc1 L_at_slow1
L_at_fin1:
    v_add_f32 v164, v156, v157
    v_rcp_f32 v164, v164
    s_nop 0
    v_mul_f32 v96, v96, v164
    v_mul_f32 v97, v97, v164
    v_mul_f32 v98, v98, v164
    v_mul_f32 v99, v99, v164
    v_mul_f32 v100, v100, v164
    v_mul_f32 v101, v101, v164
    v_mul_f32 v102, v102, v164
    v_mul_f32 v103, v103, v164
    v_mul_f32 v104, v104, v164
    v_mul_f32 v105, v105, v164
    v_mul_f32 v106, v106, v164
    v_mul_f32 v107, v107, v164
    v_mul_f32 v108, v108, v164
    v_mul_f32 v109, v109, v164
    v_mul_f32 v110, v110, v164
    v_mul_f32 v111, v111, v164
    v_cvt_pk_bf16_f32 v96, v96, v97
    v_cvt_pk_bf16_f32 v97, v98, v99
    v_cvt_pk_bf16_f32 v98, v100, v101
    v_cvt_pk_bf16_f32 v99, v102, v103
    v_cvt_pk_bf16_f32 v100, v104, v105
    v_cvt_pk_bf16_f32 v101, v106, v107
    v_cvt_pk_bf16_f32 v102, v108, v109
    v_cvt_pk_bf16_f32 v103, v110, v111
    buffer_store_dwordx4 v[96:99], v1, s[48:51], s33 offen sc1
    buffer_store_dwordx4 v[100:103], v1, s[48:51], s33 offen offset:1024 sc1
    s_mov_b32 s30, s91
    s_branch L_g2_begin
L_at_slow0:
    s_waitcnt vmcnt(0) lgkmcnt(0)
    s_lshl_b32 s32, s14, 12
    s_add_u32 s32, s32, 49152
    v_subrev_u32 v8, s18, v2
    v_subrev_u32 v9, s18, v3
    v_subrev_u32 v10, s18, v6
    v_add_u32 v11, s32, v23
    v_mov_b32 v12, v4
    v_mov_b32 v13, v5
    v_add_u32 v4, s32, v4
    v_add_u32 v5, s32, v5
    s_add_u32 s32, s32, 98304
    v_mov_b32 v32, 0xff800000
    s_mov_b32 s31, 0
    v_mov_b32 v80, 0
    v_mov_b32 v81, 0
    v_mov_b32 v82, 0
    v_mov_b32 v83, 0
    v_mov_b32 v84, 0
    v_mov_b32 v85, 0
    v_mov_b32 v86, 0
    v_mov_b32 v87, 0
    v_mov_b32 v88, 0
    v_mov_b32 v89, 0
    v_mov_b32 v90, 0
    v_mov_b32 v91, 0
    v_mov_b32 v92, 0
    v_mov_b32 v93, 0
    v_mov_b32 v94, 0
    v_mov_b32 v95, 0
    v_mov_b32 v152, 0
    v_mov_b32 v153, 0
    v_mov_b32 v154, 0
    v_mov_b32 v155, 0
L_at_sloop0:
    s_mov_b32 m0, s32
    s_nop 0
    buffer_load_dwordx4 v8, s[20:23], s31 offen sc1 lds
    buffer_load_dwordx4 v8, s[20:23], s31 offen offset:1024 sc1 lds
    s_add_u32 m0, s32, 2048
    s_nop 0
    buffer_load_dwordx4 v9, s[20:23], s31 offen sc1 lds
    buffer_load_dwordx4 v10, s[20:23], s31 offen offset:1024 sc1 lds
    s_waitcnt vmcnt(0)
    ds_read_b128 v[120:123], v11 offset:0
    ds_read_b128 v[124:127], v11 offset:1024
    ds_read_b64_tr_b16 v[136:137], v4 offset:2048
    ds_read_b64_tr_b16 v[138:139], v5 offset:2048
    ds_read_b64_tr_b16 v[140:141], v4 offset:2304
    ds_read_b64_tr_b16 v[142:143], v5 offset:2304
    s_waitcnt lgkmcnt(0)
    v_mfma_f32_32x32x16_bf16 v[48:63], v[120:123], a[96:99], 0
    v_mfma_f32_32x32x16_bf16 v[48:63], v[124:127], a[100:103], v[48:63]
    s_nop 15
    v_max3_f32 v164, v48, v49, v50
    v_max3_f32 v164, v164, v51, v52
    v_max3_f32 v164, v164, v53, v54
    v_max3_f32 v164, v164, v55, v56
    v_max3_f32 v164, v164, v57, v58
    v_max3_f32 v164, v164, v59, v60
    v_max3_f32 v164, v164, v61, v62
    v_max_f32 v164, v164, v63
    v_mov_b32 v165, v164
    s_nop 1
    v_permlane32_swap_b32 v164, v165
    s_nop 1
    v_max_f32 v164, v164, v165
    v_max_f32 v164, v164, v32
    v_mov_b32 v165, 0xff800000
    v_cmp_eq_f32 vcc, v164, v165
    s_nop 1
    v_cndmask_b32 v166, v164, 0, vcc
    v_sub_f32 v167, v32, v166
    v_exp_f32 v167, v167
    v_mov_b32 v32, v164
    v_sub_f32 v48, v48, v166
    v_sub_f32 v49, v49, v166
    v_sub_f32 v50, v50, v166
    v_sub_f32 v51, v51, v166
    v_sub_f32 v52, v52, v166
    v_sub_f32 v53, v53, v166
    v_sub_f32 v54, v54, v166
    v_sub_f32 v55, v55, v166
    v_sub_f32 v56, v56, v166
    v_sub_f32 v57, v57, v166
    v_sub_f32 v58, v58, v166
    v_sub_f32 v59, v59, v166
    v_sub_f32 v60, v60, v166
    v_sub_f32 v61, v61, v166
    v_sub_f32 v62, v62, v166
    v_sub_f32 v63, v63, v166
    v_exp_f32 v48, v48
    v_exp_f32 v49, v49
    v_exp_f32 v50, v50
    v_exp_f32 v51, v51
    v_exp_f32 v52, v52
    v_exp_f32 v53, v53
    v_exp_f32 v54, v54
    v_exp_f32 v55, v55
    v_exp_f32 v56, v56
    v_exp_f32 v57, v57
    v_exp_f32 v58, v58
    v_exp_f32 v59, v59
    v_exp_f32 v60, v60
    v_exp_f32 v61, v61
    v_exp_f32 v62, v62
    v_exp_f32 v63, v63
    v_mul_f32 v80, v80, v167
    v_mul_f32 v81, v81, v167
    v_mul_f32 v82, v82, v167
    v_mul_f32 v83, v83, v167
    v_mul_f32 v84, v84, v167
    v_mul_f32 v85, v85, v167
    v_mul_f32 v86, v86, v167
    v_mul_f32 v87, v87, v167
    v_mul_f32 v88, v88, v167
    v_mul_f32 v89, v89, v167
    v_mul_f32 v90, v90, v167
    v_mul_f32 v91, v91, v167
    v_mul_f32 v92, v92, v167
    v_mul_f32 v93, v93, v167
    v_mul_f32 v94, v94, v167
    v_mul_f32 v95, v95, v167
    v_mul_f32 v152, v152, v167
    v_mul_f32 v153, v153, v167
    v_mul_f32 v154, v154, v167
    v_mul_f32 v155, v155, v167
    v_cvt_pk_bf16_f32 v112, v48, v49
    v_cvt_pk_bf16_f32 v113, v50, v51
    v_cvt_pk_bf16_f32 v114, v52, v53
    v_cvt_pk_bf16_f32 v115, v54, v55
    v_cvt_pk_bf16_f32 v116, v56, v57
    v_cvt_pk_bf16_f32 v117, v58, v59
    v_cvt_pk_bf16_f32 v118, v60, v61
    v_cvt_pk_bf16_f32 v119, v62, v63
    s_nop 1
    v_mfma_f32_32x32x16_bf16 v[80:95], v[136:139], v[112:115], v[80:95]
    v_mfma_f32_32x32x16_bf16 v[80:95], v[140:143], v[116:119], v[80:95]
    v_smfmac_f32_16x16x64_bf16 v[152:155], v[160:163], v[112:119], v16
    s_nop 15
    s_add_u32 s31, s31, 2048
    s_cmp_lt_u32 s31, 0x20000
    s_cbranch_scc1 L_at_sloop0
    v_mov_b32 v4, v12
    v_mov_b32 v5, v13
    s_branch L_at_fin0
L_at_slow1:
    s_waitcnt vmcnt(0) lgkmcnt(0)
    s_lshl_b32 s32, s14, 12
    s_add_u32 s32, s32, 49152
    v_subrev_u32 v8, s18, v2
    v_subrev_u32 v9, s18, v3
    v_subrev_u32 v10, s18, v6
    v_add_u32 v11, s32, v23
    v_mov_b32 v12, v4
    v_mov_b32 v13, v5
    v_add_u32 v4, s32, v4
    v_add_u32 v5, s32, v5
    s_add_u32 s32, s32, 98304
    v_mov_b32 v32, 0xff800000
    s_mov_b32 s31, 0
    v_mov_b32 v96, 0
    v_mov_b32 v97, 0
    v_mov_b32 v98, 0
    v_mov_b32 v99, 0
    v_mov_b32 v100, 0
    v_mov_b32 v101, 0
    v_mov_b32 v102, 0
    v_mov_b32 v103, 0
    v_mov_b32 v104, 0
    v_mov_b32 v105, 0
    v_mov_b32 v106, 0
    v_mov_b32 v107, 0
    v_mov_b32 v108, 0
    v_mov_b32 v109, 0
    v_mov_b32 v110, 0
    v_mov_b32 v111, 0
    v_mov_b32 v156, 0
    v_mov_b32 v157, 0
    v_mov_b32 v158, 0
    v_mov_b32 v159, 0
L_at_sloop1:
    s_mov_b32 m0, s32
    s_nop 0
    buffer_load_dwordx4 v8, s[20:23], s31 offen sc1 lds
    buffer_load_dwordx4 v8, s[20:23], s31 offen offset:1024 sc1 lds
    s_add_u32 m0, s32, 2048
    s_nop 0
    buffer_load_dwordx4 v9, s[20:23], s31 offen sc1 lds
    buffer_load_dwordx4 v10, s[20:23], s31 offen offset:1024 sc1 lds
    s_waitcnt vmcnt(0)
    ds_read_b128 v[120:123], v11 offset:0
    ds_read_b128 v[124:127], v11 offset:1024
    ds_read_b64_tr_b16 v[136:137], v4 offset:2048
    ds_read_b64_tr_b16 v[138:139], v5 offset:2048
    ds_read_b64_tr_b16 v[140:141], v4 offset:2304
    ds_read_b64_tr_b16 v[142:143], v5 offset:2304
    s_waitcnt lgkmcnt(0)
    v_mfma_f32_32x32x16_bf16 v[48:63], v[120:123], a[104:107], 0
    v_mfma_f32_32x32x16_bf16 v[48:63], v[124:127], a[108:111], v[48:63]
    s_nop 15
    v_max3_f32 v164, v48, v49, v50
    v_max3_f32 v164, v164, v51, v52
    v_max3_f32 v164, v164, v53, v54
    v_max3_f32 v164, v164, v55, v56
    v_max3_f32 v164, v164, v57, v58
    v_max3_f32 v164, v164, v59, v60
    v_max3_f32 v164, v164, v61, v62
    v_max_f32 v164, v164, v63
    v_mov_b32 v165, v164
    s_nop 1
    v_permlane32_swap_b32 v164, v165
    s_nop 1
    v_max_f32 v164, v164, v165
    v_max_f32 v164, v164, v32
    v_mov_b32 v165, 0xff800000
    v_cmp_eq_f32 vcc, v164, v165
    s_nop 1
    v_cndmask_b32 v166, v164, 0, vcc
    v_sub_f32 v167, v32, v166
    v_exp_f32 v167, v167
    v_mov_b32 v32, v164
    v_sub_f32 v48, v48, v166
    v_sub_f32 v49, v49, v166
    v_sub_f32 v50, v50, v166
    v_sub_f32 v51, v51, v166
    v_sub_f32 v52, v52, v166
    v_sub_f32 v53, v53, v166
    v_sub_f32 v54, v54, v166
    v_sub_f32 v55, v55, v166
    v_sub_f32 v56, v56, v166
    v_sub_f32 v57, v57, v166
    v_sub_f32 v58, v58, v166
    v_sub_f32 v59, v59, v166
    v_sub_f32 v60, v60, v166
    v_sub_f32 v61, v61, v166
    v_sub_f32 v62, v62, v166
    v_sub_f32 v63, v63, v166
    v_exp_f32 v48, v48
    v_exp_f32 v49, v49
    v_exp_f32 v50, v50
    v_exp_f32 v51, v51
    v_exp_f32 v52, v52
    v_exp_f32 v53, v53
    v_exp_f32 v54, v54
    v_exp_f32 v55, v55
    v_exp_f32 v56, v56
    v_exp_f32 v57, v57
    v_exp_f32 v58, v58
    v_exp_f32 v59, v59
    v_exp_f32 v60, v60
    v_exp_f32 v61, v61
    v_exp_f32 v62, v62
    v_exp_f32 v63, v63
    v_mul_f32 v96, v96, v167
    v_mul_f32 v97, v97, v167
    v_mul_f32 v98, v98, v167
    v_mul_f32 v99, v99, v167
    v_mul_f32 v100, v100, v167
    v_mul_f32 v101, v101, v167
    v_mul_f32 v102, v102, v167
    v_mul_f32 v103, v103, v167
    v_mul_f32 v104, v104, v167
    v_mul_f32 v105, v105, v167
    v_mul_f32 v106, v106, v167
    v_mul_f32 v107, v107, v167
    v_mul_f32 v108, v108, v167
    v_mul_f32 v109, v109, v167
    v_mul_f32 v110, v110, v167
    v_mul_f32 v111, v111, v167
    v_mul_f32 v156, v156, v167
    v_mul_f32 v157, v157, v167
    v_mul_f32 v158, v158, v167
    v_mul_f32 v159, v159, v167
    v_cvt_pk_bf16_f32 v112, v48, v49
    v_cvt_pk_bf16_f32 v113, v50, v51
    v_cvt_pk_bf16_f32 v114, v52, v53
    v_cvt_pk_bf16_f32 v115, v54, v55
    v_cvt_pk_bf16_f32 v116, v56, v57
    v_cvt_pk_bf16_f32 v117, v58, v59
    v_cvt_pk_bf16_f32 v118, v60, v61
    v_cvt_pk_bf16_f32 v119, v62, v63
    s_nop 1
    v_mfma_f32_32x32x16_bf16 v[96:111], v[136:139], v[112:115], v[96:111]
    v_mfma_f32_32x32x16_bf16 v[96:111], v[140:143], v[116:119], v[96:111]
    v_smfmac_f32_16x16x64_bf16 v[156:159], v[160:163], v[112:119], v16
    s_nop 15
    s_add_u32 s31, s31, 2048
    s_cmp_lt_u32 s31, 0x20000
    s_cbranch_scc1 L_at_sloop1
    v_mov_b32 v4, v12
    v_mov_b32 v5, v13
    s_branch L_at_fin1
L_g2_begin:
    s_waitcnt vmcnt(48)
    s_barrier
    ds_read_b64_tr_b16 v[16:17], v190 offset:0
    ds_read_b64_tr_b16 v[18:19], v190 offset:4096
    ds_read_b64_tr_b16 v[20:21], v191 offset:0
    ds_read_b64_tr_b16 v[22:23], v191 offset:4096
    ds_read_b64_tr_b16 v[24:25], v192 offset:0
    ds_read_b64_tr_b16 v[26:27], v192 offset:4096
    ds_read_b64_tr_b16 v[28:29], v193 offset:0
    ds_read_b64_tr_b16 v[30:31], v193 offset:4096
    ds_read_b64_tr_b16 v[32:33], v194 offset:0
    ds_read_b64_tr_b16 v[34:35], v194 offset:4096
    ds_read_b64_tr_b16 v[36:37], v195 offset:0
    ds_read_b64_tr_b16 v[38:39], v195 offset:4096
    ds_read_b64_tr_b16 v[40:41], v196 offset:0
    ds_read_b64_tr_b16 v[42:43], v196 offset:4096
    ds_read_b64_tr_b16 v[44:45], v197 offset:0
    ds_read_b64_tr_b16 v[46:47], v197 offset:4096
    s_add_u32 m0, s70, 98304
    s_nop 0
    buffer_load_dwordx4 v182, s[52:55], s69 offen offset:0 lds
    buffer_load_dwordx4 v183, s[52:55], s69 offen offset:1024 lds
    buffer_load_dwordx4 v184, s[52:55], s69 offen offset:2048 lds
    buffer_load_dwordx4 v185, s[52:55], s69 offen offset:3072 lds
    s_add_u32 s69, s69, 131072
    buffer_load_dwordx4 a[224:227], v244, s[48:51], s68 offen offset:0 sc1
    buffer_load_dwordx4 a[228:231], v245, s[48:51], s68 offen offset:0 sc1
    buffer_load_dwordx4 a[232:235], v246, s[48:51], s68 offen offset:0 sc1
    buffer_load_dwordx4 a[236:239], v247, s[48:51], s68 offen offset:0 sc1
    s_add_u32 s68, s68, 4096
    s_mov_b32 s72, 0
    s_waitcnt vmcnt(44) lgkmcnt(0)
    v_mfma_f32_16x16x32_bf16 v[112:115], v[16:19], a[128:131], 0
    v_mfma_f32_16x16x32_bf16 v[116:119], v[20:23], a[128:131], 0
    s_barrier
    v_mfma_f32_16x16x32_bf16 v[120:123], v[24:27], a[128:131], 0
    ds_read_b64_tr_b16 v[48:49], v190 offset:16384
    s_add_u32 m0, s70, 114688
    v_mfma_f32_16x16x32_bf16 v[124:127], v[28:31], a[128:131], 0
    buffer_load_dwordx4 v182, s[52:55], s69 offen offset:0 lds
    v_mfma_f32_16x16x32_bf16 v[128:131], v[32:35], a[128:131], 0
    ds_read_b64_tr_b16 v[50:51], v190 offset:20480
    v_mfma_f32_16x16x32_bf16 v[132:135], v[36:39], a[128:131], 0
    ds_read_b64_tr_b16 v[52:53], v191 offset:16384
    v_mfma_f32_16x16x32_bf16 v[136:139], v[40:43], a[128:131], 0
    ds_read_b64_tr_b16 v[54:55], v191 offset:20480
    v_mfma_f32_16x16x32_bf16 v[140:143], v[44:47], a[128:131], 0
    buffer_load_dwordx4 v183, s[52:55], s69 offen offset:1024 lds
    v_mfma_f32_16x16x32_bf16 v[144:147], v[16:19], a[132:135], 0
    ds_read_b64_tr_b16 v[56:57], v192 offset:16384
    v_mfma_f32_16x16x32_bf16 v[148:151], v[20:23], a[132:135], 0
    ds_read_b64_tr_b16 v[58:59], v192 offset:20480
    v_mfma_f32_16x16x32_bf16 v[152:155], v[24:27], a[132:135], 0
    ds_read_b64_tr_b16 v[60:61], v193 offset:16384
    v_mfma_f32_16x16x32_bf16 v[156:159], v[28:31], a[132:135], 0
    buffer_load_dwordx4 v184, s[52:55], s69 offen offset:2048 lds
    v_mfma_f32_16x16x32_bf16 v[160:163], v[32:35], a[132:135], 0
    ds_read_b64_tr_b16 v[62:63], v193 offset:20480
    v_mfma_f32_16x16x32_bf16 v[164:167], v[36:39], a[132:135], 0
    ds_read_b64_tr_b16 v[64:65], v194 offset:16384
    v_mfma_f32_16x16x32_bf16 v[168:171], v[40:43], a[132:135], 0
    ds_read_b64_tr_b16 v[66:67], v194 offset:20480
    v_mfma_f32_16x16x32_bf16 v[172:175], v[44:47], a[132:135], 0
    buffer_load_dwordx4 v185, s[52:55], s69 offen offset:3072 lds
    s_add_u32 s69, s69, 131072
    v_mfma_f32_16x16x32_bf16 a[64:67], v[16:19], a[136:139], 0
    ds_read_b64_tr_b16 v[68:69], v195 offset:16384
    v_mfma_f32_16x16x32_bf16 a[68:71], v[20:23], a[136:139], 0
    ds_read_b64_tr_b16 v[70:71], v195 offset:20480
    v_mfma_f32_16x16x32_bf16 a[72:75], v[24:27], a[136:139], 0
    ds_read_b64_tr_b16 v[72:73], v196 offset:16384
    v_mfma_f32_16x16x32_bf16 a[76:79], v[28:31], a[136:139], 0
    buffer_load_dwordx4 v[224:227], v244, s[48:51], s68 offen offset:0 sc1
    v_mfma_f32_16x16x32_bf16 a[80:83], v[32:35], a[136:139], 0
    ds_read_b64_tr_b16 v[74:75], v196 offset:20480
    v_mfma_f32_16x16x32_bf16 a[84:87], v[36:39], a[136:139], 0
    ds_read_b64_tr_b16 v[76:77], v197 offset:16384
    v_mfma_f32_16x16x32_bf16 a[88:91], v[40:43], a[136:139], 0
    ds_read_b64_tr_b16 v[78:79], v197 offset:20480
    v_mfma_f32_16x16x32_bf16 a[92:95], v[44:47], a[136:139], 0
    buffer_load_dwordx4 v[228:231], v245, s[48:51], s68 offen offset:0 sc1
    v_mfma_f32_16x16x32_bf16 a[96:99], v[16:19], a[140:143], 0
    v_mfma_f32_16x16x32_bf16 a[100:103], v[20:23], a[140:143], 0
    v_mfma_f32_16x16x32_bf16 a[104:107], v[24:27], a[140:143], 0
    v_mfma_f32_16x16x32_bf16 a[108:111], v[28:31], a[140:143], 0
    buffer_load_dwordx4 v[232:235], v246, s[48:51], s68 offen offset:0 sc1
    v_mfma_f32_16x16x32_bf16 a[112:115], v[32:35], a[140:143], 0
    v_mfma_f32_16x16x32_bf16 a[116:119], v[36:39], a[140:143], 0
    v_mfma_f32_16x16x32_bf16 a[120:123], v[40:43], a[140:143], 0
    buffer_load_dwordx4 v[236:239], v247, s[48:51], s68 offen offset:0 sc1
    s_add_u32 s68, s68, 4096
    v_mfma_f32_16x16x32_bf16 a[124:127], v[44:47], a[140:143], 0
    s_branch L_g2_s1
L_g2_loop:
    s_waitcnt vmcnt(44) lgkmcnt(0)
    v_mfma_f32_16x16x32_bf16 v[112:115], v[16:19], a[128:131], v[112:115]
    v_mfma_f32_16x16x32_bf16 v[116:119], v[20:23], a[128:131], v[116:119]
    s_barrier
    v_mfma_f32_16x16x32_bf16 v[120:123], v[24:27], a[128:131], v[120:123]
    ds_read_b64_tr_b16 v[48:49], v190 offset:16384
    s_add_u32 m0, s70, 114688
    v_mfma_f32_16x16x32_bf16 v[124:127], v[28:31], a[128:131], v[124:127]
    buffer_load_dwordx4 v182, s[52:55], s69 offen offset:0 lds
    v_mfma_f32_16x16x32_bf16 v[128:131], v[32:35], a[128:131], v[128:131]
    ds_read_b64_tr_b16 v[50:51], v190 offset:20480
    v_mfma_f32_16x16x32_bf16 v[132:135], v[36:39], a[128:131], v[132:135]
    ds_read_b64_tr_b16 v[52:53], v191 offset:16384
    v_mfma_f32_16x16x32_bf16 v[136:139], v[40:43], a[128:131], v[136:139]
    ds_read_b64_tr_b16 v[54:55], v191 offset:20480
    v_mfma_f32_16x16x32_bf16 v[140:143], v[44:47], a[128:131], v[140:143]
    buffer_load_dwordx4 v183, s[52:55], s69 offen offset:1024 lds
    v_mfma_f32_16x16x32_bf16 v[144:147], v[16:19], a[132:135], v[144:147]
    ds_read_b64_tr_b16 v[56:57], v192 offset:16384
    v_mfma_f32_16x16x32_bf16 v[148:151], v[20:23], a[132:135], v[148:151]
    ds_read_b64_tr_b16 v[58:59], v192 offset:20480
    v_mfma_f32_16x16x32_bf16 v[152:155], v[24:27], a[132:135], v[152:155]
    ds_read_b64_tr_b16 v[60:61], v193 offset:16384
    v_mfma_f32_16x16x32_bf16 v[156:159], v[28:31], a[132:135], v[156:159]
    buffer_load_dwordx4 v184, s[52:55], s69 offen offset:2048 lds
    v_mfma_f32_16x16x32_bf16 v[160:163], v[32:35], a[132:135], v[160:163]
    ds_read_b64_tr_b16 v[62:63], v193 offset:20480
    v_mfma_f32_16x16x32_bf16 v[164:167], v[36:39], a[132:135], v[164:167]
    ds_read_b64_tr_b16 v[64:65], v194 offset:16384
    v_mfma_f32_16x16x32_bf16 v[168:171], v[40:43], a[132:135], v[168:171]
    ds_read_b64_tr_b16 v[66:67], v194 offset:20480
    v_mfma_f32_16x16x32_bf16 v[172:175], v[44:47], a[132:135], v[172:175]
    buffer_load_dwordx4 v185, s[52:55], s69 offen offset:3072 lds
    s_add_u32 s69, s69, 131072
    v_mfma_f32_16x16x32_bf16 a[64:67], v[16:19], a[136:139], a[64:67]
    ds_read_b64_tr_b16 v[68:69], v195 offset:16384
    v_mfma_f32_16x16x32_bf16 a[68:71], v[20:23], a[136:139], a[68:71]
    ds_read_b64_tr_b16 v[70:71], v195 offset:20480
    v_mfma_f32_16x16x32_bf16 a[72:75], v[24:27], a[136:139], a[72:75]
    ds_read_b64_tr_b16 v[72:73], v196 offset:16384
    v_mfma_f32_16x16x32_bf16 a[76:79], v[28:31], a[136:139], a[76:79]
    buffer_load_dwordx4 v[224:227], v244, s[48:51], s68 offen offset:0 sc1
    v_mfma_f32_16x16x32_bf16 a[80:83], v[32:35], a[136:139], a[80:83]
    ds_read_b64_tr_b16 v[74:75], v196 offset:20480
    v_mfma_f32_16x16x32_bf16 a[84:87], v[36:39], a[136:139], a[84:87]
    ds_read_b64_tr_b16 v[76:77], v197 offset:16384
    v_mfma_f32_16x16x32_bf16 a[88:91], v[40:43], a[136:139], a[88:91]
    ds_read_b64_tr_b16 v[78:79], v197 offset:20480
    v_mfma_f32_16x16x32_bf16 a[92:95], v[44:47], a[136:139], a[92:95]
    buffer_load_dwordx4 v[228:231], v245, s[48:51], s68 offen offset:0 sc1
    v_mfma_f32_16x16x32_bf16 a[96:99], v[16:19], a[140:143], a[96:99]
    v_mfma_f32_16x16x32_bf16 a[100:103], v[20:23], a[140:143], a[100:103]
    v_mfma_f32_16x16x32_bf16 a[104:107], v[24:27], a[140:143], a[104:107]
    v_mfma_f32_16x16x32_bf16 a[108:111], v[28:31], a[140:143], a[108:111]
    buffer_load_dwordx4 v[232:235], v246, s[48:51], s68 offen offset:0 sc1
    v_mfma_f32_16x16x32_bf16 a[112:115], v[32:35], a[140:143], a[112:115]
    v_mfma_f32_16x16x32_bf16 a[116:119], v[36:39], a[140:143], a[116:119]
    v_mfma_f32_16x16x32_bf16 a[120:123], v[40:43], a[140:143], a[120:123]
    buffer_load_dwordx4 v[236:239], v247, s[48:51], s68 offen offset:0 sc1
    s_add_u32 s68, s68, 4096
    v_mfma_f32_16x16x32_bf16 a[124:127], v[44:47], a[140:143], a[124:127]
L_g2_s1:
    s_waitcnt vmcnt(44) lgkmcnt(0)
    v_mfma_f32_16x16x32_bf16 v[112:115], v[48:51], a[144:147], v[112:115]
    v_mfma_f32_16x16x32_bf16 v[116:119], v[52:55], a[144:147], v[116:119]
    s_barrier
    v_mfma_f32_16x16x32_bf16 v[120:123], v[56:59], a[144:147], v[120:123]
    ds_read_b64_tr_b16 v[16:17], v190 offset:32768
    s_add_u32 m0, s70, 0
    v_mfma_f32_16x16x32_bf16 v[124:127], v[60:63], a[144:147], v[124:127]
    buffer_load_dwordx4 v182, s[52:55], s69 offen offset:0 lds
    v_mfma_f32_16x16x32_bf16 v[128:131], v[64:67], a[144:147], v[128:131]
    ds_read_b64_tr_b16 v[18:19], v190 offset:36864
    v_mfma_f32_16x16x32_bf16 v[132:135], v[68:71], a[144:147], v[132:135]
    ds_read_b64_tr_b16 v[20:21], v191 offset:32768
    v_mfma_f32_16x16x32_bf16 v[136:139], v[72:75], a[144:147], v[136:139]
    ds_read_b64_tr_b16 v[22:23], v191 offset:36864
    v_mfma_f32_16x16x32_bf16 v[140:143], v[76:79], a[144:147], v[140:143]
    buffer_load_dwordx4 v183, s[52:55], s69 offen offset:1024 lds
    v_mfma_f32_16x16x32_bf16 v[144:147], v[48:51], a[148:151], v[144:147]
    ds_read_b64_tr_b16 v[24:25], v192 offset:32768
    v_mfma_f32_16x16x32_bf16 v[148:151], v[52:55], a[148:151], v[148:151]
    ds_read_b64_tr_b16 v[26:27], v192 offset:36864
    v_mfma_f32_16x16x32_bf16 v[152:155], v[56:59], a[148:151], v[152:155]
    ds_read_b64_tr_b16 v[28:29], v193 offset:32768
    v_mfma_f32_16x16x32_bf16 v[156:159], v[60:63], a[148:151], v[156:159]
    buffer_load_dwordx4 v184, s[52:55], s69 offen offset:2048 lds
    v_mfma_f32_16x16x32_bf16 v[160:163], v[64:67], a[148:151], v[160:163]
    ds_read_b64_tr_b16 v[30:31], v193 offset:36864
    v_mfma_f32_16x16x32_bf16 v[164:167], v[68:71], a[148:151], v[164:167]
    ds_read_b64_tr_b16 v[32:33], v194 offset:32768
    v_mfma_f32_16x16x32_bf16 v[168:171], v[72:75], a[148:151], v[168:171]
    ds_read_b64_tr_b16 v[34:35], v194 offset:36864
    v_mfma_f32_16x16x32_bf16 v[172:175], v[76:79], a[148:151], v[172:175]
    buffer_load_dwordx4 v185, s[52:55], s69 offen offset:3072 lds
    s_add_u32 s69, s69, 131072
    v_mfma_f32_16x16x32_bf16 a[64:67], v[48:51], a[152:155], a[64:67]
    ds_read_b64_tr_b16 v[36:37], v195 offset:32768
    v_mfma_f32_16x16x32_bf16 a[68:71], v[52:55], a[152:155], a[68:71]
    ds_read_b64_tr_b16 v[38:39], v195 offset:36864
    v_mfma_f32_16x16x32_bf16 a[72:75], v[56:59], a[152:155], a[72:75]
    ds_read_b64_tr_b16 v[40:41], v196 offset:32768
    v_mfma_f32_16x16x32_bf16 a[76:79], v[60:63], a[152:155], a[76:79]
    buffer_load_dwordx4 a[128:131], v244, s[48:51], s68 offen offset:0 sc1
    v_mfma_f32_16x16x32_bf16 a[80:83], v[64:67], a[152:155], a[80:83]
    ds_read_b64_tr_b16 v[42:43], v196 offset:36864
    v_mfma_f32_16x16x32_bf16 a[84:87], v[68:71], a[152:155], a[84:87]
    ds_read_b64_tr_b16 v[44:45], v197 offset:32768
    v_mfma_f32_16x16x32_bf16 a[88:91], v[72:75], a[152:155], a[88:91]
    ds_read_b64_tr_b16 v[46:47], v197 offset:36864
    v_mfma_f32_16x16x32_bf16 a[92:95], v[76:79], a[152:155], a[92:95]
    buffer_load_dwordx4 a[132:135], v245, s[48:51], s68 offen offset:0 sc1
    v_mfma_f32_16x16x32_bf16 a[96:99], v[48:51], a[156:159], a[96:99]
    v_mfma_f32_16x16x32_bf16 a[100:103], v[52:55], a[156:159], a[100:103]
    v_mfma_f32_16x16x32_bf16 a[104:107], v[56:59], a[156:159], a[104:107]
    v_mfma_f32_16x16x32_bf16 a[108:111], v[60:63], a[156:159], a[108:111]
    buffer_load_dwordx4 a[136:139], v246, s[48:51], s68 offen offset:0 sc1
    v_mfma_f32_16x16x32_bf16 a[112:115], v[64:67], a[156:159], a[112:115]
    v_mfma_f32_16x16x32_bf16 a[116:119], v[68:71], a[156:159], a[116:119]
    v_mfma_f32_16x16x32_bf16 a[120:123], v[72:75], a[156:159], a[120:123]
    buffer_load_dwordx4 a[140:143], v247, s[48:51], s68 offen offset:0 sc1
    s_add_u32 s68, s68, 4096
    v_mfma_f32_16x16x32_bf16 a[124:127], v[76:79], a[156:159], a[124:127]
    s_cmp_eq_u32 s72, 2
    s_cbranch_scc0 L_g2_nosm
    buffer_load_dword v209, v208, s[24:27], s82 offen sc1
L_g2_nosm:
    s_cmp_eq_u32 s72, 2
    s_cbranch_scc0 L_g2_nocp
    s_getpc_b64 s[36:37]
L_pc_g2:
    s_add_u32 s36, s36, L_code_d - L_pc_g2
    s_addc_u32 s37, s37, 0
    s_mov_b32 s38, L_code_b - L_code_d
    s_mov_b32 s39, 0x00020000
    s_lshr_b32 s19, s2, 3
    s_lshl_b32 s19, s19, 2
    s_add_u32 s19, s19, s14
    s_lshl_b32 s19, s19, 10
    buffer_load_dwordx4 v[240:243], v210, s[36:39], s19 offen
L_g2_nocp:
    s_waitcnt vmcnt(44) lgkmcnt(0)
    v_mfma_f32_16x16x32_bf16 v[112:115], v[16:19], a[160:163], v[112:115]
    v_mfma_f32_16x16x32_bf16 v[116:119], v[20:23], a[160:163], v[116:119]
    s_barrier
    v_mfma_f32_16x16x32_bf16 v[120:123], v[24:27], a[160:163], v[120:123]
    ds_read_b64_tr_b16 v[48:49], v190 offset:49152
    s_add_u32 m0, s70, 16384
    v_mfma_f32_16x16x32_bf16 v[124:127], v[28:31], a[160:163], v[124:127]
    buffer_load_dwordx4 v182, s[52:55], s69 offen offset:0 lds
    v_mfma_f32_16x16x32_bf16 v[128:131], v[32:35], a[160:163], v[128:131]
    ds_read_b64_tr_b16 v[50:51], v190 offset:53248
    v_mfma_f32_16x16x32_bf16 v[132:135], v[36:39], a[160:163], v[132:135]
    ds_read_b64_tr_b16 v[52:53], v191 offset:49152
    v_mfma_f32_16x16x32_bf16 v[136:139], v[40:43], a[160:163], v[136:139]
    ds_read_b64_tr_b16 v[54:55], v191 offset:53248
    v_mfma_f32_16x16x32_bf16 v[140:143], v[44:47], a[160:163], v[140:143]
    buffer_load_dwordx4 v183, s[52:55], s69 offen offset:1024 lds
    v_mfma_f32_16x16x32_bf16 v[144:147], v[16:19], a[164:167], v[144:147]
    ds_read_b64_tr_b16 v[56:57], v192 offset:49152
    v_mfma_f32_16x16x32_bf16 v[148:151], v[20:23], a[164:167], v[148:151]
    ds_read_b64_tr_b16 v[58:59], v192 offset:53248
    v_mfma_f32_16x16x32_bf16 v[152:155], v[24:27], a[164:167], v[152:155]
    ds_read_b64_tr_b16 v[60:61], v193 offset:49152
    v_mfma_f32_16x16x32_bf16 v[156:159], v[28:31], a[164:167], v[156:159]
    buffer_load_dwordx4 v184, s[52:55], s69 offen offset:2048 lds
    v_mfma_f32_16x16x32_bf16 v[160:163], v[32:35], a[164:167], v[160:163]
    ds_read_b64_tr_b16 v[62:63], v193 offset:53248
    v_mfma_f32_16x16x32_bf16 v[164:167], v[36:39], a[164:167], v[164:167]
    ds_read_b64_tr_b16 v[64:65], v194 offset:49152
    v_mfma_f32_16x16x32_bf16 v[168:171], v[40:43], a[164:167], v[168:171]
    ds_read_b64_tr_b16 v[66:67], v194 offset:53248
    v_mfma_f32_16x16x32_bf16 v[172:175], v[44:47], a[164:167], v[172:175]
    buffer_load_dwordx4 v185, s[52:55], s69 offen offset:3072 lds
    s_add_u32 s69, s69, 131072
    v_mfma_f32_16x16x32_bf16 a[64:67], v[16:19], a[168:171], a[64:67]
    ds_read_b64_tr_b16 v[68:69], v195 offset:49152
    v_mfma_f32_16x16x32_bf16 a[68:71], v[20:23], a[168:171], a[68:71]
    ds_read_b64_tr_b16 v[70:71], v195 offset:53248
    v_mfma_f32_16x16x32_bf16 a[72:75], v[24:27], a[168:171], a[72:75]
    ds_read_b64_tr_b16 v[72:73], v196 offset:49152
    v_mfma_f32_16x16x32_bf16 a[76:79], v[28:31], a[168:171], a[76:79]
    buffer_load_dwordx4 a[144:147], v244, s[48:51], s68 offen offset:0 sc1
    v_mfma_f32_16x16x32_bf16 a[80:83], v[32:35], a[168:171], a[80:83]
    ds_read_b64_tr_b16 v[74:75], v196 offset:53248
    v_mfma_f32_16x16x32_bf16 a[84:87], v[36:39], a[168:171], a[84:87]
    ds_read_b64_tr_b16 v[76:77], v197 offset:49152
    v_mfma_f32_16x16x32_bf16 a[88:91], v[40:43], a[168:171], a[88:91]
    ds_read_b64_tr_b16 v[78:79], v197 offset:53248
    v_mfma_f32_16x16x32_bf16 a[92:95], v[44:47], a[168:171], a[92:95]
    buffer_load_dwordx4 a[148:151], v245, s[48:51], s68 offen offset:0 sc1
    v_mfma_f32_16x16x32_bf16 a[96:99], v[16:19], a[172:175], a[96:99]
    v_mfma_f32_16x16x32_bf16 a[100:103], v[20:23], a[172:175], a[100:103]
    v_mfma_f32_16x16x32_bf16 a[104:107], v[24:27], a[172:175], a[104:107]
    v_mfma_f32_16x16x32_bf16 a[108:111], v[28:31], a[172:175], a[108:111]
    buffer_load_dwordx4 a[152:155], v246, s[48:51], s68 offen offset:0 sc1
    v_mfma_f32_16x16x32_bf16 a[112:115], v[32:35], a[172:175], a[112:115]
    v_mfma_f32_16x16x32_bf16 a[116:119], v[36:39], a[172:175], a[116:119]
    v_mfma_f32_16x16x32_bf16 a[120:123], v[40:43], a[172:175], a[120:123]
    buffer_load_dwordx4 a[156:159], v247, s[48:51], s68 offen offset:0 sc1
    s_add_u32 s68, s68, 4096
    v_mfma_f32_16x16x32_bf16 a[124:127], v[44:47], a[172:175], a[124:127]
    s_cmp_eq_u32 s72, 0
    s_cbranch_scc0 L_g2_nofs
    s_waitcnt vmcnt(32)
    v_mov_b32 v211, 1
    s_mov_b64 exec, 1
    buffer_store_dword v211, off, s[24:27], s30 sc1
    s_mov_b64 exec, -1
L_g2_nofs:
    s_waitcnt vmcnt(44) lgkmcnt(0)
    v_mfma_f32_16x16x32_bf16 v[112:115], v[48:51], a[176:179], v[112:115]
    v_mfma_f32_16x16x32_bf16 v[116:119], v[52:55], a[176:179], v[116:119]
    s_barrier
    v_mfma_f32_16x16x32_bf16 v[120:123], v[56:59], a[176:179], v[120:123]
    ds_read_b64_tr_b16 v[16:17], v198 offset:0
    s_add_u32 m0, s70, 32768
    v_mfma_f32_16x16x32_bf16 v[124:127], v[60:63], a[176:179], v[124:127]
    buffer_load_dwordx4 v182, s[52:55], s69 offen offset:0 lds
    v_mfma_f32_16x16x32_bf16 v[128:131], v[64:67], a[176:179], v[128:131]
    ds_read_b64_tr_b16 v[18:19], v198 offset:4096
    v_mfma_f32_16x16x32_bf16 v[132:135], v[68:71], a[176:179], v[132:135]
    ds_read_b64_tr_b16 v[20:21], v199 offset:0
    v_mfma_f32_16x16x32_bf16 v[136:139], v[72:75], a[176:179], v[136:139]
    ds_read_b64_tr_b16 v[22:23], v199 offset:4096
    v_mfma_f32_16x16x32_bf16 v[140:143], v[76:79], a[176:179], v[140:143]
    buffer_load_dwordx4 v183, s[52:55], s69 offen offset:1024 lds
    v_mfma_f32_16x16x32_bf16 v[144:147], v[48:51], a[180:183], v[144:147]
    ds_read_b64_tr_b16 v[24:25], v200 offset:0
    v_mfma_f32_16x16x32_bf16 v[148:151], v[52:55], a[180:183], v[148:151]
    ds_read_b64_tr_b16 v[26:27], v200 offset:4096
    v_mfma_f32_16x16x32_bf16 v[152:155], v[56:59], a[180:183], v[152:155]
    ds_read_b64_tr_b16 v[28:29], v201 offset:0
    v_mfma_f32_16x16x32_bf16 v[156:159], v[60:63], a[180:183], v[156:159]
    buffer_load_dwordx4 v184, s[52:55], s69 offen offset:2048 lds
    v_mfma_f32_16x16x32_bf16 v[160:163], v[64:67], a[180:183], v[160:163]
    ds_read_b64_tr_b16 v[30:31], v201 offset:4096
    v_mfma_f32_16x16x32_bf16 v[164:167], v[68:71], a[180:183], v[164:167]
    ds_read_b64_tr_b16 v[32:33], v202 offset:0
    v_mfma_f32_16x16x32_bf16 v[168:171], v[72:75], a[180:183], v[168:171]
    ds_read_b64_tr_b16 v[34:35], v202 offset:4096
    v_mfma_f32_16x16x32_bf16 v[172:175], v[76:79], a[180:183], v[172:175]
    buffer_load_dwordx4 v185, s[52:55], s69 offen offset:3072 lds
    s_add_u32 s69, s69, 131072
    v_mfma_f32_16x16x32_bf16 a[64:67], v[48:51], a[184:187], a[64:67]
    ds_read_b64_tr_b16 v[36:37], v203 offset:0
    v_mfma_f32_16x16x32_bf16 a[68:71], v[52:55], a[184:187], a[68:71]
    ds_read_b64_tr_b16 v[38:39], v203 offset:4096
    v_mfma_f32_16x16x32_bf16 a[72:75], v[56:59], a[184:187], a[72:75]
    ds_read_b64_tr_b16 v[40:41], v204 offset:0
    v_mfma_f32_16x16x32_bf16 a[76:79], v[60:63], a[184:187], a[76:79]
    buffer_load_dwordx4 a[160:163], v244, s[48:51], s68 offen offset:0 sc1
    v_mfma_f32_16x16x32_bf16 a[80:83], v[64:67], a[184:187], a[80:83]
    ds_read_b64_tr_b16 v[42:43], v204 offset:4096
    v_mfma_f32_16x16x32_bf16 a[84:87], v[68:71], a[184:187], a[84:87]
    ds_read_b64_tr_b16 v[44:45], v205 offset:0
    v_mfma_f32_16x16x32_bf16 a[88:91], v[72:75], a[184:187], a[88:91]
    ds_read_b64_tr_b16 v[46:47], v205 offset:4096
    v_mfma_f32_16x16x32_bf16 a[92:95], v[76:79], a[184:187], a[92:95]
    buffer_load_dwordx4 a[164:167], v245, s[48:51], s68 offen offset:0 sc1
    v_mfma_f32_16x16x32_bf16 a[96:99], v[48:51], a[188:191], a[96:99]
    v_mfma_f32_16x16x32_bf16 a[100:103], v[52:55], a[188:191], a[100:103]
    v_mfma_f32_16x16x32_bf16 a[104:107], v[56:59], a[188:191], a[104:107]
    v_mfma_f32_16x16x32_bf16 a[108:111], v[60:63], a[188:191], a[108:111]
    buffer_load_dwordx4 a[168:171], v246, s[48:51], s68 offen offset:0 sc1
    v_mfma_f32_16x16x32_bf16 a[112:115], v[64:67], a[188:191], a[112:115]
    v_mfma_f32_16x16x32_bf16 a[116:119], v[68:71], a[188:191], a[116:119]
    v_mfma_f32_16x16x32_bf16 a[120:123], v[72:75], a[188:191], a[120:123]
    buffer_load_dwordx4 a[172:175], v247, s[48:51], s68 offen offset:0 sc1
    s_add_u32 s68, s68, 4096
    v_mfma_f32_16x16x32_bf16 a[124:127], v[76:79], a[188:191], a[124:127]
    s_waitcnt vmcnt(44) lgkmcnt(0)
    v_mfma_f32_16x16x32_bf16 v[112:115], v[16:19], a[192:195], v[112:115]
    v_mfma_f32_16x16x32_bf16 v[116:119], v[20:23], a[192:195], v[116:119]
    s_barrier
    v_mfma_f32_16x16x32_bf16 v[120:123], v[24:27], a[192:195], v[120:123]
    ds_read_b64_tr_b16 v[48:49], v198 offset:16384
    s_add_u32 m0, s70, 49152
    v_mfma_f32_16x16x32_bf16 v[124:127], v[28:31], a[192:195], v[124:127]
    buffer_load_dwordx4 v182, s[52:55], s69 offen offset:0 lds
    v_mfma_f32_16x16x32_bf16 v[128:131], v[32:35], a[192:195], v[128:131]
    ds_read_b64_tr_b16 v[50:51], v198 offset:20480
    v_mfma_f32_16x16x32_bf16 v[132:135], v[36:39], a[192:195], v[132:135]
    ds_read_b64_tr_b16 v[52:53], v199 offset:16384
    v_mfma_f32_16x16x32_bf16 v[136:139], v[40:43], a[192:195], v[136:139]
    ds_read_b64_tr_b16 v[54:55], v199 offset:20480
    v_mfma_f32_16x16x32_bf16 v[140:143], v[44:47], a[192:195], v[140:143]
    buffer_load_dwordx4 v183, s[52:55], s69 offen offset:1024 lds
    v_mfma_f32_16x16x32_bf16 v[144:147], v[16:19], a[196:199], v[144:147]
    ds_read_b64_tr_b16 v[56:57], v200 offset:16384
    v_mfma_f32_16x16x32_bf16 v[148:151], v[20:23], a[196:199], v[148:151]
    ds_read_b64_tr_b16 v[58:59], v200 offset:20480
    v_mfma_f32_16x16x32_bf16 v[152:155], v[24:27], a[196:199], v[152:155]
    ds_read_b64_tr_b16 v[60:61], v201 offset:16384
    v_mfma_f32_16x16x32_bf16 v[156:159], v[28:31], a[196:199], v[156:159]
    buffer_load_dwordx4 v184, s[52:55], s69 offen offset:2048 lds
    v_mfma_f32_16x16x32_bf16 v[160:163], v[32:35], a[196:199], v[160:163]
    ds_read_b64_tr_b16 v[62:63], v201 offset:20480
    v_mfma_f32_16x16x32_bf16 v[164:167], v[36:39], a[196:199], v[164:167]
    ds_read_b64_tr_b16 v[64:65], v202 offset:16384
    v_mfma_f32_16x16x32_bf16 v[168:171], v[40:43], a[196:199], v[168:171]
    ds_read_b64_tr_b16 v[66:67], v202 offset:20480
    v_mfma_f32_16x16x32_bf16 v[172:175], v[44:47], a[196:199], v[172:175]
    buffer_load_dwordx4 v185, s[52:55], s69 offen offset:3072 lds
    s_add_u32 s69, s69, 131072
    v_mfma_f32_16x16x32_bf16 a[64:67], v[16:19], a[200:203], a[64:67]
    ds_read_b64_tr_b16 v[68:69], v203 offset:16384
    v_mfma_f32_16x16x32_bf16 a[68:71], v[20:23], a[200:203], a[68:71]
    ds_read_b64_tr_b16 v[70:71], v203 offset:20480
    v_mfma_f32_16x16x32_bf16 a[72:75], v[24:27], a[200:203], a[72:75]
    ds_read_b64_tr_b16 v[72:73], v204 offset:16384
    v_mfma_f32_16x16x32_bf16 a[76:79], v[28:31], a[200:203], a[76:79]
    buffer_load_dwordx4 a[176:179], v244, s[48:51], s68 offen offset:0 sc1
    v_mfma_f32_16x16x32_bf16 a[80:83], v[32:35], a[200:203], a[80:83]
    ds_read_b64_tr_b16 v[74:75], v204 offset:20480
    v_mfma_f32_16x16x32_bf16 a[84:87], v[36:39], a[200:203], a[84:87]
    ds_read_b64_tr_b16 v[76:77], v205 offset:16384
    v_mfma_f32_16x16x32_bf16 a[88:91], v[40:43], a[200:203], a[88:91]
    ds_read_b64_tr_b16 v[78:79], v205 offset:20480
    v_mfma_f32_16x16x32_bf16 a[92:95], v[44:47], a[200:203], a[92:95]
    buffer_load_dwordx4 a[180:183], v245, s[48:51], s68 offen offset:0 sc1
    v_mfma_f32_16x16x32_bf16 a[96:99], v[16:19], a[204:207], a[96:99]
    v_mfma_f32_16x16x32_bf16 a[100:103], v[20:23], a[204:207], a[100:103]
    v_mfma_f32_16x16x32_bf16 a[104:107], v[24:27], a[204:207], a[104:107]
    v_mfma_f32_16x16x32_bf16 a[108:111], v[28:31], a[204:207], a[108:111]
    buffer_load_dwordx4 a[184:187], v246, s[48:51], s68 offen offset:0 sc1
    v_mfma_f32_16x16x32_bf16 a[112:115], v[32:35], a[204:207], a[112:115]
    v_mfma_f32_16x16x32_bf16 a[116:119], v[36:39], a[204:207], a[116:119]
    v_mfma_f32_16x16x32_bf16 a[120:123], v[40:43], a[204:207], a[120:123]
    buffer_load_dwordx4 a[188:191], v247, s[48:51], s68 offen offset:0 sc1
    s_add_u32 s68, s68, 4096
    v_mfma_f32_16x16x32_bf16 a[124:127], v[44:47], a[204:207], a[124:127]
    s_cmp_eq_u32 s72, 2
    s_cbranch_scc0 L_g2_nosw
    s_mov_b32 s52, s88
    s_mov_b32 s53, s89
    s_mov_b32 s54, 0x200000
    s_lshl_b32 s69, s73, 20
    s_lshl_b32 s68, s73, 15
    v_mov_b32 v182, v186
    v_mov_b32 v183, v187
    v_mov_b32 v184, v188
    v_mov_b32 v185, v189
    s_waitcnt vmcnt(24)
    s_mov_b32 s19, 0x80000
L_fw_o:
    v_cmp_ne_u32 vcc, 1, v209
    s_nop 1
    s_cmp_eq_u64 vcc, 0
    s_cbranch_scc1 L_fwd_o
    s_sleep 1
    buffer_load_dword v209, v208, s[24:27], s82 offen sc1
    s_waitcnt vmcnt(0)
    s_sub_u32 s19, s19, 1
    s_cmp_lg_u32 s19, 0
    s_cbranch_scc1 L_fw_o
L_fwd_o:
L_g2_nosw:
    s_waitcnt vmcnt(44) lgkmcnt(0)
    v_mfma_f32_16x16x32_bf16 v[112:115], v[48:51], a[208:211], v[112:115]
    v_mfma_f32_16x16x32_bf16 v[116:119], v[52:55], a[208:211], v[116:119]
    s_barrier
    v_mfma_f32_16x16x32_bf16 v[120:123], v[56:59], a[208:211], v[120:123]
    ds_read_b64_tr_b16 v[16:17], v198 offset:32768
    s_add_u32 m0, s70, 65536
    v_mfma_f32_16x16x32_bf16 v[124:127], v[60:63], a[208:211], v[124:127]
    buffer_load_dwordx4 v182, s[52:55], s69 offen offset:0 lds
    v_mfma_f32_16x16x32_bf16 v[128:131], v[64:67], a[208:211], v[128:131]
    ds_read_b64_tr_b16 v[18:19], v198 offset:36864
    v_mfma_f32_16x16x32_bf16 v[132:135], v[68:71], a[208:211], v[132:135]
    ds_read_b64_tr_b16 v[20:21], v199 offset:32768
    v_mfma_f32_16x16x32_bf16 v[136:139], v[72:75], a[208:211], v[136:139]
    ds_read_b64_tr_b16 v[22:23], v199 offset:36864
    v_mfma_f32_16x16x32_bf16 v[140:143], v[76:79], a[208:211], v[140:143]
    buffer_load_dwordx4 v183, s[52:55], s69 offen offset:1024 lds
    v_mfma_f32_16x16x32_bf16 v[144:147], v[48:51], a[212:215], v[144:147]
    ds_read_b64_tr_b16 v[24:25], v200 offset:32768
    v_mfma_f32_16x16x32_bf16 v[148:151], v[52:55], a[212:215], v[148:151]
    ds_read_b64_tr_b16 v[26:27], v200 offset:36864
    v_mfma_f32_16x16x32_bf16 v[152:155], v[56:59], a[212:215], v[152:155]
    ds_read_b64_tr_b16 v[28:29], v201 offset:32768
    v_mfma_f32_16x16x32_bf16 v[156:159], v[60:63], a[212:215], v[156:159]
    buffer_load_dwordx4 v184, s[52:55], s69 offen offset:2048 lds
    v_mfma_f32_16x16x32_bf16 v[160:163], v[64:67], a[212:215], v[160:163]
    ds_read_b64_tr_b16 v[30:31], v201 offset:36864
    v_mfma_f32_16x16x32_bf16 v[164:167], v[68:71], a[212:215], v[164:167]
    ds_read_b64_tr_b16 v[32:33], v202 offset:32768
    v_mfma_f32_16x16x32_bf16 v[168:171], v[72:75], a[212:215], v[168:171]
    ds_read_b64_tr_b16 v[34:35], v202 offset:36864
    v_mfma_f32_16x16x32_bf16 v[172:175], v[76:79], a[212:215], v[172:175]
    buffer_load_dwordx4 v185, s[52:55], s69 offen offset:3072 lds
    s_add_u32 s69, s69, 131072
    v_mfma_f32_16x16x32_bf16 a[64:67], v[48:51], a[216:219], a[64:67]
    ds_read_b64_tr_b16 v[36:37], v203 offset:32768
    v_mfma_f32_16x16x32_bf16 a[68:71], v[52:55], a[216:219], a[68:71]
    ds_read_b64_tr_b16 v[38:39], v203 offset:36864
    v_mfma_f32_16x16x32_bf16 a[72:75], v[56:59], a[216:219], a[72:75]
    ds_read_b64_tr_b16 v[40:41], v204 offset:32768
    v_mfma_f32_16x16x32_bf16 a[76:79], v[60:63], a[216:219], a[76:79]
    buffer_load_dwordx4 a[192:195], v244, s[48:51], s68 offen offset:0 sc1
    v_mfma_f32_16x16x32_bf16 a[80:83], v[64:67], a[216:219], a[80:83]
    ds_read_b64_tr_b16 v[42:43], v204 offset:36864
    v_mfma_f32_16x16x32_bf16 a[84:87], v[68:71], a[216:219], a[84:87]
    ds_read_b64_tr_b16 v[44:45], v205 offset:32768
    v_mfma_f32_16x16x32_bf16 a[88:91], v[72:75], a[216:219], a[88:91]
    ds_read_b64_tr_b16 v[46:47], v205 offset:36864
    v_mfma_f32_16x16x32_bf16 a[92:95], v[76:79], a[216:219], a[92:95]
    buffer_load_dwordx4 a[196:199], v245, s[48:51], s68 offen offset:0 sc1
    v_mfma_f32_16x16x32_bf16 a[96:99], v[48:51], a[220:223], a[96:99]
    v_mfma_f32_16x16x32_bf16 a[100:103], v[52:55], a[220:223], a[100:103]
    v_mfma_f32_16x16x32_bf16 a[104:107], v[56:59], a[220:223], a[104:107]
    v_mfma_f32_16x16x32_bf16 a[108:111], v[60:63], a[220:223], a[108:111]
    buffer_load_dwordx4 a[200:203], v246, s[48:51], s68 offen offset:0 sc1
    v_mfma_f32_16x16x32_bf16 a[112:115], v[64:67], a[220:223], a[112:115]
    v_mfma_f32_16x16x32_bf16 a[116:119], v[68:71], a[220:223], a[116:119]
    v_mfma_f32_16x16x32_bf16 a[120:123], v[72:75], a[220:223], a[120:123]
    buffer_load_dwordx4 a[204:207], v247, s[48:51], s68 offen offset:0 sc1
    s_add_u32 s68, s68, 4096
    v_mfma_f32_16x16x32_bf16 a[124:127], v[76:79], a[220:223], a[124:127]
    s_waitcnt vmcnt(44) lgkmcnt(0)
    v_mfma_f32_16x16x32_bf16 v[112:115], v[16:19], a[224:227], v[112:115]
    v_mfma_f32_16x16x32_bf16 v[116:119], v[20:23], a[224:227], v[116:119]
    s_barrier
    v_mfma_f32_16x16x32_bf16 v[120:123], v[24:27], a[224:227], v[120:123]
    ds_read_b64_tr_b16 v[48:49], v198 offset:49152
    s_add_u32 m0, s70, 81920
    v_mfma_f32_16x16x32_bf16 v[124:127], v[28:31], a[224:227], v[124:127]
    buffer_load_dwordx4 v182, s[52:55], s69 offen offset:0 lds
    v_mfma_f32_16x16x32_bf16 v[128:131], v[32:35], a[224:227], v[128:131]
    ds_read_b64_tr_b16 v[50:51], v198 offset:53248
    v_mfma_f32_16x16x32_bf16 v[132:135], v[36:39], a[224:227], v[132:135]
    ds_read_b64_tr_b16 v[52:53], v199 offset:49152
    v_mfma_f32_16x16x32_bf16 v[136:139], v[40:43], a[224:227], v[136:139]
    ds_read_b64_tr_b16 v[54:55], v199 offset:53248
    v_mfma_f32_16x16x32_bf16 v[140:143], v[44:47], a[224:227], v[140:143]
    buffer_load_dwordx4 v183, s[52:55], s69 offen offset:1024 lds
    v_mfma_f32_16x16x32_bf16 v[144:147], v[16:19], a[228:231], v[144:147]
    ds_read_b64_tr_b16 v[56:57], v200 offset:49152
    v_mfma_f32_16x16x32_bf16 v[148:151], v[20:23], a[228:231], v[148:151]
    ds_read_b64_tr_b16 v[58:59], v200 offset:53248
    v_mfma_f32_16x16x32_bf16 v[152:155], v[24:27], a[228:231], v[152:155]
    ds_read_b64_tr_b16 v[60:61], v201 offset:49152
    v_mfma_f32_16x16x32_bf16 v[156:159], v[28:31], a[228:231], v[156:159]
    buffer_load_dwordx4 v184, s[52:55], s69 offen offset:2048 lds
    v_mfma_f32_16x16x32_bf16 v[160:163], v[32:35], a[228:231], v[160:163]
    ds_read_b64_tr_b16 v[62:63], v201 offset:53248
    v_mfma_f32_16x16x32_bf16 v[164:167], v[36:39], a[228:231], v[164:167]
    ds_read_b64_tr_b16 v[64:65], v202 offset:49152
    v_mfma_f32_16x16x32_bf16 v[168:171], v[40:43], a[228:231], v[168:171]
    ds_read_b64_tr_b16 v[66:67], v202 offset:53248
    v_mfma_f32_16x16x32_bf16 v[172:175], v[44:47], a[228:231], v[172:175]
    buffer_load_dwordx4 v185, s[52:55], s69 offen offset:3072 lds
    s_add_u32 s69, s69, 131072
    v_mfma_f32_16x16x32_bf16 a[64:67], v[16:19], a[232:235], a[64:67]
    ds_read_b64_tr_b16 v[68:69], v203 offset:49152
    v_mfma_f32_16x16x32_bf16 a[68:71], v[20:23], a[232:235], a[68:71]
    ds_read_b64_tr_b16 v[70:71], v203 offset:53248
    v_mfma_f32_16x16x32_bf16 a[72:75], v[24:27], a[232:235], a[72:75]
    ds_read_b64_tr_b16 v[72:73], v204 offset:49152
    v_mfma_f32_16x16x32_bf16 a[76:79], v[28:31], a[232:235], a[76:79]
    buffer_load_dwordx4 a[208:211], v244, s[48:51], s68 offen offset:0 sc1
    v_mfma_f32_16x16x32_bf16 a[80:83], v[32:35], a[232:235], a[80:83]
    ds_read_b64_tr_b16 v[74:75], v204 offset:53248
    v_mfma_f32_16x16x32_bf16 a[84:87], v[36:39], a[232:235], a[84:87]
    ds_read_b64_tr_b16 v[76:77], v205 offset:49152
    v_mfma_f32_16x16x32_bf16 a[88:91], v[40:43], a[232:235], a[88:91]
    ds_read_b64_tr_b16 v[78:79], v205 offset:53248
    v_mfma_f32_16x16x32_bf16 a[92:95], v[44:47], a[232:235], a[92:95]
    buffer_load_dwordx4 a[212:215], v245, s[48:51], s68 offen offset:0 sc1
    v_mfma_f32_16x16x32_bf16 a[96:99], v[16:19], a[236:239], a[96:99]
    v_mfma_f32_16x16x32_bf16 a[100:103], v[20:23], a[236:239], a[100:103]
    v_mfma_f32_16x16x32_bf16 a[104:107], v[24:27], a[236:239], a[104:107]
    v_mfma_f32_16x16x32_bf16 a[108:111], v[28:31], a[236:239], a[108:111]
    buffer_load_dwordx4 a[216:219], v246, s[48:51], s68 offen offset:0 sc1
    v_mfma_f32_16x16x32_bf16 a[112:115], v[32:35], a[236:239], a[112:115]
    v_mfma_f32_16x16x32_bf16 a[116:119], v[36:39], a[236:239], a[116:119]
    v_mfma_f32_16x16x32_bf16 a[120:123], v[40:43], a[236:239], a[120:123]
    buffer_load_dwordx4 a[220:223], v247, s[48:51], s68 offen offset:0 sc1
    s_add_u32 s68, s68, 4096
    v_mfma_f32_16x16x32_bf16 a[124:127], v[44:47], a[236:239], a[124:127]
    s_waitcnt vmcnt(44) lgkmcnt(0)
    v_mfma_f32_16x16x32_bf16 v[112:115], v[48:51], v[224:227], v[112:115]
    v_mfma_f32_16x16x32_bf16 v[116:119], v[52:55], v[224:227], v[116:119]
    s_barrier
    v_mfma_f32_16x16x32_bf16 v[120:123], v[56:59], v[224:227], v[120:123]
    ds_read_b64_tr_b16 v[16:17], v190 offset:0
    s_add_u32 m0, s70, 98304
    v_mfma_f32_16x16x32_bf16 v[124:127], v[60:63], v[224:227], v[124:127]
    buffer_load_dwordx4 v182, s[52:55], s69 offen offset:0 lds
    v_mfma_f32_16x16x32_bf16 v[128:131], v[64:67], v[224:227], v[128:131]
    ds_read_b64_tr_b16 v[18:19], v190 offset:4096
    v_mfma_f32_16x16x32_bf16 v[132:135], v[68:71], v[224:227], v[132:135]
    ds_read_b64_tr_b16 v[20:21], v191 offset:0
    v_mfma_f32_16x16x32_bf16 v[136:139], v[72:75], v[224:227], v[136:139]
    ds_read_b64_tr_b16 v[22:23], v191 offset:4096
    v_mfma_f32_16x16x32_bf16 v[140:143], v[76:79], v[224:227], v[140:143]
    buffer_load_dwordx4 v183, s[52:55], s69 offen offset:1024 lds
    v_mfma_f32_16x16x32_bf16 v[144:147], v[48:51], v[228:231], v[144:147]
    ds_read_b64_tr_b16 v[24:25], v192 offset:0
    v_mfma_f32_16x16x32_bf16 v[148:151], v[52:55], v[228:231], v[148:151]
    ds_read_b64_tr_b16 v[26:27], v192 offset:4096
    v_mfma_f32_16x16x32_bf16 v[152:155], v[56:59], v[228:231], v[152:155]
    ds_read_b64_tr_b16 v[28:29], v193 offset:0
    v_mfma_f32_16x16x32_bf16 v[156:159], v[60:63], v[228:231], v[156:159]
    buffer_load_dwordx4 v184, s[52:55], s69 offen offset:2048 lds
    v_mfma_f32_16x16x32_bf16 v[160:163], v[64:67], v[228:231], v[160:163]
    ds_read_b64_tr_b16 v[30:31], v193 offset:4096
    v_mfma_f32_16x16x32_bf16 v[164:167], v[68:71], v[228:231], v[164:167]
    ds_read_b64_tr_b16 v[32:33], v194 offset:0
    v_mfma_f32_16x16x32_bf16 v[168:171], v[72:75], v[228:231], v[168:171]
    ds_read_b64_tr_b16 v[34:35], v194 offset:4096
    v_mfma_f32_16x16x32_bf16 v[172:175], v[76:79], v[228:231], v[172:175]
    buffer_load_dwordx4 v185, s[52:55], s69 offen offset:3072 lds
    s_add_u32 s69, s69, 131072
    v_mfma_f32_16x16x32_bf16 a[64:67], v[48:51], v[232:235], a[64:67]
    ds_read_b64_tr_b16 v[36:37], v195 offset:0
    v_mfma_f32_16x16x32_bf16 a[68:71], v[52:55], v[232:235], a[68:71]
    ds_read_b64_tr_b16 v[38:39], v195 offset:4096
    v_mfma_f32_16x16x32_bf16 a[72:75], v[56:59], v[232:235], a[72:75]
    ds_read_b64_tr_b16 v[40:41], v196 offset:0
    v_mfma_f32_16x16x32_bf16 a[76:79], v[60:63], v[232:235], a[76:79]
    buffer_load_dwordx4 a[224:227], v244, s[48:51], s68 offen offset:0 sc1
    v_mfma_f32_16x16x32_bf16 a[80:83], v[64:67], v[232:235], a[80:83]
    ds_read_b64_tr_b16 v[42:43], v196 offset:4096
    v_mfma_f32_16x16x32_bf16 a[84:87], v[68:71], v[232:235], a[84:87]
    ds_read_b64_tr_b16 v[44:45], v197 offset:0
    v_mfma_f32_16x16x32_bf16 a[88:91], v[72:75], v[232:235], a[88:91]
    ds_read_b64_tr_b16 v[46:47], v197 offset:4096
    v_mfma_f32_16x16x32_bf16 a[92:95], v[76:79], v[232:235], a[92:95]
    buffer_load_dwordx4 a[228:231], v245, s[48:51], s68 offen offset:0 sc1
    v_mfma_f32_16x16x32_bf16 a[96:99], v[48:51], v[236:239], a[96:99]
    v_mfma_f32_16x16x32_bf16 a[100:103], v[52:55], v[236:239], a[100:103]
    v_mfma_f32_16x16x32_bf16 a[104:107], v[56:59], v[236:239], a[104:107]
    v_mfma_f32_16x16x32_bf16 a[108:111], v[60:63], v[236:239], a[108:111]
    buffer_load_dwordx4 a[232:235], v246, s[48:51], s68 offen offset:0 sc1
    v_mfma_f32_16x16x32_bf16 a[112:115], v[64:67], v[236:239], a[112:115]
    v_mfma_f32_16x16x32_bf16 a[116:119], v[68:71], v[236:239], a[116:119]
    v_mfma_f32_16x16x32_bf16 a[120:123], v[72:75], v[236:239], a[120:123]
    buffer_load_dwordx4 a[236:239], v247, s[48:51], s68 offen offset:0 sc1
    s_add_u32 s68, s68, 4096
    v_mfma_f32_16x16x32_bf16 a[124:127], v[76:79], v[236:239], a[124:127]
    s_add_u32 s72, s72, 1
    s_cmp_lt_u32 s72, 3
    s_cbranch_scc1 L_g2_loop
L_code_d:
    v_mov_b32 v211, 0
    s_waitcnt vmcnt(44) lgkmcnt(0)
    v_mfma_f32_16x16x32_bf16 v[112:115], v[16:19], a[128:131], v[112:115]
    v_mfma_f32_16x16x32_bf16 v[116:119], v[20:23], a[128:131], v[116:119]
    s_barrier
    v_mfma_f32_16x16x32_bf16 v[120:123], v[24:27], a[128:131], v[120:123]
    ds_read_b64_tr_b16 v[48:49], v190 offset:16384
    s_add_u32 m0, s70, 114688
    v_mfma_f32_16x16x32_bf16 v[124:127], v[28:31], a[128:131], v[124:127]
    buffer_load_dwordx4 v182, s[52:55], s69 offen offset:0 lds
    v_mfma_f32_16x16x32_bf16 v[128:131], v[32:35], a[128:131], v[128:131]
    ds_read_b64_tr_b16 v[50:51], v190 offset:20480
    v_mfma_f32_16x16x32_bf16 v[132:135], v[36:39], a[128:131], v[132:135]
    ds_read_b64_tr_b16 v[52:53], v191 offset:16384
    v_mfma_f32_16x16x32_bf16 v[136:139], v[40:43], a[128:131], v[136:139]
    ds_read_b64_tr_b16 v[54:55], v191 offset:20480
    v_mfma_f32_16x16x32_bf16 v[140:143], v[44:47], a[128:131], v[140:143]
    buffer_load_dwordx4 v183, s[52:55], s69 offen offset:1024 lds
    v_mfma_f32_16x16x32_bf16 v[144:147], v[16:19], a[132:135], v[144:147]
    ds_read_b64_tr_b16 v[56:57], v192 offset:16384
    v_mfma_f32_16x16x32_bf16 v[148:151], v[20:23], a[132:135], v[148:151]
    ds_read_b64_tr_b16 v[58:59], v192 offset:20480
    v_mfma_f32_16x16x32_bf16 v[152:155], v[24:27], a[132:135], v[152:155]
    ds_read_b64_tr_b16 v[60:61], v193 offset:16384
    v_mfma_f32_16x16x32_bf16 v[156:159], v[28:31], a[132:135], v[156:159]
    buffer_load_dwordx4 v184, s[52:55], s69 offen offset:2048 lds
    v_mfma_f32_16x16x32_bf16 v[160:163], v[32:35], a[132:135], v[160:163]
    ds_read_b64_tr_b16 v[62:63], v193 offset:20480
    v_mfma_f32_16x16x32_bf16 v[164:167], v[36:39], a[132:135], v[164:167]
    ds_read_b64_tr_b16 v[64:65], v194 offset:16384
    v_mfma_f32_16x16x32_bf16 v[168:171], v[40:43], a[132:135], v[168:171]
    ds_read_b64_tr_b16 v[66:67], v194 offset:20480
    v_mfma_f32_16x16x32_bf16 v[172:175], v[44:47], a[132:135], v[172:175]
    buffer_load_dwordx4 v185, s[52:55], s69 offen offset:3072 lds
    s_add_u32 s69, s69, 131072
    v_mfma_f32_16x16x32_bf16 a[64:67], v[16:19], a[136:139], a[64:67]
    ds_read_b64_tr_b16 v[68:69], v195 offset:16384
    v_mfma_f32_16x16x32_bf16 a[68:71], v[20:23], a[136:139], a[68:71]
    ds_read_b64_tr_b16 v[70:71], v195 offset:20480
    v_mfma_f32_16x16x32_bf16 a[72:75], v[24:27], a[136:139], a[72:75]
    ds_read_b64_tr_b16 v[72:73], v196 offset:16384
    v_mfma_f32_16x16x32_bf16 a[76:79], v[28:31], a[136:139], a[76:79]
    buffer_load_dwordx4 v[224:227], v244, s[48:51], s68 offen offset:0 sc1
    v_mfma_f32_16x16x32_bf16 a[80:83], v[32:35], a[136:139], a[80:83]
    ds_read_b64_tr_b16 v[74:75], v196 offset:20480
    v_mfma_f32_16x16x32_bf16 a[84:87], v[36:39], a[136:139], a[84:87]
    ds_read_b64_tr_b16 v[76:77], v197 offset:16384
    v_mfma_f32_16x16x32_bf16 a[88:91], v[40:43], a[136:139], a[88:91]
    ds_read_b64_tr_b16 v[78:79], v197 offset:20480
    v_mfma_f32_16x16x32_bf16 a[92:95], v[44:47], a[136:139], a[92:95]
    buffer_load_dwordx4 v[228:231], v245, s[48:51], s68 offen offset:0 sc1
    v_mfma_f32_16x16x32_bf16 a[96:99], v[16:19], a[140:143], a[96:99]
    v_mfma_f32_16x16x32_bf16 a[100:103], v[20:23], a[140:143], a[100:103]
    v_mfma_f32_16x16x32_bf16 a[104:107], v[24:27], a[140:143], a[104:107]
    v_mfma_f32_16x16x32_bf16 a[108:111], v[28:31], a[140:143], a[108:111]
    buffer_load_dwordx4 v[232:235], v246, s[48:51], s68 offen offset:0 sc1
    v_mfma_f32_16x16x32_bf16 a[112:115], v[32:35], a[140:143], a[112:115]
    v_mfma_f32_16x16x32_bf16 a[116:119], v[36:39], a[140:143], a[116:119]
    v_mfma_f32_16x16x32_bf16 a[120:123], v[40:43], a[140:143], a[120:123]
    buffer_load_dwordx4 v[236:239], v247, s[48:51], s68 offen offset:0 sc1
    s_add_u32 s68, s68, 4096
    v_mfma_f32_16x16x32_bf16 a[124:127], v[44:47], a[140:143], a[124:127]
    s_waitcnt vmcnt(44) lgkmcnt(0)
    v_mfma_f32_16x16x32_bf16 v[112:115], v[48:51], a[144:147], v[112:115]
    v_mfma_f32_16x16x32_bf16 v[116:119], v[52:55], a[144:147], v[116:119]
    s_barrier
    v_mfma_f32_16x16x32_bf16 v[120:123], v[56:59], a[144:147], v[120:123]
    ds_read_b64_tr_b16 v[16:17], v190 offset:32768
    s_add_u32 m0, s70, 0
    v_mfma_f32_16x16x32_bf16 v[124:127], v[60:63], a[144:147], v[124:127]
    buffer_load_dwordx4 v182, s[52:55], s69 offen offset:0 lds
    v_mfma_f32_16x16x32_bf16 v[128:131], v[64:67], a[144:147], v[128:131]
    ds_read_b64_tr_b16 v[18:19], v190 offset:36864
    v_mfma_f32_16x16x32_bf16 v[132:135], v[68:71], a[144:147], v[132:135]
    ds_read_b64_tr_b16 v[20:21], v191 offset:32768
    v_mfma_f32_16x16x32_bf16 v[136:139], v[72:75], a[144:147], v[136:139]
    ds_read_b64_tr_b16 v[22:23], v191 offset:36864
    v_mfma_f32_16x16x32_bf16 v[140:143], v[76:79], a[144:147], v[140:143]
    buffer_load_dwordx4 v183, s[52:55], s69 offen offset:1024 lds
    v_mfma_f32_16x16x32_bf16 v[144:147], v[48:51], a[148:151], v[144:147]
    ds_read_b64_tr_b16 v[24:25], v192 offset:32768
    v_mfma_f32_16x16x32_bf16 v[148:151], v[52:55], a[148:151], v[148:151]
    ds_read_b64_tr_b16 v[26:27], v192 offset:36864
    v_mfma_f32_16x16x32_bf16 v[152:155], v[56:59], a[148:151], v[152:155]
    ds_read_b64_tr_b16 v[28:29], v193 offset:32768
    v_mfma_f32_16x16x32_bf16 v[156:159], v[60:63], a[148:151], v[156:159]
    buffer_load_dwordx4 v184, s[52:55], s69 offen offset:2048 lds
    v_mfma_f32_16x16x32_bf16 v[160:163], v[64:67], a[148:151], v[160:163]
    ds_read_b64_tr_b16 v[30:31], v193 offset:36864
    v_mfma_f32_16x16x32_bf16 v[164:167], v[68:71], a[148:151], v[164:167]
    ds_read_b64_tr_b16 v[32:33], v194 offset:32768
    v_mfma_f32_16x16x32_bf16 v[168:171], v[72:75], a[148:151], v[168:171]
    ds_read_b64_tr_b16 v[34:35], v194 offset:36864
    v_mfma_f32_16x16x32_bf16 v[172:175], v[76:79], a[148:151], v[172:175]
    buffer_load_dwordx4 v185, s[52:55], s69 offen offset:3072 lds
    s_add_u32 s69, s69, 131072
    v_mfma_f32_16x16x32_bf16 a[64:67], v[48:51], a[152:155], a[64:67]
    ds_read_b64_tr_b16 v[36:37], v195 offset:32768
    v_mfma_f32_16x16x32_bf16 a[68:71], v[52:55], a[152:155], a[68:71]
    ds_read_b64_tr_b16 v[38:39], v195 offset:36864
    v_mfma_f32_16x16x32_bf16 a[72:75], v[56:59], a[152:155], a[72:75]
    ds_read_b64_tr_b16 v[40:41], v196 offset:32768
    v_mfma_f32_16x16x32_bf16 a[76:79], v[60:63], a[152:155], a[76:79]
    buffer_load_dwordx4 a[128:131], v244, s[48:51], s68 offen offset:0 sc1
    v_mfma_f32_16x16x32_bf16 a[80:83], v[64:67], a[152:155], a[80:83]
    ds_read_b64_tr_b16 v[42:43], v196 offset:36864
    v_mfma_f32_16x16x32_bf16 a[84:87], v[68:71], a[152:155], a[84:87]
    ds_read_b64_tr_b16 v[44:45], v197 offset:32768
    v_mfma_f32_16x16x32_bf16 a[88:91], v[72:75], a[152:155], a[88:91]
    ds_read_b64_tr_b16 v[46:47], v197 offset:36864
    v_mfma_f32_16x16x32_bf16 a[92:95], v[76:79], a[152:155], a[92:95]
    buffer_load_dwordx4 a[132:135], v245, s[48:51], s68 offen offset:0 sc1
    v_mfma_f32_16x16x32_bf16 a[96:99], v[48:51], a[156:159], a[96:99]
    v_mfma_f32_16x16x32_bf16 a[100:103], v[52:55], a[156:159], a[100:103]
    v_mfma_f32_16x16x32_bf16 a[104:107], v[56:59], a[156:159], a[104:107]
    v_mfma_f32_16x16x32_bf16 a[108:111], v[60:63], a[156:159], a[108:111]
    buffer_load_dwordx4 a[136:139], v246, s[48:51], s68 offen offset:0 sc1
    v_mfma_f32_16x16x32_bf16 a[112:115], v[64:67], a[156:159], a[112:115]
    v_mfma_f32_16x16x32_bf16 a[116:119], v[68:71], a[156:159], a[116:119]
    v_mfma_f32_16x16x32_bf16 a[120:123], v[72:75], a[156:159], a[120:123]
    buffer_load_dwordx4 a[140:143], v247, s[48:51], s68 offen offset:0 sc1
    s_add_u32 s68, s68, 4096
    v_mfma_f32_16x16x32_bf16 a[124:127], v[76:79], a[156:159], a[124:127]
    s_waitcnt vmcnt(44) lgkmcnt(0)
    v_mfma_f32_16x16x32_bf16 v[112:115], v[16:19], a[160:163], v[112:115]
    v_mfma_f32_16x16x32_bf16 v[116:119], v[20:23], a[160:163], v[116:119]
    s_barrier
    v_mfma_f32_16x16x32_bf16 v[120:123], v[24:27], a[160:163], v[120:123]
    ds_read_b64_tr_b16 v[48:49], v190 offset:49152
    s_add_u32 m0, s70, 16384
    v_mfma_f32_16x16x32_bf16 v[124:127], v[28:31], a[160:163], v[124:127]
    buffer_load_dwordx4 v182, s[52:55], s69 offen offset:0 lds
    v_mfma_f32_16x16x32_bf16 v[128:131], v[32:35], a[160:163], v[128:131]
    ds_read_b64_tr_b16 v[50:51], v190 offset:53248
    v_mfma_f32_16x16x32_bf16 v[132:135], v[36:39], a[160:163], v[132:135]
    ds_read_b64_tr_b16 v[52:53], v191 offset:49152
    v_mfma_f32_16x16x32_bf16 v[136:139], v[40:43], a[160:163], v[136:139]
    ds_read_b64_tr_b16 v[54:55], v191 offset:53248
    v_mfma_f32_16x16x32_bf16 v[140:143], v[44:47], a[160:163], v[140:143]
    buffer_load_dwordx4 v183, s[52:55], s69 offen offset:1024 lds
    v_mfma_f32_16x16x32_bf16 v[144:147], v[16:19], a[164:167], v[144:147]
    ds_read_b64_tr_b16 v[56:57], v192 offset:49152
    v_mfma_f32_16x16x32_bf16 v[148:151], v[20:23], a[164:167], v[148:151]
    ds_read_b64_tr_b16 v[58:59], v192 offset:53248
    v_mfma_f32_16x16x32_bf16 v[152:155], v[24:27], a[164:167], v[152:155]
    ds_read_b64_tr_b16 v[60:61], v193 offset:49152
    v_mfma_f32_16x16x32_bf16 v[156:159], v[28:31], a[164:167], v[156:159]
    buffer_load_dwordx4 v184, s[52:55], s69 offen offset:2048 lds
    v_mfma_f32_16x16x32_bf16 v[160:163], v[32:35], a[164:167], v[160:163]
    ds_read_b64_tr_b16 v[62:63], v193 offset:53248
    v_mfma_f32_16x16x32_bf16 v[164:167], v[36:39], a[164:167], v[164:167]
    ds_read_b64_tr_b16 v[64:65], v194 offset:49152
    v_mfma_f32_16x16x32_bf16 v[168:171], v[40:43], a[164:167], v[168:171]
    ds_read_b64_tr_b16 v[66:67], v194 offset:53248
    v_mfma_f32_16x16x32_bf16 v[172:175], v[44:47], a[164:167], v[172:175]
    buffer_load_dwordx4 v185, s[52:55], s69 offen offset:3072 lds
    s_add_u32 s69, s69, 131072
    v_mfma_f32_16x16x32_bf16 a[64:67], v[16:19], a[168:171], a[64:67]
    ds_read_b64_tr_b16 v[68:69], v195 offset:49152
    v_mfma_f32_16x16x32_bf16 a[68:71], v[20:23], a[168:171], a[68:71]
    ds_read_b64_tr_b16 v[70:71], v195 offset:53248
    v_mfma_f32_16x16x32_bf16 a[72:75], v[24:27], a[168:171], a[72:75]
    ds_read_b64_tr_b16 v[72:73], v196 offset:49152
    v_mfma_f32_16x16x32_bf16 a[76:79], v[28:31], a[168:171], a[76:79]
    buffer_load_dwordx4 a[144:147], v244, s[48:51], s68 offen offset:0 sc1
    v_mfma_f32_16x16x32_bf16 a[80:83], v[32:35], a[168:171], a[80:83]
    ds_read_b64_tr_b16 v[74:75], v196 offset:53248
    v_mfma_f32_16x16x32_bf16 a[84:87], v[36:39], a[168:171], a[84:87]
    ds_read_b64_tr_b16 v[76:77], v197 offset:49152
    v_mfma_f32_16x16x32_bf16 a[88:91], v[40:43], a[168:171], a[88:91]
    ds_read_b64_tr_b16 v[78:79], v197 offset:53248
    v_mfma_f32_16x16x32_bf16 a[92:95], v[44:47], a[168:171], a[92:95]
    buffer_load_dwordx4 a[148:151], v245, s[48:51], s68 offen offset:0 sc1
    v_mfma_f32_16x16x32_bf16 a[96:99], v[16:19], a[172:175], a[96:99]
    v_mfma_f32_16x16x32_bf16 a[100:103], v[20:23], a[172:175], a[100:103]
    v_mfma_f32_16x16x32_bf16 a[104:107], v[24:27], a[172:175], a[104:107]
    v_mfma_f32_16x16x32_bf16 a[108:111], v[28:31], a[172:175], a[108:111]
    buffer_load_dwordx4 a[152:155], v246, s[48:51], s68 offen offset:0 sc1
    v_mfma_f32_16x16x32_bf16 a[112:115], v[32:35], a[172:175], a[112:115]
    v_mfma_f32_16x16x32_bf16 a[116:119], v[36:39], a[172:175], a[116:119]
    v_mfma_f32_16x16x32_bf16 a[120:123], v[40:43], a[172:175], a[120:123]
    buffer_load_dwordx4 a[156:159], v247, s[48:51], s68 offen offset:0 sc1
    s_add_u32 s68, s68, 4096
    v_mfma_f32_16x16x32_bf16 a[124:127], v[44:47], a[172:175], a[124:127]
    s_waitcnt vmcnt(44) lgkmcnt(0)
    v_mfma_f32_16x16x32_bf16 v[112:115], v[48:51], a[176:179], v[112:115]
    v_mfma_f32_16x16x32_bf16 v[116:119], v[52:55], a[176:179], v[116:119]
    s_barrier
    v_mfma_f32_16x16x32_bf16 v[120:123], v[56:59], a[176:179], v[120:123]
    ds_read_b64_tr_b16 v[16:17], v198 offset:0
    s_add_u32 m0, s70, 32768
    v_mfma_f32_16x16x32_bf16 v[124:127], v[60:63], a[176:179], v[124:127]
    buffer_load_dwordx4 v182, s[52:55], s69 offen offset:0 lds
    v_mfma_f32_16x16x32_bf16 v[128:131], v[64:67], a[176:179], v[128:131]
    ds_read_b64_tr_b16 v[18:19], v198 offset:4096
    v_mfma_f32_16x16x32_bf16 v[132:135], v[68:71], a[176:179], v[132:135]
    ds_read_b64_tr_b16 v[20:21], v199 offset:0
    v_mfma_f32_16x16x32_bf16 v[136:139], v[72:75], a[176:179], v[136:139]
    ds_read_b64_tr_b16 v[22:23], v199 offset:4096
    v_mfma_f32_16x16x32_bf16 v[140:143], v[76:79], a[176:179], v[140:143]
    buffer_load_dwordx4 v183, s[52:55], s69 offen offset:1024 lds
    v_mfma_f32_16x16x32_bf16 v[144:147], v[48:51], a[180:183], v[144:147]
    ds_read_b64_tr_b16 v[24:25], v200 offset:0
    v_mfma_f32_16x16x32_bf16 v[148:151], v[52:55], a[180:183], v[148:151]
    ds_read_b64_tr_b16 v[26:27], v200 offset:4096
    v_mfma_f32_16x16x32_bf16 v[152:155], v[56:59], a[180:183], v[152:155]
    ds_read_b64_tr_b16 v[28:29], v201 offset:0
    v_mfma_f32_16x16x32_bf16 v[156:159], v[60:63], a[180:183], v[156:159]
    buffer_load_dwordx4 v184, s[52:55], s69 offen offset:2048 lds
    v_mfma_f32_16x16x32_bf16 v[160:163], v[64:67], a[180:183], v[160:163]
    ds_read_b64_tr_b16 v[30:31], v201 offset:4096
    v_mfma_f32_16x16x32_bf16 v[164:167], v[68:71], a[180:183], v[164:167]
    ds_read_b64_tr_b16 v[32:33], v202 offset:0
    v_mfma_f32_16x16x32_bf16 v[168:171], v[72:75], a[180:183], v[168:171]
    ds_read_b64_tr_b16 v[34:35], v202 offset:4096
    v_mfma_f32_16x16x32_bf16 v[172:175], v[76:79], a[180:183], v[172:175]
    buffer_load_dwordx4 v185, s[52:55], s69 offen offset:3072 lds
    s_add_u32 s69, s69, 131072
    v_mfma_f32_16x16x32_bf16 a[64:67], v[48:51], a[184:187], a[64:67]
    ds_read_b64_tr_b16 v[36:37], v203 offset:0
    v_mfma_f32_16x16x32_bf16 a[68:71], v[52:55], a[184:187], a[68:71]
    ds_read_b64_tr_b16 v[38:39], v203 offset:4096
    v_mfma_f32_16x16x32_bf16 a[72:75], v[56:59], a[184:187], a[72:75]
    ds_read_b64_tr_b16 v[40:41], v204 offset:0
    v_mfma_f32_16x16x32_bf16 a[76:79], v[60:63], a[184:187], a[76:79]
    buffer_load_dwordx4 a[160:163], v244, s[48:51], s68 offen offset:0 sc1
    v_mfma_f32_16x16x32_bf16 a[80:83], v[64:67], a[184:187], a[80:83]
    ds_read_b64_tr_b16 v[42:43], v204 offset:4096
    v_mfma_f32_16x16x32_bf16 a[84:87], v[68:71], a[184:187], a[84:87]
    ds_read_b64_tr_b16 v[44:45], v205 offset:0
    v_mfma_f32_16x16x32_bf16 a[88:91], v[72:75], a[184:187], a[88:91]
    ds_read_b64_tr_b16 v[46:47], v205 offset:4096
    v_mfma_f32_16x16x32_bf16 a[92:95], v[76:79], a[184:187], a[92:95]
    buffer_load_dwordx4 a[164:167], v245, s[48:51], s68 offen offset:0 sc1
    v_mfma_f32_16x16x32_bf16 a[96:99], v[48:51], a[188:191], a[96:99]
    v_mfma_f32_16x16x32_bf16 a[100:103], v[52:55], a[188:191], a[100:103]
    v_mfma_f32_16x16x32_bf16 a[104:107], v[56:59], a[188:191], a[104:107]
    v_mfma_f32_16x16x32_bf16 a[108:111], v[60:63], a[188:191], a[108:111]
    buffer_load_dwordx4 a[168:171], v246, s[48:51], s68 offen offset:0 sc1
    v_mfma_f32_16x16x32_bf16 a[112:115], v[64:67], a[188:191], a[112:115]
    v_mfma_f32_16x16x32_bf16 a[116:119], v[68:71], a[188:191], a[116:119]
    v_mfma_f32_16x16x32_bf16 a[120:123], v[72:75], a[188:191], a[120:123]
    buffer_load_dwordx4 a[172:175], v247, s[48:51], s68 offen offset:0 sc1
    s_add_u32 s68, s68, 4096
    v_mfma_f32_16x16x32_bf16 a[124:127], v[76:79], a[188:191], a[124:127]
    s_waitcnt vmcnt(44) lgkmcnt(0)
    v_mfma_f32_16x16x32_bf16 v[112:115], v[16:19], a[192:195], v[112:115]
    v_mfma_f32_16x16x32_bf16 v[116:119], v[20:23], a[192:195], v[116:119]
    s_barrier
    v_mfma_f32_16x16x32_bf16 v[120:123], v[24:27], a[192:195], v[120:123]
    ds_read_b64_tr_b16 v[48:49], v198 offset:16384
    s_add_u32 m0, s70, 49152
    v_mfma_f32_16x16x32_bf16 v[124:127], v[28:31], a[192:195], v[124:127]
    buffer_load_dwordx4 v182, s[52:55], s69 offen offset:0 lds
    v_mfma_f32_16x16x32_bf16 v[128:131], v[32:35], a[192:195], v[128:131]
    ds_read_b64_tr_b16 v[50:51], v198 offset:20480
    v_mfma_f32_16x16x32_bf16 v[132:135], v[36:39], a[192:195], v[132:135]
    ds_read_b64_tr_b16 v[52:53], v199 offset:16384
    v_mfma_f32_16x16x32_bf16 v[136:139], v[40:43], a[192:195], v[136:139]
    ds_read_b64_tr_b16 v[54:55], v199 offset:20480
    v_mfma_f32_16x16x32_bf16 v[140:143], v[44:47], a[192:195], v[140:143]
    buffer_load_dwordx4 v183, s[52:55], s69 offen offset:1024 lds
    v_mfma_f32_16x16x32_bf16 v[144:147], v[16:19], a[196:199], v[144:147]
    ds_read_b64_tr_b16 v[56:57], v200 offset:16384
    v_mfma_f32_16x16x32_bf16 v[148:151], v[20:23], a[196:199], v[148:151]
    ds_read_b64_tr_b16 v[58:59], v200 offset:20480
    v_mfma_f32_16x16x32_bf16 v[152:155], v[24:27], a[196:199], v[152:155]
    ds_read_b64_tr_b16 v[60:61], v201 offset:16384
    v_mfma_f32_16x16x32_bf16 v[156:159], v[28:31], a[196:199], v[156:159]
    buffer_load_dwordx4 v184, s[52:55], s69 offen offset:2048 lds
    v_mfma_f32_16x16x32_bf16 v[160:163], v[32:35], a[196:199], v[160:163]
    ds_read_b64_tr_b16 v[62:63], v201 offset:20480
    v_mfma_f32_16x16x32_bf16 v[164:167], v[36:39], a[196:199], v[164:167]
    ds_read_b64_tr_b16 v[64:65], v202 offset:16384
    v_mfma_f32_16x16x32_bf16 v[168:171], v[40:43], a[196:199], v[168:171]
    ds_read_b64_tr_b16 v[66:67], v202 offset:20480
    v_mfma_f32_16x16x32_bf16 v[172:175], v[44:47], a[196:199], v[172:175]
    buffer_load_dwordx4 v185, s[52:55], s69 offen offset:3072 lds
    s_add_u32 s69, s69, 131072
    v_mfma_f32_16x16x32_bf16 a[64:67], v[16:19], a[200:203], a[64:67]
    ds_read_b64_tr_b16 v[68:69], v203 offset:16384
    v_mfma_f32_16x16x32_bf16 a[68:71], v[20:23], a[200:203], a[68:71]
    ds_read_b64_tr_b16 v[70:71], v203 offset:20480
    v_mfma_f32_16x16x32_bf16 a[72:75], v[24:27], a[200:203], a[72:75]
    ds_read_b64_tr_b16 v[72:73], v204 offset:16384
    v_mfma_f32_16x16x32_bf16 a[76:79], v[28:31], a[200:203], a[76:79]
    buffer_load_dwordx4 a[176:179], v244, s[48:51], s68 offen offset:0 sc1
    v_mfma_f32_16x16x32_bf16 a[80:83], v[32:35], a[200:203], a[80:83]
    ds_read_b64_tr_b16 v[74:75], v204 offset:20480
    v_mfma_f32_16x16x32_bf16 a[84:87], v[36:39], a[200:203], a[84:87]
    ds_read_b64_tr_b16 v[76:77], v205 offset:16384
    v_mfma_f32_16x16x32_bf16 a[88:91], v[40:43], a[200:203], a[88:91]
    ds_read_b64_tr_b16 v[78:79], v205 offset:20480
    v_mfma_f32_16x16x32_bf16 a[92:95], v[44:47], a[200:203], a[92:95]
    buffer_load_dwordx4 a[180:183], v245, s[48:51], s68 offen offset:0 sc1
    v_mfma_f32_16x16x32_bf16 a[96:99], v[16:19], a[204:207], a[96:99]
    v_mfma_f32_16x16x32_bf16 a[100:103], v[20:23], a[204:207], a[100:103]
    v_mfma_f32_16x16x32_bf16 a[104:107], v[24:27], a[204:207], a[104:107]
    v_mfma_f32_16x16x32_bf16 a[108:111], v[28:31], a[204:207], a[108:111]
    buffer_load_dwordx4 a[184:187], v246, s[48:51], s68 offen offset:0 sc1
    v_mfma_f32_16x16x32_bf16 a[112:115], v[32:35], a[204:207], a[112:115]
    v_mfma_f32_16x16x32_bf16 a[116:119], v[36:39], a[204:207], a[116:119]
    v_mfma_f32_16x16x32_bf16 a[120:123], v[40:43], a[204:207], a[120:123]
    buffer_load_dwordx4 a[188:191], v247, s[48:51], s68 offen offset:0 sc1
    s_add_u32 s68, s68, 4096
    v_mfma_f32_16x16x32_bf16 a[124:127], v[44:47], a[204:207], a[124:127]
    s_waitcnt vmcnt(44) lgkmcnt(0)
    v_mfma_f32_16x16x32_bf16 v[112:115], v[48:51], a[208:211], v[112:115]
    v_mfma_f32_16x16x32_bf16 v[116:119], v[52:55], a[208:211], v[116:119]
    s_barrier
    v_mfma_f32_16x16x32_bf16 v[120:123], v[56:59], a[208:211], v[120:123]
    ds_read_b64_tr_b16 v[16:17], v198 offset:32768
    v_mfma_f32_16x16x32_bf16 v[124:127], v[60:63], a[208:211], v[124:127]
    buffer_load_dwordx4 v[80:83], v206, s[56:59], 0 offen offset:0
    v_mfma_f32_16x16x32_bf16 v[128:131], v[64:67], a[208:211], v[128:131]
    ds_read_b64_tr_b16 v[18:19], v198 offset:36864
    v_mfma_f32_16x16x32_bf16 v[132:135], v[68:71], a[208:211], v[132:135]
    ds_read_b64_tr_b16 v[20:21], v199 offset:32768
    v_mfma_f32_16x16x32_bf16 v[136:139], v[72:75], a[208:211], v[136:139]
    ds_read_b64_tr_b16 v[22:23], v199 offset:36864
    v_mfma_f32_16x16x32_bf16 v[140:143], v[76:79], a[208:211], v[140:143]
    buffer_load_dwordx4 v[84:87], v206, s[56:59], 0 offen offset:64
    v_mfma_f32_16x16x32_bf16 v[144:147], v[48:51], a[212:215], v[144:147]
    ds_read_b64_tr_b16 v[24:25], v200 offset:32768
    v_mfma_f32_16x16x32_bf16 v[148:151], v[52:55], a[212:215], v[148:151]
    ds_read_b64_tr_b16 v[26:27], v200 offset:36864
    v_mfma_f32_16x16x32_bf16 v[152:155], v[56:59], a[212:215], v[152:155]
    ds_read_b64_tr_b16 v[28:29], v201 offset:32768
    v_mfma_f32_16x16x32_bf16 v[156:159], v[60:63], a[212:215], v[156:159]
    buffer_load_dwordx4 v[88:91], v206, s[56:59], 0 offen offset:128
    v_mfma_f32_16x16x32_bf16 v[160:163], v[64:67], a[212:215], v[160:163]
    ds_read_b64_tr_b16 v[30:31], v201 offset:36864
    v_mfma_f32_16x16x32_bf16 v[164:167], v[68:71], a[212:215], v[164:167]
    ds_read_b64_tr_b16 v[32:33], v202 offset:32768
    v_mfma_f32_16x16x32_bf16 v[168:171], v[72:75], a[212:215], v[168:171]
    ds_read_b64_tr_b16 v[34:35], v202 offset:36864
    v_mfma_f32_16x16x32_bf16 v[172:175], v[76:79], a[212:215], v[172:175]
    buffer_load_dwordx4 v[92:95], v206, s[56:59], 0 offen offset:192
    v_mfma_f32_16x16x32_bf16 a[64:67], v[48:51], a[216:219], a[64:67]
    ds_read_b64_tr_b16 v[36:37], v203 offset:32768
    v_mfma_f32_16x16x32_bf16 a[68:71], v[52:55], a[216:219], a[68:71]
    ds_read_b64_tr_b16 v[38:39], v203 offset:36864
    v_mfma_f32_16x16x32_bf16 a[72:75], v[56:59], a[216:219], a[72:75]
    ds_read_b64_tr_b16 v[40:41], v204 offset:32768
    v_mfma_f32_16x16x32_bf16 a[76:79], v[60:63], a[216:219], a[76:79]
    buffer_load_dword v209, v211, s[24:27], s83 offen sc1
    v_mfma_f32_16x16x32_bf16 a[80:83], v[64:67], a[216:219], a[80:83]
    ds_read_b64_tr_b16 v[42:43], v204 offset:36864
    v_mfma_f32_16x16x32_bf16 a[84:87], v[68:71], a[216:219], a[84:87]
    ds_read_b64_tr_b16 v[44:45], v205 offset:32768
    v_mfma_f32_16x16x32_bf16 a[88:91], v[72:75], a[216:219], a[88:91]
    ds_read_b64_tr_b16 v[46:47], v205 offset:36864
    v_mfma_f32_16x16x32_bf16 a[92:95], v[76:79], a[216:219], a[92:95]
    v_mfma_f32_16x16x32_bf16 a[96:99], v[48:51], a[220:223], a[96:99]
    v_mfma_f32_16x16x32_bf16 a[100:103], v[52:55], a[220:223], a[100:103]
    v_mfma_f32_16x16x32_bf16 a[104:107], v[56:59], a[220:223], a[104:107]
    v_mfma_f32_16x16x32_bf16 a[108:111], v[60:63], a[220:223], a[108:111]
    v_mfma_f32_16x16x32_bf16 a[112:115], v[64:67], a[220:223], a[112:115]
    v_mfma_f32_16x16x32_bf16 a[116:119], v[68:71], a[220:223], a[116:119]
    v_mfma_f32_16x16x32_bf16 a[120:123], v[72:75], a[220:223], a[120:123]
    v_mfma_f32_16x16x32_bf16 a[124:127], v[76:79], a[220:223], a[124:127]
    s_add_u32 s72, s84, 4096
    s_waitcnt vmcnt(41) lgkmcnt(0)
    v_mfma_f32_16x16x32_bf16 v[112:115], v[16:19], a[224:227], v[112:115]
    v_mfma_f32_16x16x32_bf16 v[116:119], v[20:23], a[224:227], v[116:119]
    s_barrier
    v_mfma_f32_16x16x32_bf16 v[120:123], v[24:27], a[224:227], v[120:123]
    ds_read_b64_tr_b16 v[48:49], v198 offset:49152
    v_mfma_f32_16x16x32_bf16 v[124:127], v[28:31], a[224:227], v[124:127]
    buffer_load_dwordx4 v[240:243], v210, s[64:67], s84 offen offset:0 sc1
    v_mfma_f32_16x16x32_bf16 v[128:131], v[32:35], a[224:227], v[128:131]
    ds_read_b64_tr_b16 v[50:51], v198 offset:53248
    v_mfma_f32_16x16x32_bf16 v[132:135], v[36:39], a[224:227], v[132:135]
    ds_read_b64_tr_b16 v[52:53], v199 offset:49152
    v_mfma_f32_16x16x32_bf16 v[136:139], v[40:43], a[224:227], v[136:139]
    ds_read_b64_tr_b16 v[54:55], v199 offset:53248
    v_mfma_f32_16x16x32_bf16 v[140:143], v[44:47], a[224:227], v[140:143]
    buffer_load_dwordx4 v[240:243], v210, s[64:67], s84 offen offset:1024 sc1
    v_mfma_f32_16x16x32_bf16 v[144:147], v[16:19], a[228:231], v[144:147]
    ds_read_b64_tr_b16 v[56:57], v200 offset:49152
    v_mfma_f32_16x16x32_bf16 v[148:151], v[20:23], a[228:231], v[148:151]
    ds_read_b64_tr_b16 v[58:59], v200 offset:53248
    v_mfma_f32_16x16x32_bf16 v[152:155], v[24:27], a[228:231], v[152:155]
    ds_read_b64_tr_b16 v[60:61], v201 offset:49152
    v_mfma_f32_16x16x32_bf16 v[156:159], v[28:31], a[228:231], v[156:159]
    buffer_load_dwordx4 v[240:243], v210, s[64:67], s84 offen offset:2048 sc1
    v_mfma_f32_16x16x32_bf16 v[160:163], v[32:35], a[228:231], v[160:163]
    ds_read_b64_tr_b16 v[62:63], v201 offset:53248
    v_mfma_f32_16x16x32_bf16 v[164:167], v[36:39], a[228:231], v[164:167]
    ds_read_b64_tr_b16 v[64:65], v202 offset:49152
    v_mfma_f32_16x16x32_bf16 v[168:171], v[40:43], a[228:231], v[168:171]
    ds_read_b64_tr_b16 v[66:67], v202 offset:53248
    v_mfma_f32_16x16x32_bf16 v[172:175], v[44:47], a[228:231], v[172:175]
    buffer_load_dwordx4 v[240:243], v210, s[64:67], s84 offen offset:3072 sc1
    v_mfma_f32_16x16x32_bf16 a[64:67], v[16:19], a[232:235], a[64:67]
    ds_read_b64_tr_b16 v[68:69], v203 offset:49152
    v_mfma_f32_16x16x32_bf16 a[68:71], v[20:23], a[232:235], a[68:71]
    ds_read_b64_tr_b16 v[70:71], v203 offset:53248
    v_mfma_f32_16x16x32_bf16 a[72:75], v[24:27], a[232:235], a[72:75]
    ds_read_b64_tr_b16 v[72:73], v204 offset:49152
    v_mfma_f32_16x16x32_bf16 a[76:79], v[28:31], a[232:235], a[76:79]
    v_mfma_f32_16x16x32_bf16 a[80:83], v[32:35], a[232:235], a[80:83]
    ds_read_b64_tr_b16 v[74:75], v204 offset:53248
    v_mfma_f32_16x16x32_bf16 a[84:87], v[36:39], a[232:235], a[84:87]
    ds_read_b64_tr_b16 v[76:77], v205 offset:49152
    v_mfma_f32_16x16x32_bf16 a[88:91], v[40:43], a[232:235], a[88:91]
    ds_read_b64_tr_b16 v[78:79], v205 offset:53248
    v_mfma_f32_16x16x32_bf16 a[92:95], v[44:47], a[232:235], a[92:95]
    v_mfma_f32_16x16x32_bf16 a[96:99], v[16:19], a[236:239], a[96:99]
    v_mfma_f32_16x16x32_bf16 a[100:103], v[20:23], a[236:239], a[100:103]
    v_mfma_f32_16x16x32_bf16 a[104:107], v[24:27], a[236:239], a[104:107]
    v_mfma_f32_16x16x32_bf16 a[108:111], v[28:31], a[236:239], a[108:111]
    v_mfma_f32_16x16x32_bf16 a[112:115], v[32:35], a[236:239], a[112:115]
    v_mfma_f32_16x16x32_bf16 a[116:119], v[36:39], a[236:239], a[116:119]
    v_mfma_f32_16x16x32_bf16 a[120:123], v[40:43], a[236:239], a[120:123]
    v_mfma_f32_16x16x32_bf16 a[124:127], v[44:47], a[236:239], a[124:127]
    s_waitcnt vmcnt(37) lgkmcnt(0)
    v_mfma_f32_16x16x32_bf16 v[112:115], v[48:51], v[224:227], v[112:115]
    v_mfma_f32_16x16x32_bf16 v[116:119], v[52:55], v[224:227], v[116:119]
    s_barrier
    v_mfma_f32_16x16x32_bf16 v[120:123], v[56:59], v[224:227], v[120:123]
    ds_read_b64_tr_b16 v[16:17], v190 offset:0
    v_mfma_f32_16x16x32_bf16 v[124:127], v[60:63], v[224:227], v[124:127]
    v_mfma_f32_16x16x32_bf16 v[128:131], v[64:67], v[224:227], v[128:131]
    ds_read_b64_tr_b16 v[18:19], v190 offset:4096
    v_mfma_f32_16x16x32_bf16 v[132:135], v[68:71], v[224:227], v[132:135]
    ds_read_b64_tr_b16 v[20:21], v191 offset:0
    v_mfma_f32_16x16x32_bf16 v[136:139], v[72:75], v[224:227], v[136:139]
    ds_read_b64_tr_b16 v[22:23], v191 offset:4096
    v_mfma_f32_16x16x32_bf16 v[140:143], v[76:79], v[224:227], v[140:143]
    v_mfma_f32_16x16x32_bf16 v[144:147], v[48:51], v[228:231], v[144:147]
    ds_read_b64_tr_b16 v[24:25], v192 offset:0
    v_mfma_f32_16x16x32_bf16 v[148:151], v[52:55], v[228:231], v[148:151]
    ds_read_b64_tr_b16 v[26:27], v192 offset:4096
    v_mfma_f32_16x16x32_bf16 v[152:155], v[56:59], v[228:231], v[152:155]
    ds_read_b64_tr_b16 v[28:29], v193 offset:0
    v_mfma_f32_16x16x32_bf16 v[156:159], v[60:63], v[228:231], v[156:159]
    v_mfma_f32_16x16x32_bf16 v[160:163], v[64:67], v[228:231], v[160:163]
    ds_read_b64_tr_b16 v[30:31], v193 offset:4096
    v_mfma_f32_16x16x32_bf16 v[164:167], v[68:71], v[228:231], v[164:167]
    ds_read_b64_tr_b16 v[32:33], v194 offset:0
    v_mfma_f32_16x16x32_bf16 v[168:171], v[72:75], v[228:231], v[168:171]
    ds_read_b64_tr_b16 v[34:35], v194 offset:4096
    v_mfma_f32_16x16x32_bf16 v[172:175], v[76:79], v[228:231], v[172:175]
    v_mfma_f32_16x16x32_bf16 a[64:67], v[48:51], v[232:235], a[64:67]
    ds_read_b64_tr_b16 v[36:37], v195 offset:0
    v_mfma_f32_16x16x32_bf16 a[68:71], v[52:55], v[232:235], a[68:71]
    ds_read_b64_tr_b16 v[38:39], v195 offset:4096
    v_mfma_f32_16x16x32_bf16 a[72:75], v[56:59], v[232:235], a[72:75]
    ds_read_b64_tr_b16 v[40:41], v196 offset:0
    v_mfma_f32_16x16x32_bf16 a[76:79], v[60:63], v[232:235], a[76:79]
    v_mfma_f32_16x16x32_bf16 a[80:83], v[64:67], v[232:235], a[80:83]
    ds_read_b64_tr_b16 v[42:43], v196 offset:4096
    v_mfma_f32_16x16x32_bf16 a[84:87], v[68:71], v[232:235], a[84:87]
    ds_read_b64_tr_b16 v[44:45], v197 offset:0
    v_mfma_f32_16x16x32_bf16 a[88:91], v[72:75], v[232:235], a[88:91]
    ds_read_b64_tr_b16 v[46:47], v197 offset:4096
    v_mfma_f32_16x16x32_bf16 a[92:95], v[76:79], v[232:235], a[92:95]
    v_mfma_f32_16x16x32_bf16 a[96:99], v[48:51], v[236:239], a[96:99]
    v_mfma_f32_16x16x32_bf16 a[100:103], v[52:55], v[236:239], a[100:103]
    v_mfma_f32_16x16x32_bf16 a[104:107], v[56:59], v[236:239], a[104:107]
    v_mfma_f32_16x16x32_bf16 a[108:111], v[60:63], v[236:239], a[108:111]
    v_mfma_f32_16x16x32_bf16 a[112:115], v[64:67], v[236:239], a[112:115]
    v_mfma_f32_16x16x32_bf16 a[116:119], v[68:71], v[236:239], a[116:119]
    v_mfma_f32_16x16x32_bf16 a[120:123], v[72:75], v[236:239], a[120:123]
    v_mfma_f32_16x16x32_bf16 a[124:127], v[76:79], v[236:239], a[124:127]
    s_waitcnt vmcnt(29) lgkmcnt(0)
    v_mfma_f32_16x16x32_bf16 v[112:115], v[16:19], a[128:131], v[112:115]
    v_mfma_f32_16x16x32_bf16 v[116:119], v[20:23], a[128:131], v[116:119]
    s_barrier
    v_mfma_f32_16x16x32_bf16 v[120:123], v[24:27], a[128:131], v[120:123]
    ds_read_b64_tr_b16 v[48:49], v190 offset:16384
    v_mfma_f32_16x16x32_bf16 v[124:127], v[28:31], a[128:131], v[124:127]
    v_mfma_f32_16x16x32_bf16 v[128:131], v[32:35], a[128:131], v[128:131]
    ds_read_b64_tr_b16 v[50:51], v190 offset:20480
    v_mfma_f32_16x16x32_bf16 v[132:135], v[36:39], a[128:131], v[132:135]
    ds_read_b64_tr_b16 v[52:53], v191 offset:16384
    v_mfma_f32_16x16x32_bf16 v[136:139], v[40:43], a[128:131], v[136:139]
    ds_read_b64_tr_b16 v[54:55], v191 offset:20480
    v_mfma_f32_16x16x32_bf16 v[140:143], v[44:47], a[128:131], v[140:143]
    v_mfma_f32_16x16x32_bf16 v[144:147], v[16:19], a[132:135], v[144:147]
    ds_read_b64_tr_b16 v[56:57], v192 offset:16384
    v_mfma_f32_16x16x32_bf16 v[148:151], v[20:23], a[132:135], v[148:151]
    ds_read_b64_tr_b16 v[58:59], v192 offset:20480
    v_mfma_f32_16x16x32_bf16 v[152:155], v[24:27], a[132:135], v[152:155]
    ds_read_b64_tr_b16 v[60:61], v193 offset:16384
    v_mfma_f32_16x16x32_bf16 v[156:159], v[28:31], a[132:135], v[156:159]
    v_mfma_f32_16x16x32_bf16 v[160:163], v[32:35], a[132:135], v[160:163]
    ds_read_b64_tr_b16 v[62:63], v193 offset:20480
    v_mfma_f32_16x16x32_bf16 v[164:167], v[36:39], a[132:135], v[164:167]
    ds_read_b64_tr_b16 v[64:65], v194 offset:16384
    v_mfma_f32_16x16x32_bf16 v[168:171], v[40:43], a[132:135], v[168:171]
    ds_read_b64_tr_b16 v[66:67], v194 offset:20480
    v_mfma_f32_16x16x32_bf16 v[172:175], v[44:47], a[132:135], v[172:175]
    v_mfma_f32_16x16x32_bf16 a[64:67], v[16:19], a[136:139], a[64:67]
    ds_read_b64_tr_b16 v[68:69], v195 offset:16384
    v_mfma_f32_16x16x32_bf16 a[68:71], v[20:23], a[136:139], a[68:71]
    ds_read_b64_tr_b16 v[70:71], v195 offset:20480
    v_mfma_f32_16x16x32_bf16 a[72:75], v[24:27], a[136:139], a[72:75]
    ds_read_b64_tr_b16 v[72:73], v196 offset:16384
    v_mfma_f32_16x16x32_bf16 a[76:79], v[28:31], a[136:139], a[76:79]
    v_mfma_f32_16x16x32_bf16 a[80:83], v[32:35], a[136:139], a[80:83]
    ds_read_b64_tr_b16 v[74:75], v196 offset:20480
    v_mfma_f32_16x16x32_bf16 a[84:87], v[36:39], a[136:139], a[84:87]
    ds_read_b64_tr_b16 v[76:77], v197 offset:16384
    v_mfma_f32_16x16x32_bf16 a[88:91], v[40:43], a[136:139], a[88:91]
    ds_read_b64_tr_b16 v[78:79], v197 offset:20480
    v_mfma_f32_16x16x32_bf16 a[92:95], v[44:47], a[136:139], a[92:95]
    v_mfma_f32_16x16x32_bf16 a[96:99], v[16:19], a[140:143], a[96:99]
    v_mfma_f32_16x16x32_bf16 a[100:103], v[20:23], a[140:143], a[100:103]
    v_mfma_f32_16x16x32_bf16 a[104:107], v[24:27], a[140:143], a[104:107]
    v_mfma_f32_16x16x32_bf16 a[108:111], v[28:31], a[140:143], a[108:111]
    v_mfma_f32_16x16x32_bf16 a[112:115], v[32:35], a[140:143], a[112:115]
    v_mfma_f32_16x16x32_bf16 a[116:119], v[36:39], a[140:143], a[116:119]
    v_mfma_f32_16x16x32_bf16 a[120:123], v[40:43], a[140:143], a[120:123]
    v_mfma_f32_16x16x32_bf16 a[124:127], v[44:47], a[140:143], a[124:127]
    s_waitcnt vmcnt(21) lgkmcnt(0)
    v_mfma_f32_16x16x32_bf16 v[112:115], v[48:51], a[144:147], v[112:115]
    v_mfma_f32_16x16x32_bf16 v[116:119], v[52:55], a[144:147], v[116:119]
    s_barrier
    v_mfma_f32_16x16x32_bf16 v[120:123], v[56:59], a[144:147], v[120:123]
    ds_read_b64_tr_b16 v[16:17], v190 offset:32768
    v_mfma_f32_16x16x32_bf16 v[124:127], v[60:63], a[144:147], v[124:127]
    v_mfma_f32_16x16x32_bf16 v[128:131], v[64:67], a[144:147], v[128:131]
    ds_read_b64_tr_b16 v[18:19], v190 offset:36864
    v_mfma_f32_16x16x32_bf16 v[132:135], v[68:71], a[144:147], v[132:135]
    ds_read_b64_tr_b16 v[20:21], v191 offset:32768
    v_mfma_f32_16x16x32_bf16 v[136:139], v[72:75], a[144:147], v[136:139]
    ds_read_b64_tr_b16 v[22:23], v191 offset:36864
    v_mfma_f32_16x16x32_bf16 v[140:143], v[76:79], a[144:147], v[140:143]
    v_mfma_f32_16x16x32_bf16 v[144:147], v[48:51], a[148:151], v[144:147]
    ds_read_b64_tr_b16 v[24:25], v192 offset:32768
    v_mfma_f32_16x16x32_bf16 v[148:151], v[52:55], a[148:151], v[148:151]
    ds_read_b64_tr_b16 v[26:27], v192 offset:36864
    v_mfma_f32_16x16x32_bf16 v[152:155], v[56:59], a[148:151], v[152:155]
    ds_read_b64_tr_b16 v[28:29], v193 offset:32768
    v_mfma_f32_16x16x32_bf16 v[156:159], v[60:63], a[148:151], v[156:159]
    v_mfma_f32_16x16x32_bf16 v[160:163], v[64:67], a[148:151], v[160:163]
    ds_read_b64_tr_b16 v[30:31], v193 offset:36864
    v_mfma_f32_16x16x32_bf16 v[164:167], v[68:71], a[148:151], v[164:167]
    ds_read_b64_tr_b16 v[32:33], v194 offset:32768
    v_mfma_f32_16x16x32_bf16 v[168:171], v[72:75], a[148:151], v[168:171]
    ds_read_b64_tr_b16 v[34:35], v194 offset:36864
    v_mfma_f32_16x16x32_bf16 v[172:175], v[76:79], a[148:151], v[172:175]
    v_mfma_f32_16x16x32_bf16 a[64:67], v[48:51], a[152:155], a[64:67]
    ds_read_b64_tr_b16 v[36:37], v195 offset:32768
    v_mfma_f32_16x16x32_bf16 a[68:71], v[52:55], a[152:155], a[68:71]
    ds_read_b64_tr_b16 v[38:39], v195 offset:36864
    v_mfma_f32_16x16x32_bf16 a[72:75], v[56:59], a[152:155], a[72:75]
    ds_read_b64_tr_b16 v[40:41], v196 offset:32768
    v_mfma_f32_16x16x32_bf16 a[76:79], v[60:63], a[152:155], a[76:79]
    v_mfma_f32_16x16x32_bf16 a[80:83], v[64:67], a[152:155], a[80:83]
    ds_read_b64_tr_b16 v[42:43], v196 offset:36864
    v_mfma_f32_16x16x32_bf16 a[84:87], v[68:71], a[152:155], a[84:87]
    ds_read_b64_tr_b16 v[44:45], v197 offset:32768
    v_mfma_f32_16x16x32_bf16 a[88:91], v[72:75], a[152:155], a[88:91]
    ds_read_b64_tr_b16 v[46:47], v197 offset:36864
    v_mfma_f32_16x16x32_bf16 a[92:95], v[76:79], a[152:155], a[92:95]
    v_mfma_f32_16x16x32_bf16 a[96:99], v[48:51], a[156:159], a[96:99]
    v_mfma_f32_16x16x32_bf16 a[100:103], v[52:55], a[156:159], a[100:103]
    v_mfma_f32_16x16x32_bf16 a[104:107], v[56:59], a[156:159], a[104:107]
    v_mfma_f32_16x16x32_bf16 a[108:111], v[60:63], a[156:159], a[108:111]
    v_mfma_f32_16x16x32_bf16 a[112:115], v[64:67], a[156:159], a[112:115]
    v_mfma_f32_16x16x32_bf16 a[116:119], v[68:71], a[156:159], a[116:119]
    v_mfma_f32_16x16x32_bf16 a[120:123], v[72:75], a[156:159], a[120:123]
    v_mfma_f32_16x16x32_bf16 a[124:127], v[76:79], a[156:159], a[124:127]
    s_waitcnt vmcnt(13) lgkmcnt(0)
    v_mfma_f32_16x16x32_bf16 v[112:115], v[16:19], a[160:163], v[112:115]
    v_mfma_f32_16x16x32_bf16 v[116:119], v[20:23], a[160:163], v[116:119]
    s_barrier
    v_mfma_f32_16x16x32_bf16 v[120:123], v[24:27], a[160:163], v[120:123]
    ds_read_b64_tr_b16 v[48:49], v190 offset:49152
    v_mfma_f32_16x16x32_bf16 v[124:127], v[28:31], a[160:163], v[124:127]
    v_mfma_f32_16x16x32_bf16 v[128:131], v[32:35], a[160:163], v[128:131]
    ds_read_b64_tr_b16 v[50:51], v190 offset:53248
    v_mfma_f32_16x16x32_bf16 v[132:135], v[36:39], a[160:163], v[132:135]
    ds_read_b64_tr_b16 v[52:53], v191 offset:49152
    v_mfma_f32_16x16x32_bf16 v[136:139], v[40:43], a[160:163], v[136:139]
    ds_read_b64_tr_b16 v[54:55], v191 offset:53248
    v_mfma_f32_16x16x32_bf16 v[140:143], v[44:47], a[160:163], v[140:143]
    v_mfma_f32_16x16x32_bf16 v[144:147], v[16:19], a[164:167], v[144:147]
    ds_read_b64_tr_b16 v[56:57], v192 offset:49152
    v_mfma_f32_16x16x32_bf16 v[148:151], v[20:23], a[164:167], v[148:151]
    ds_read_b64_tr_b16 v[58:59], v192 offset:53248
    v_mfma_f32_16x16x32_bf16 v[152:155], v[24:27], a[164:167], v[152:155]
    ds_read_b64_tr_b16 v[60:61], v193 offset:49152
    v_mfma_f32_16x16x32_bf16 v[156:159], v[28:31], a[164:167], v[156:159]
    v_mfma_f32_16x16x32_bf16 v[160:163], v[32:35], a[164:167], v[160:163]
    ds_read_b64_tr_b16 v[62:63], v193 offset:53248
    v_mfma_f32_16x16x32_bf16 v[164:167], v[36:39], a[164:167], v[164:167]
    ds_read_b64_tr_b16 v[64:65], v194 offset:49152
    v_mfma_f32_16x16x32_bf16 v[168:171], v[40:43], a[164:167], v[168:171]
    ds_read_b64_tr_b16 v[66:67], v194 offset:53248
    v_mfma_f32_16x16x32_bf16 v[172:175], v[44:47], a[164:167], v[172:175]
    v_mfma_f32_16x16x32_bf16 a[64:67], v[16:19], a[168:171], a[64:67]
    ds_read_b64_tr_b16 v[68:69], v195 offset:49152
    v_mfma_f32_16x16x32_bf16 a[68:71], v[20:23], a[168:171], a[68:71]
    ds_read_b64_tr_b16 v[70:71], v195 offset:53248
    v_mfma_f32_16x16x32_bf16 a[72:75], v[24:27], a[168:171], a[72:75]
    ds_read_b64_tr_b16 v[72:73], v196 offset:49152
    v_mfma_f32_16x16x32_bf16 a[76:79], v[28:31], a[168:171], a[76:79]
    v_mfma_f32_16x16x32_bf16 a[80:83], v[32:35], a[168:171], a[80:83]
    ds_read_b64_tr_b16 v[74:75], v196 offset:53248
    v_mfma_f32_16x16x32_bf16 a[84:87], v[36:39], a[168:171], a[84:87]
    ds_read_b64_tr_b16 v[76:77], v197 offset:49152
    v_mfma_f32_16x16x32_bf16 a[88:91], v[40:43], a[168:171], a[88:91]
    ds_read_b64_tr_b16 v[78:79], v197 offset:53248
    v_mfma_f32_16x16x32_bf16 a[92:95], v[44:47], a[168:171], a[92:95]
    v_mfma_f32_16x16x32_bf16 a[96:99], v[16:19], a[172:175], a[96:99]
    v_mfma_f32_16x16x32_bf16 a[100:103], v[20:23], a[172:175], a[100:103]
    v_mfma_f32_16x16x32_bf16 a[104:107], v[24:27], a[172:175], a[104:107]
    v_mfma_f32_16x16x32_bf16 a[108:111], v[28:31], a[172:175], a[108:111]
    v_mfma_f32_16x16x32_bf16 a[112:115], v[32:35], a[172:175], a[112:115]
    v_mfma_f32_16x16x32_bf16 a[116:119], v[36:39], a[172:175], a[116:119]
    v_mfma_f32_16x16x32_bf16 a[120:123], v[40:43], a[172:175], a[120:123]
    v_mfma_f32_16x16x32_bf16 a[124:127], v[44:47], a[172:175], a[124:127]
    s_waitcnt vmcnt(9) lgkmcnt(0)
    v_mfma_f32_16x16x32_bf16 a[64:67], v[48:51], a[184:187], a[64:67]
    v_mfma_f32_16x16x32_bf16 a[68:71], v[52:55], a[184:187], a[68:71]
    s_barrier
    s_xor_b32 s85, s14, 1
    s_lshl_b32 s85, s85, 14
    v_mfma_f32_16x16x32_bf16 a[72:75], v[56:59], a[184:187], a[72:75]
    v_add_u32 v212, s85, v210
    s_lshl_b32 s85, s14, 14
    v_mfma_f32_16x16x32_bf16 a[76:79], v[60:63], a[184:187], a[76:79]
    v_add_u32 v213, s85, v210
    v_mfma_f32_16x16x32_bf16 a[80:83], v[64:67], a[184:187], a[80:83]
    v_mfma_f32_16x16x32_bf16 a[84:87], v[68:71], a[184:187], a[84:87]
    v_mfma_f32_16x16x32_bf16 a[88:91], v[72:75], a[184:187], a[88:91]
    v_mfma_f32_16x16x32_bf16 a[92:95], v[76:79], a[184:187], a[92:95]
    v_mfma_f32_16x16x32_bf16 a[96:99], v[48:51], a[188:191], a[96:99]
    v_mfma_f32_16x16x32_bf16 a[100:103], v[52:55], a[188:191], a[100:103]
    v_mfma_f32_16x16x32_bf16 a[104:107], v[56:59], a[188:191], a[104:107]
    ds_write_b128 v212, a[64:67] offset:0
    v_mfma_f32_16x16x32_bf16 a[108:111], v[60:63], a[188:191], a[108:111]
    ds_write_b128 v212, a[68:71] offset:1024
    v_mfma_f32_16x16x32_bf16 a[112:115], v[64:67], a[188:191], a[112:115]
    v_mfma_f32_16x16x32_bf16 a[116:119], v[68:71], a[188:191], a[116:119]
    ds_write_b128 v212, a[72:75] offset:2048
    v_mfma_f32_16x16x32_bf16 a[120:123], v[72:75], a[188:191], a[120:123]
    ds_write_b128 v212, a[76:79] offset:3072
    v_mfma_f32_16x16x32_bf16 a[124:127], v[76:79], a[188:191], a[124:127]
    v_mfma_f32_16x16x32_bf16 v[112:115], v[48:51], a[176:179], v[112:115]
    ds_write_b128 v212, a[80:83] offset:4096
    v_mfma_f32_16x16x32_bf16 v[116:119], v[52:55], a[176:179], v[116:119]
    ds_write_b128 v212, a[84:87] offset:5120
    v_mfma_f32_16x16x32_bf16 v[120:123], v[56:59], a[176:179], v[120:123]
    v_mfma_f32_16x16x32_bf16 v[124:127], v[60:63], a[176:179], v[124:127]
    ds_write_b128 v212, a[88:91] offset:6144
    v_mfma_f32_16x16x32_bf16 v[128:131], v[64:67], a[176:179], v[128:131]
    ds_write_b128 v212, a[92:95] offset:7168
    v_mfma_f32_16x16x32_bf16 v[132:135], v[68:71], a[176:179], v[132:135]
    v_mfma_f32_16x16x32_bf16 v[136:139], v[72:75], a[176:179], v[136:139]
    ds_write_b128 v212, a[96:99] offset:8192
    v_mfma_f32_16x16x32_bf16 v[140:143], v[76:79], a[176:179], v[140:143]
    ds_write_b128 v212, a[100:103] offset:9216
    v_mfma_f32_16x16x32_bf16 v[144:147], v[48:51], a[180:183], v[144:147]
    v_mfma_f32_16x16x32_bf16 v[148:151], v[52:55], a[180:183], v[148:151]
    ds_write_b128 v212, a[104:107] offset:10240
    v_mfma_f32_16x16x32_bf16 v[152:155], v[56:59], a[180:183], v[152:155]
    ds_write_b128 v212, a[108:111] offset:11264
    v_mfma_f32_16x16x32_bf16 v[156:159], v[60:63], a[180:183], v[156:159]
    v_mfma_f32_16x16x32_bf16 v[160:163], v[64:67], a[180:183], v[160:163]
    ds_write_b128 v212, a[112:115] offset:12288
    v_mfma_f32_16x16x32_bf16 v[164:167], v[68:71], a[180:183], v[164:167]
    ds_write_b128 v212, a[116:119] offset:13312
    v_mfma_f32_16x16x32_bf16 v[168:171], v[72:75], a[180:183], v[168:171]
    v_mfma_f32_16x16x32_bf16 v[172:175], v[76:79], a[180:183], v[172:175]
    ds_write_b128 v212, a[120:123] offset:14336
    ds_write_b128 v212, a[124:127] offset:15360
    s_waitcnt lgkmcnt(0)
    s_barrier
    ds_read_b128 v[48:51], v213 offset:8192
    ds_read_b128 v[52:55], v213 offset:9216
    ds_read_b128 v[56:59], v213 offset:10240
    ds_read_b128 v[60:63], v213 offset:11264
    ds_read_b128 v[64:67], v213 offset:12288
    ds_read_b128 v[68:71], v213 offset:13312
    ds_read_b128 v[72:75], v213 offset:14336
    ds_read_b128 v[76:79], v213 offset:15360
    ds_read_b128 v[16:19], v213 offset:0
    ds_read_b128 v[20:23], v213 offset:1024
    ds_read_b128 v[24:27], v213 offset:2048
    ds_read_b128 v[28:31], v213 offset:3072
    ds_read_b128 v[32:35], v213 offset:4096
    ds_read_b128 v[36:39], v213 offset:5120
    ds_read_b128 v[40:43], v213 offset:6144
    ds_read_b128 v[44:47], v213 offset:7168
    s_xor_b32 s85, s84, 0x8000
    s_xor_b32 s86, s83, 16
    s_add_u32 s72, s84, 4096
    s_waitcnt lgkmcnt(15)
    v_pk_add_f32 v[144:145], v[144:145], v[48:49]
    v_pk_add_f32 v[146:147], v[146:147], v[50:51]
    s_waitcnt lgkmcnt(14)
    v_pk_add_f32 v[148:149], v[148:149], v[52:53]
    v_pk_add_f32 v[150:151], v[150:151], v[54:55]
    v_cvt_pk_bf16_f32 v144, v144, v145
    v_cvt_pk_bf16_f32 v145, v146, v147
    v_cvt_pk_bf16_f32 v146, v148, v149
    v_cvt_pk_bf16_f32 v147, v150, v151
    buffer_store_dwordx4 v[144:147], v210, s[64:67], s84 offen offset:0
    s_waitcnt lgkmcnt(13)
    v_pk_add_f32 v[152:153], v[152:153], v[56:57]
    v_pk_add_f32 v[154:155], v[154:155], v[58:59]
    s_waitcnt lgkmcnt(12)
    v_pk_add_f32 v[156:157], v[156:157], v[60:61]
    v_pk_add_f32 v[158:159], v[158:159], v[62:63]
    v_cvt_pk_bf16_f32 v152, v152, v153
    v_cvt_pk_bf16_f32 v153, v154, v155
    v_cvt_pk_bf16_f32 v154, v156, v157
    v_cvt_pk_bf16_f32 v155, v158, v159
    buffer_store_dwordx4 v[152:155], v210, s[64:67], s84 offen offset:1024
    s_waitcnt lgkmcnt(11)
    v_pk_add_f32 v[160:161], v[160:161], v[64:65]
    v_pk_add_f32 v[162:163], v[162:163], v[66:67]
    s_waitcnt lgkmcnt(10)
    v_pk_add_f32 v[164:165], v[164:165], v[68:69]
    v_pk_add_f32 v[166:167], v[166:167], v[70:71]
    v_cvt_pk_bf16_f32 v160, v160, v161
    v_cvt_pk_bf16_f32 v161, v162, v163
    v_cvt_pk_bf16_f32 v162, v164, v165
    v_cvt_pk_bf16_f32 v163, v166, v167
    buffer_store_dwordx4 v[160:163], v210, s[64:67], s84 offen offset:2048
    s_waitcnt lgkmcnt(9)
    v_pk_add_f32 v[168:169], v[168:169], v[72:73]
    v_pk_add_f32 v[170:171], v[170:171], v[74:75]
    s_waitcnt lgkmcnt(8)
    v_pk_add_f32 v[172:173], v[172:173], v[76:77]
    v_pk_add_f32 v[174:175], v[174:175], v[78:79]
    v_cvt_pk_bf16_f32 v168, v168, v169
    v_cvt_pk_bf16_f32 v169, v170, v171
    v_cvt_pk_bf16_f32 v170, v172, v173
    v_cvt_pk_bf16_f32 v171, v174, v175
    buffer_store_dwordx4 v[168:171], v210, s[64:67], s84 offen offset:3072
    s_waitcnt lgkmcnt(7)
    v_pk_add_f32 v[112:113], v[112:113], v[16:17]
    v_pk_add_f32 v[114:115], v[114:115], v[18:19]
    s_waitcnt lgkmcnt(6)
    v_pk_add_f32 v[116:117], v[116:117], v[20:21]
    v_pk_add_f32 v[118:119], v[118:119], v[22:23]
    s_waitcnt lgkmcnt(5)
    v_pk_add_f32 v[120:121], v[120:121], v[24:25]
    v_pk_add_f32 v[122:123], v[122:123], v[26:27]
    s_waitcnt lgkmcnt(4)
    v_pk_add_f32 v[124:125], v[124:125], v[28:29]
    v_pk_add_f32 v[126:127], v[126:127], v[30:31]
    s_waitcnt lgkmcnt(3)
    v_pk_add_f32 v[128:129], v[128:129], v[32:33]
    v_pk_add_f32 v[130:131], v[130:131], v[34:35]
    s_waitcnt lgkmcnt(2)
    v_pk_add_f32 v[132:133], v[132:133], v[36:37]
    v_pk_add_f32 v[134:135], v[134:135], v[38:39]
    s_waitcnt lgkmcnt(1)
    v_pk_add_f32 v[136:137], v[136:137], v[40:41]
    v_pk_add_f32 v[138:139], v[138:139], v[42:43]
    s_waitcnt lgkmcnt(0)
    v_pk_add_f32 v[140:141], v[140:141], v[44:45]
    v_pk_add_f32 v[142:143], v[142:143], v[46:47]
    v_mov_b32 v214, 1
    s_waitcnt vmcnt(0)
    s_cmp_eq_u32 s93, 0
    s_cbranch_scc0 L_g2_rm
    s_mov_b64 exec, 1
    buffer_store_dword v214, off, s[24:27], s83
    s_mov_b64 exec, -1
L_g2_rr:
    buffer_load_dword v209, v211, s[24:27], s86 offen sc1
    v_permlane16_swap_b32 v80, v82
    v_permlane16_swap_b32 v81, v83
    v_permlane16_swap_b32 v84, v86
    v_permlane16_swap_b32 v85, v87
    v_permlane16_swap_b32 v88, v90
    v_permlane16_swap_b32 v89, v91
    v_permlane16_swap_b32 v92, v94
    v_permlane16_swap_b32 v93, v95
    s_nop 1
    v_lshlrev_b32 v214, 16, v80
    v_and_b32 v215, 0xffff0000, v80
    v_pk_add_f32 v[112:113], v[112:113], v[214:215]
    v_lshlrev_b32 v214, 16, v81
    v_and_b32 v215, 0xffff0000, v81
    v_pk_add_f32 v[114:115], v[114:115], v[214:215]
    v_lshlrev_b32 v214, 16, v82
    v_and_b32 v215, 0xffff0000, v82
    v_pk_add_f32 v[116:117], v[116:117], v[214:215]
    v_lshlrev_b32 v214, 16, v83
    v_and_b32 v215, 0xffff0000, v83
    v_pk_add_f32 v[118:119], v[118:119], v[214:215]
    v_lshlrev_b32 v214, 16, v84
    v_and_b32 v215, 0xffff0000, v84
    v_pk_add_f32 v[120:121], v[120:121], v[214:215]
    v_lshlrev_b32 v214, 16, v85
    v_and_b32 v215, 0xffff0000, v85
    v_pk_add_f32 v[122:123], v[122:123], v[214:215]
    v_lshlrev_b32 v214, 16, v86
    v_and_b32 v215, 0xffff0000, v86
    v_pk_add_f32 v[124:125], v[124:125], v[214:215]
    v_lshlrev_b32 v214, 16, v87
    v_and_b32 v215, 0xffff0000, v87
    v_pk_add_f32 v[126:127], v[126:127], v[214:215]
    v_lshlrev_b32 v214, 16, v88
    v_and_b32 v215, 0xffff0000, v88
    v_pk_add_f32 v[128:129], v[128:129], v[214:215]
    v_lshlrev_b32 v214, 16, v89
    v_and_b32 v215, 0xffff0000, v89
    v_pk_add_f32 v[130:131], v[130:131], v[214:215]
    v_lshlrev_b32 v214, 16, v90
    v_and_b32 v215, 0xffff0000, v90
    v_pk_add_f32 v[132:133], v[132:133], v[214:215]
    v_lshlrev_b32 v214, 16, v91
    v_and_b32 v215, 0xffff0000, v91
    v_pk_add_f32 v[134:135], v[134:135], v[214:215]
    v_lshlrev_b32 v214, 16, v92
    v_and_b32 v215, 0xffff0000, v92
    v_pk_add_f32 v[136:137], v[136:137], v[214:215]
    v_lshlrev_b32 v214, 16, v93
    v_and_b32 v215, 0xffff0000, v93
    v_pk_add_f32 v[138:139], v[138:139], v[214:215]
    v_lshlrev_b32 v214, 16, v94
    v_and_b32 v215, 0xffff0000, v94
    v_pk_add_f32 v[140:141], v[140:141], v[214:215]
    v_lshlrev_b32 v214, 16, v95
    v_and_b32 v215, 0xffff0000, v95
    v_pk_add_f32 v[142:143], v[142:143], v[214:215]
    s_waitcnt vmcnt(0)
    s_mov_b32 s19, 0x80000
L_fw_p:
    v_cmp_ne_u32 vcc, 1, v209
    s_nop 1
    s_cmp_eq_u64 vcc, 0
    s_cbranch_scc1 L_fwd_p
    s_sleep 1
    buffer_load_dword v209, v211, s[24:27], s86 offen sc1
    s_waitcnt vmcnt(0)
    s_sub_u32 s19, s19, 1
    s_cmp_lg_u32 s19, 0
    s_cbranch_scc1 L_fw_p
L_fwd_p:
    s_add_u32 s72, s85, 4096
    buffer_load_dwordx4 v[96:99], v210, s[64:67], s85 offen offset:0 sc1
    buffer_load_dwordx4 v[100:103], v210, s[64:67], s85 offen offset:1024 sc1
    buffer_load_dwordx4 v[104:107], v210, s[64:67], s85 offen offset:2048 sc1
    buffer_load_dwordx4 v[108:111], v210, s[64:67], s85 offen offset:3072 sc1
    s_waitcnt vmcnt(3)
    v_lshlrev_b32 v214, 16, v96
    v_and_b32 v215, 0xffff0000, v96
    v_pk_add_f32 v[112:113], v[112:113], v[214:215]
    v_lshlrev_b32 v214, 16, v97
    v_and_b32 v215, 0xffff0000, v97
    v_pk_add_f32 v[114:115], v[114:115], v[214:215]
    v_lshlrev_b32 v214, 16, v98
    v_and_b32 v215, 0xffff0000, v98
    v_pk_add_f32 v[116:117], v[116:117], v[214:215]
    v_lshlrev_b32 v214, 16, v99
    v_and_b32 v215, 0xffff0000, v99
    v_pk_add_f32 v[118:119], v[118:119], v[214:215]
    v_cvt_pk_bf16_f32 v112, v112, v113
    v_cvt_pk_bf16_f32 v113, v114, v115
    v_cvt_pk_bf16_f32 v114, v116, v117
    v_cvt_pk_bf16_f32 v115, v118, v119
    s_nop 1
    v_permlane16_swap_b32 v112, v114
    v_permlane16_swap_b32 v113, v115
    s_nop 1
    buffer_store_dwordx4 v[112:115], v206, s[60:63], 0 offen offset:0 nt
    s_waitcnt vmcnt(3)
    v_lshlrev_b32 v214, 16, v100
    v_and_b32 v215, 0xffff0000, v100
    v_pk_add_f32 v[120:121], v[120:121], v[214:215]
    v_lshlrev_b32 v214, 16, v101
    v_and_b32 v215, 0xffff0000, v101
    v_pk_add_f32 v[122:123], v[122:123], v[214:215]
    v_lshlrev_b32 v214, 16, v102
    v_and_b32 v215, 0xffff0000, v102
    v_pk_add_f32 v[124:125], v[124:125], v[214:215]
    v_lshlrev_b32 v214, 16, v103
    v_and_b32 v215, 0xffff0000, v103
    v_pk_add_f32 v[126:127], v[126:127], v[214:215]
    v_cvt_pk_bf16_f32 v120, v120, v121
    v_cvt_pk_bf16_f32 v121, v122, v123
    v_cvt_pk_bf16_f32 v122, v124, v125
    v_cvt_pk_bf16_f32 v123, v126, v127
    s_nop 1
    v_permlane16_swap_b32 v120, v122
    v_permlane16_swap_b32 v121, v123
    s_nop 1
    buffer_store_dwordx4 v[120:123], v206, s[60:63], 0 offen offset:64 nt
    s_waitcnt vmcnt(3)
    v_lshlrev_b32 v214, 16, v104
    v_and_b32 v215, 0xffff0000, v104
    v_pk_add_f32 v[128:129], v[128:129], v[214:215]
    v_lshlrev_b32 v214, 16, v105
    v_and_b32 v215, 0xffff0000, v105
    v_pk_add_f32 v[130:131], v[130:131], v[214:215]
    v_lshlrev_b32 v214, 16, v106
    v_and_b32 v215, 0xffff0000, v106
    v_pk_add_f32 v[132:133], v[132:133], v[214:215]
    v_lshlrev_b32 v214, 16, v107
    v_and_b32 v215, 0xffff0000, v107
    v_pk_add_f32 v[134:135], v[134:135], v[214:215]
    v_cvt_pk_bf16_f32 v128, v128, v129
    v_cvt_pk_bf16_f32 v129, v130, v131
    v_cvt_pk_bf16_f32 v130, v132, v133
    v_cvt_pk_bf16_f32 v131, v134, v135
    s_nop 1
    v_permlane16_swap_b32 v128, v130
    v_permlane16_swap_b32 v129, v131
    s_nop 1
    buffer_store_dwordx4 v[128:131], v206, s[60:63], 0 offen offset:128 nt
    s_waitcnt vmcnt(3)
    v_lshlrev_b32 v214, 16, v108
    v_and_b32 v215, 0xffff0000, v108
    v_pk_add_f32 v[136:137], v[136:137], v[214:215]
    v_lshlrev_b32 v214, 16, v109
    v_and_b32 v215, 0xffff0000, v109
    v_pk_add_f32 v[138:139], v[138:139], v[214:215]
    v_lshlrev_b32 v214, 16, v110
    v_and_b32 v215, 0xffff0000, v110
    v_pk_add_f32 v[140:141], v[140:141], v[214:215]
    v_lshlrev_b32 v214, 16, v111
    v_and_b32 v215, 0xffff0000, v111
    v_pk_add_f32 v[142:143], v[142:143], v[214:215]
    v_cvt_pk_bf16_f32 v136, v136, v137
    v_cvt_pk_bf16_f32 v137, v138, v139
    v_cvt_pk_bf16_f32 v138, v140, v141
    v_cvt_pk_bf16_f32 v139, v142, v143
    s_nop 1
    v_permlane16_swap_b32 v136, v138
    v_permlane16_swap_b32 v137, v139
    s_nop 1
    buffer_store_dwordx4 v[136:139], v206, s[60:63], 0 offen offset:192 nt
    s_branch L_g2_fin
L_g2_rm:
    s_mov_b32 s66, 0x800000
    buffer_store_dwordx4 v[144:147], v210, s[64:67], s84 offen offset:0 sc1
    buffer_store_dwordx4 v[152:155], v210, s[64:67], s84 offen offset:1024 sc1
    buffer_store_dwordx4 v[160:163], v210, s[64:67], s84 offen offset:2048 sc1
    buffer_store_dwordx4 v[168:171], v210, s[64:67], s84 offen offset:3072 sc1
    s_waitcnt vmcnt(0)
    s_mov_b64 exec, 1
    buffer_store_dword v214, off, s[24:27], s83 sc1
    s_mov_b64 exec, -1
    s_branch L_g2_rr
L_g2_fin:
    s_endpgm
L_code_b:
.section .rodata,"a"
.p2align 6
.amdhsa_kernel mega_kernel
  .amdhsa_next_free_vgpr 512
  .amdhsa_next_free_sgpr 102
  .amdhsa_accum_offset 256
  .amdhsa_group_segment_fixed_size 0
  .amdhsa_kernarg_size 80
  .amdhsa_user_sgpr_count 2
  .amdhsa_user_sgpr_kernarg_segment_ptr 1
  .amdhsa_system_sgpr_workgroup_id_x 1
  .amdhsa_float_denorm_mode_32 3
.end_amdhsa_kernel
```
